```python
import torch

def _softmax(x, axis=-1):
    return torch.softmax(x, dim=axis)

def _gelu(x):
    return torch.nn.functional.gelu(x, approximate='tanh')

def _silu(x):
    return torch.nn.functional.silu(x)

def _sigmoid(x):
    return torch.sigmoid(x)

def _layernorm(x, axis=-1, eps=1e-05):
    m = x.mean(dim=axis, keepdim=True)
    v = x.var(dim=axis, keepdim=True, unbiased=False)
    return (x - m) / torch.sqrt(v + eps)

def _scatter_add(tgt, idx, src, axis=0):
    return tgt.clone().index_add_(axis, idx, src)

def _segment_sum(src, seg, n):
    out = torch.zeros((n,) + src.shape[1:], dtype=src.dtype)
    return out.index_add_(0, seg, src)

def _pad(x, pw):
    flat = tuple((v for pair in reversed(pw) for v in pair))
    return torch.nn.functional.pad(x, flat)
kernel_name = 'parallel_sum__memory_aug_recurrent_mem_tr__glu_gated_glu__prompt'

def setup_inputs():

    _w = lambda a: (lambda t: t.to(torch.bfloat16) if t.is_floating_point() else t)(torch.as_tensor(a))

    def _A_setup():
        B, S, Dm = (1, 2048, 640)
        H, Dh = (32, 128)
        M, seg = (8, 32)
        seg = min(seg, S)
        S = S // seg * seg
        return {'x': _w((lambda *s: torch.randn(*s, dtype=torch.bfloat16) * 0.05)(B, S, Dm)), 'mem0': _w((lambda *s: torch.randn(*s, dtype=torch.bfloat16) * 1.6)(B, M, Dm)), 'Wq': _w((lambda *s: torch.randn(*s, dtype=torch.bfloat16) * 0.8)(Dm, H, Dh) * Dm ** (-0.5)), 'Wk': _w((lambda *s: torch.randn(*s, dtype=torch.bfloat16) * 0.8)(Dm, H, Dh) * Dm ** (-0.5)), 'Wv': _w((lambda *s: torch.randn(*s, dtype=torch.bfloat16) * 1.6)(Dm, H, Dh) * Dm ** (-0.5)), 'Wo': _w((lambda *s: torch.randn(*s, dtype=torch.bfloat16) * 1.6)(H, Dh, Dm) * (H * Dh) ** (-0.5)), 'seg_len': seg}
    _A_in = _A_setup()

    def _B_setup():
        B, S, D, F = (1, 2048, 640, 1728)
        return {'x': _w((lambda *s: torch.randn(*s, dtype=torch.bfloat16) * 0.05)(B, S, D)), 'w_gate': _w((lambda *s: torch.randn(*s, dtype=torch.bfloat16) * 0.05)(D, F)), 'w_up': _w((lambda *s: torch.randn(*s, dtype=torch.bfloat16) * 0.05)(D, F)), 'w_down': _w((lambda *s: torch.randn(*s, dtype=torch.bfloat16) * 0.05)(F, D))}
    _B_in = _B_setup()
    return {'A_x': _A_in['x'], 'A_mem0': _A_in['mem0'], 'A_Wq': _A_in['Wq'], 'A_Wk': _A_in['Wk'], 'A_Wv': _A_in['Wv'], 'A_Wo': _A_in['Wo'], 'A_seg_len': _A_in['seg_len'], 'B_x': _B_in['x'], 'B_w_gate': _B_in['w_gate'], 'B_w_up': _B_in['w_up'], 'B_w_down': _B_in['w_down']}

def reference(A_x, A_mem0, A_Wq, A_Wk, A_Wv, A_Wo, A_seg_len, B_x, B_w_gate, B_w_up, B_w_down):

    def _A_ref(x, mem0, Wq, Wk, Wv, Wo, seg_len):
        B, S, Dm = x.shape
        H, Dh = (Wq.shape[1], Wq.shape[2])
        M = mem0.shape[1]
        scale = Dh ** (-0.5)
        n_seg = S // seg_len
        L = M + seg_len
        idx = torch.arange(L)
        mask = (idx[:, None] < M) | (idx[:, None] >= idx[None, :])
        mem = mem0
        outs = []
        for s in range(n_seg):
            xs = x[:, s * seg_len:(s + 1) * seg_len, :].clone()
            h = torch.concatenate([mem, xs], axis=1)
            q = torch.einsum('btd,dhe->bhte', h, Wq)
            k = torch.einsum('btd,dhe->bhte', h, Wk)
            v = torch.einsum('btd,dhe->bhte', h, Wv)
            scores = torch.einsum('bhqe,bhke->bhqk', q, k) * scale
            scores = torch.where(mask[None, None], scores, -1000000000.0)
            p = _softmax(scores, axis=-1)
            o = torch.einsum('bhqk,bhke->bhqe', p, v)
            o = torch.einsum('bhte,hed->btd', o, Wo)
            mem = o[:, :M, :].clone()
            outs.append(o[:, M:, :])
        return torch.concatenate(outs, axis=1)

    def _B_ref(x, w_gate, w_up, w_down):
        g = torch.einsum('bsd,df->bsf', x, w_gate)
        u = torch.einsum('bsd,df->bsf', x, w_up)
        h = _sigmoid(g) * u
        return torch.einsum('bsf,fd->bsd', h, w_down)
    x = A_x
    xn = _layernorm(x, axis=-1)
    return x + _A_ref(xn, A_mem0, A_Wq, A_Wk, A_Wv, A_Wo, A_seg_len) + _B_ref(xn, B_w_gate, B_w_up, B_w_down)
```

```asm
; @launch grid=(256,1,1) block=(256,1,1) lds=163840
.amdgcn_target "amdgcn-amd-amdhsa--gfx950"
.text
.globl parallel_sum__memory_aug_recurrent_mem_tr__glu_gated_glu__prompt_kernel
.p2align 8
.type parallel_sum__memory_aug_recurrent_mem_tr__glu_gated_glu__prompt_kernel,@function
parallel_sum__memory_aug_recurrent_mem_tr__glu_gated_glu__prompt_kernel:
    s_cmp_ge_u32 s2, 256
    s_cbranch_scc1 L_exit
    s_load_dwordx4 s[16:19], s[0:1], 0
    s_load_dwordx8 s[8:15], s[0:1], 16
    s_load_dwordx4 s[20:23], s[0:1], 96
    s_mov_b64 s[100:101], s[0:1]
    s_getreg_b32 s32, hwreg(HW_REG_XCC_ID, 0, 4)
    v_lshrrev_b32 v1, 6, v0
    s_nop 0
    v_readfirstlane_b32 s26, v1
    s_mov_b32 s27, 400000
    s_mov_b32 s33, 0
    s_waitcnt lgkmcnt(0)
    s_mov_b32 s4, s22
    s_and_b32 s5, s23, 0xffff
    s_mov_b32 s6, 0x10000000
    s_mov_b32 s7, 0x20000
    s_cmp_lg_u32 s26, 0
    s_cbranch_scc1 L_tk
    s_mov_b64 exec, 3
    s_lshl_b32 s28, s2, 8
    s_add_u32 s28, s28, 71303168
    v_lshlrev_b32 v1, 7, v0
    v_mov_b32 v2, 0
    buffer_store_dword v2, v1, s[4:7], s28 offen sc1
    s_and_b32 s28, s32, 3
    s_lshl_b32 s28, s28, 6
    s_bfe_u32 s29, s32, 0x10002
    s_lshl_b32 s29, s29, 2
    s_add_u32 s28, s28, s29
    v_mov_b32 v1, s28
    v_mov_b32 v2, 1
    s_mov_b64 exec, 1
    s_waitcnt vmcnt(0)
    global_atomic_add v3, v1, v2, s[20:21] sc0
    v_mov_b32 v1, 0
    s_waitcnt vmcnt(0)
    ds_write_b32 v1, v3
    s_waitcnt lgkmcnt(0)
    s_mov_b64 exec, -1
L_tk:
    s_barrier
    v_mov_b32 v1, 0
    ds_read_b32 v2, v1
    s_waitcnt lgkmcnt(0)
    v_readfirstlane_b32 s24, v2
    s_barrier
    s_and_b32 s25, s32, 7
    s_cmp_ge_u32 s24, 32
    s_cbranch_scc1 L_norole
L_dispatch:
    s_cmp_lt_u32 s25, 2
    s_cbranch_scc1 L_R
    s_load_dwordx8 s[36:43], s[100:101], 64
    s_waitcnt lgkmcnt(0)
    s_cmp_eq_u32 s25, 4
    s_cbranch_scc1 L_KV
    s_cmp_eq_u32 s25, 2
    s_cbranch_scc1 L_QA
    s_cmp_eq_u32 s25, 5
    s_cbranch_scc0 L_d5
    s_add_u32 s24, s24, 32
    s_branch L_KV
L_d5:
    s_cmp_eq_u32 s25, 3
    s_cbranch_scc0 L_d6
    s_cmp_lt_u32 s24, 27
    s_cbranch_scc1 L_G2
    s_sub_u32 s24, s24, 27
    s_branch L_F
L_d6:
    s_cmp_eq_u32 s25, 6
    s_cbranch_scc0 L_d7
    s_cmp_lt_u32 s24, 30
    s_cbranch_scc1 L_G4
    s_sub_u32 s24, s24, 25
    s_branch L_F
L_d7:
    s_cmp_lt_u32 s24, 10
    s_cbranch_scc0 L_d7b
    s_add_u32 s24, s24, 30
    s_branch L_G4
L_d7b:
    s_cmp_lt_u32 s24, 25
    s_cbranch_scc0 L_d7c
    s_sub_u32 s24, s24, 10
    s_branch L_G3
L_d7c:
    s_sub_u32 s24, s24, 18
    s_branch L_F
L_norole:
    v_mbcnt_lo_u32_b32 v1, -1, 0
    v_bfe_u32 v2, v1, 2, 1
    v_and_b32 v1, 3, v1
    v_lshlrev_b32 v1, 6, v1
    v_lshl_add_u32 v1, v2, 2, v1
L_cen_1:
    global_load_dword v2, v1, s[20:21] sc1
    s_sub_u32 s27, s27, 1
    s_cbranch_scc0 L_ok_3
    s_mov_b32 s28, 10
    s_branch L_bail
L_ok_3:
    s_waitcnt vmcnt(0)
L_cenc_2:
    s_mov_b32 s29, 0
    v_readlane_b32 s30, v2, 0
    s_nop 0
    s_add_u32 s29, s29, s30
    v_readlane_b32 s30, v2, 1
    s_nop 0
    s_add_u32 s29, s29, s30
    v_readlane_b32 s30, v2, 2
    s_nop 0
    s_add_u32 s29, s29, s30
    v_readlane_b32 s30, v2, 3
    s_nop 0
    s_add_u32 s29, s29, s30
    v_readlane_b32 s30, v2, 4
    s_nop 0
    s_add_u32 s29, s29, s30
    v_readlane_b32 s30, v2, 5
    s_nop 0
    s_add_u32 s29, s29, s30
    v_readlane_b32 s30, v2, 6
    s_nop 0
    s_add_u32 s29, s29, s30
    v_readlane_b32 s30, v2, 7
    s_nop 0
    s_add_u32 s29, s29, s30
    s_cmp_lt_u32 s29, 256
    s_cbranch_scc1 L_cen_1
    v_cmp_ne_u32 vcc, 32, v2
    s_cbranch_vccnz L_fallback
L_fallback:
    s_waitcnt vmcnt(0) lgkmcnt(0)
    s_barrier
    s_mov_b32 s33, 1
    v_mbcnt_lo_u32_b32 v0, -1, 0
    v_mbcnt_hi_u32_b32 v0, -1, v0
    s_lshl_b32 s28, s26, 6
    v_add_u32 v0, s28, v0
    s_lshr_b32 s25, s2, 5
    s_and_b32 s24, s2, 31
    s_branch L_dispatch
L_F:
    s_getpc_b64 s[28:29]
    v_lshlrev_b32 v1, 4, v0
    global_load_dwordx4 v[252:255], v1, s[28:29]
    v_add_u32 v1, 4096, v1
    global_load_dwordx4 v[252:255], v1, s[28:29]
    v_and_b32 v1, 63, v0
    v_mov_b32 v3, 0
    v_lshlrev_b32 v4, 4, v1
    s_mov_b32 s44, s16
    s_and_b32 s45, s17, 0xffff
    s_mov_b32 s46, 2621440
    s_mov_b32 s47, 0x20000
    s_mov_b32 s48, s42
    s_and_b32 s49, s43, 0xffff
    s_mov_b32 s50, 2621440
    s_mov_b32 s51, 0x20000
    v_mov_b32 v10, 0
    s_mul_i32 s28, s24, 128
    v_add_u32 v10, s28, v10
    v_add_u32 v10, 71303168, v10
    v_mov_b32 v6, 1073741824
    v_cmp_eq_u32 vcc, 0, v0
    s_nop 1
    v_cndmask_b32 v10, v6, v10, vcc
    s_lshl_b32 s29, s24, 2
    s_add_u32 s55, s29, s26
    s_cmp_lg_u32 s55, 55
    s_cbranch_scc1 L_noprobe_4
    v_mov_b32 v17, 68681728
    s_mov_b64 exec, 1
    s_mov_b32 s68, -1
    s_mov_b32 s69, -1
    s_waitcnt vmcnt(0)
    s_mov_b32 s30, 0
    s_memtime s[64:65]
    s_waitcnt lgkmcnt(0)
    buffer_store_dword v3, v17, s[4:7], s30 offen sc1
    s_waitcnt vmcnt(0)
    s_memtime s[66:67]
    s_waitcnt lgkmcnt(0)
    s_sub_u32 s30, s66, s64
    s_min_u32 s68, s68, s30
    s_mov_b32 s30, 8192
    s_memtime s[64:65]
    s_waitcnt lgkmcnt(0)
    buffer_store_dword v3, v17, s[4:7], s30 offen sc1
    s_waitcnt vmcnt(0)
    s_memtime s[66:67]
    s_waitcnt lgkmcnt(0)
    s_sub_u32 s30, s66, s64
    s_min_u32 s69, s69, s30
    s_mov_b32 s30, 128
    s_memtime s[64:65]
    s_waitcnt lgkmcnt(0)
    buffer_store_dword v3, v17, s[4:7], s30 offen sc1
    s_waitcnt vmcnt(0)
    s_memtime s[66:67]
    s_waitcnt lgkmcnt(0)
    s_sub_u32 s30, s66, s64
    s_min_u32 s68, s68, s30
    s_mov_b32 s30, 8320
    s_memtime s[64:65]
    s_waitcnt lgkmcnt(0)
    buffer_store_dword v3, v17, s[4:7], s30 offen sc1
    s_waitcnt vmcnt(0)
    s_memtime s[66:67]
    s_waitcnt lgkmcnt(0)
    s_sub_u32 s30, s66, s64
    s_min_u32 s69, s69, s30
    s_mov_b32 s30, 256
    s_memtime s[64:65]
    s_waitcnt lgkmcnt(0)
    buffer_store_dword v3, v17, s[4:7], s30 offen sc1
    s_waitcnt vmcnt(0)
    s_memtime s[66:67]
    s_waitcnt lgkmcnt(0)
    s_sub_u32 s30, s66, s64
    s_min_u32 s68, s68, s30
    s_mov_b32 s30, 8448
    s_memtime s[64:65]
    s_waitcnt lgkmcnt(0)
    buffer_store_dword v3, v17, s[4:7], s30 offen sc1
    s_waitcnt vmcnt(0)
    s_memtime s[66:67]
    s_waitcnt lgkmcnt(0)
    s_sub_u32 s30, s66, s64
    s_min_u32 s69, s69, s30
    s_cmp_lt_u32 s69, s68
    s_cselect_b32 s30, 1, 0
    s_lshr_b32 s31, s32, 2
    s_xor_b32 s30, s30, s31
    s_or_b32 s30, s30, 2
    v_mov_b32 v17, s30
    s_lshl_b32 s30, s33, 2
    v_mov_b32 v6, s30
    global_store_dword v6, v17, s[20:21] offset:48 sc1
    s_mov_b64 exec, -1
L_noprobe_4:
    v_bfe_u32 v2, v1, 0, 3
    v_mul_u32_u24 v11, 1280, v2
    v_bfe_u32 v2, v1, 3, 3
    v_mul_u32_u24 v2, 16, v2
    v_add_u32 v11, v11, v2
    s_mul_i32 s28, s26, 10240
    v_add_u32 v11, s28, v11
    v_bfe_u32 v2, v1, 4, 2
    v_mul_u32_u24 v12, 1024, v2
    v_bfe_u32 v2, v1, 3, 1
    v_mul_u32_u24 v2, 512, v2
    v_add_u32 v12, v12, v2
    v_bfe_u32 v2, v1, 0, 3
    v_mul_u32_u24 v2, 16, v2
    v_add_u32 v12, v12, v2
    s_mul_i32 s28, s26, 128
    v_add_u32 v12, s28, v12
    s_mov_b32 s52, s24
    s_mov_b32 s54, 0
    s_mul_i32 s53, s52, 40960
    buffer_load_dwordx4 v[18:21], v11, s[44:47], s53 offen offset:0
    buffer_load_dwordx4 v[22:25], v11, s[44:47], s53 offen offset:128
    buffer_load_dwordx4 v[26:29], v11, s[44:47], s53 offen offset:256
    buffer_load_dwordx4 v[30:33], v11, s[44:47], s53 offen offset:384
    buffer_load_dwordx4 v[34:37], v11, s[44:47], s53 offen offset:512
    buffer_load_dwordx4 v[38:41], v11, s[44:47], s53 offen offset:640
    buffer_load_dwordx4 v[42:45], v11, s[44:47], s53 offen offset:768
    buffer_load_dwordx4 v[46:49], v11, s[44:47], s53 offen offset:896
    buffer_load_dwordx4 v[50:53], v11, s[44:47], s53 offen offset:1024
    buffer_load_dwordx4 v[54:57], v11, s[44:47], s53 offen offset:1152
L_ln_5:
    s_waitcnt vmcnt(0)
    v_lshlrev_b32 v66, 16, v18
    v_and_b32 v67, 0xffff0000, v18
    v_lshlrev_b32 v68, 16, v19
    v_and_b32 v69, 0xffff0000, v19
    v_lshlrev_b32 v70, 16, v20
    v_and_b32 v71, 0xffff0000, v20
    v_lshlrev_b32 v72, 16, v21
    v_and_b32 v73, 0xffff0000, v21
    v_lshlrev_b32 v74, 16, v22
    v_and_b32 v75, 0xffff0000, v22
    v_lshlrev_b32 v76, 16, v23
    v_and_b32 v77, 0xffff0000, v23
    v_lshlrev_b32 v78, 16, v24
    v_and_b32 v79, 0xffff0000, v24
    v_lshlrev_b32 v80, 16, v25
    v_and_b32 v81, 0xffff0000, v25
    v_lshlrev_b32 v82, 16, v26
    v_and_b32 v83, 0xffff0000, v26
    v_lshlrev_b32 v84, 16, v27
    v_and_b32 v85, 0xffff0000, v27
    v_lshlrev_b32 v86, 16, v28
    v_and_b32 v87, 0xffff0000, v28
    v_lshlrev_b32 v88, 16, v29
    v_and_b32 v89, 0xffff0000, v29
    v_lshlrev_b32 v90, 16, v30
    v_and_b32 v91, 0xffff0000, v30
    v_lshlrev_b32 v92, 16, v31
    v_and_b32 v93, 0xffff0000, v31
    v_lshlrev_b32 v94, 16, v32
    v_and_b32 v95, 0xffff0000, v32
    v_lshlrev_b32 v96, 16, v33
    v_and_b32 v97, 0xffff0000, v33
    v_lshlrev_b32 v98, 16, v34
    v_and_b32 v99, 0xffff0000, v34
    v_lshlrev_b32 v100, 16, v35
    v_and_b32 v101, 0xffff0000, v35
    v_lshlrev_b32 v102, 16, v36
    v_and_b32 v103, 0xffff0000, v36
    v_lshlrev_b32 v104, 16, v37
    v_and_b32 v105, 0xffff0000, v37
    v_lshlrev_b32 v106, 16, v38
    v_and_b32 v107, 0xffff0000, v38
    v_lshlrev_b32 v108, 16, v39
    v_and_b32 v109, 0xffff0000, v39
    v_lshlrev_b32 v110, 16, v40
    v_and_b32 v111, 0xffff0000, v40
    v_lshlrev_b32 v112, 16, v41
    v_and_b32 v113, 0xffff0000, v41
    v_lshlrev_b32 v114, 16, v42
    v_and_b32 v115, 0xffff0000, v42
    v_lshlrev_b32 v116, 16, v43
    v_and_b32 v117, 0xffff0000, v43
    v_lshlrev_b32 v118, 16, v44
    v_and_b32 v119, 0xffff0000, v44
    v_lshlrev_b32 v120, 16, v45
    v_and_b32 v121, 0xffff0000, v45
    v_lshlrev_b32 v122, 16, v46
    v_and_b32 v123, 0xffff0000, v46
    v_lshlrev_b32 v124, 16, v47
    v_and_b32 v125, 0xffff0000, v47
    v_lshlrev_b32 v126, 16, v48
    v_and_b32 v127, 0xffff0000, v48
    v_lshlrev_b32 v128, 16, v49
    v_and_b32 v129, 0xffff0000, v49
    v_lshlrev_b32 v130, 16, v50
    v_and_b32 v131, 0xffff0000, v50
    v_lshlrev_b32 v132, 16, v51
    v_and_b32 v133, 0xffff0000, v51
    v_lshlrev_b32 v134, 16, v52
    v_and_b32 v135, 0xffff0000, v52
    v_lshlrev_b32 v136, 16, v53
    v_and_b32 v137, 0xffff0000, v53
    v_lshlrev_b32 v138, 16, v54
    v_and_b32 v139, 0xffff0000, v54
    v_lshlrev_b32 v140, 16, v55
    v_and_b32 v141, 0xffff0000, v55
    v_lshlrev_b32 v142, 16, v56
    v_and_b32 v143, 0xffff0000, v56
    v_lshlrev_b32 v144, 16, v57
    v_and_b32 v145, 0xffff0000, v57
    s_mul_i32 s62, s52, 40960
    s_add_u32 s62, s62, 75497472
    s_add_u32 s52, s52, 14
    s_mul_i32 s53, s52, 40960
    buffer_load_dwordx4 v[18:21], v11, s[44:47], s53 offen offset:0
    buffer_load_dwordx4 v[22:25], v11, s[44:47], s53 offen offset:128
    buffer_load_dwordx4 v[26:29], v11, s[44:47], s53 offen offset:256
    buffer_load_dwordx4 v[30:33], v11, s[44:47], s53 offen offset:384
    buffer_load_dwordx4 v[34:37], v11, s[44:47], s53 offen offset:512
    buffer_load_dwordx4 v[38:41], v11, s[44:47], s53 offen offset:640
    buffer_load_dwordx4 v[42:45], v11, s[44:47], s53 offen offset:768
    buffer_load_dwordx4 v[46:49], v11, s[44:47], s53 offen offset:896
    buffer_load_dwordx4 v[50:53], v11, s[44:47], s53 offen offset:1024
    buffer_load_dwordx4 v[54:57], v11, s[44:47], s53 offen offset:1152
    v_pk_add_f32 v[8:9], v[66:67], v[68:69]
    v_pk_add_f32 v[8:9], v[8:9], v[70:71]
    v_pk_add_f32 v[8:9], v[8:9], v[72:73]
    v_pk_add_f32 v[8:9], v[8:9], v[74:75]
    v_pk_add_f32 v[8:9], v[8:9], v[76:77]
    v_pk_add_f32 v[8:9], v[8:9], v[78:79]
    v_pk_add_f32 v[8:9], v[8:9], v[80:81]
    v_pk_add_f32 v[8:9], v[8:9], v[82:83]
    v_pk_add_f32 v[8:9], v[8:9], v[84:85]
    v_pk_add_f32 v[8:9], v[8:9], v[86:87]
    v_pk_add_f32 v[8:9], v[8:9], v[88:89]
    v_pk_add_f32 v[8:9], v[8:9], v[90:91]
    v_pk_add_f32 v[8:9], v[8:9], v[92:93]
    v_pk_add_f32 v[8:9], v[8:9], v[94:95]
    v_pk_add_f32 v[8:9], v[8:9], v[96:97]
    v_pk_add_f32 v[8:9], v[8:9], v[98:99]
    v_pk_add_f32 v[8:9], v[8:9], v[100:101]
    v_pk_add_f32 v[8:9], v[8:9], v[102:103]
    v_pk_add_f32 v[8:9], v[8:9], v[104:105]
    v_pk_add_f32 v[8:9], v[8:9], v[106:107]
    v_pk_add_f32 v[8:9], v[8:9], v[108:109]
    v_pk_add_f32 v[8:9], v[8:9], v[110:111]
    v_pk_add_f32 v[8:9], v[8:9], v[112:113]
    v_pk_add_f32 v[8:9], v[8:9], v[114:115]
    v_pk_add_f32 v[8:9], v[8:9], v[116:117]
    v_pk_add_f32 v[8:9], v[8:9], v[118:119]
    v_pk_add_f32 v[8:9], v[8:9], v[120:121]
    v_pk_add_f32 v[8:9], v[8:9], v[122:123]
    v_pk_add_f32 v[8:9], v[8:9], v[124:125]
    v_pk_add_f32 v[8:9], v[8:9], v[126:127]
    v_pk_add_f32 v[8:9], v[8:9], v[128:129]
    v_pk_add_f32 v[8:9], v[8:9], v[130:131]
    v_pk_add_f32 v[8:9], v[8:9], v[132:133]
    v_pk_add_f32 v[8:9], v[8:9], v[134:135]
    v_pk_add_f32 v[8:9], v[8:9], v[136:137]
    v_pk_add_f32 v[8:9], v[8:9], v[138:139]
    v_pk_add_f32 v[8:9], v[8:9], v[140:141]
    v_pk_add_f32 v[8:9], v[8:9], v[142:143]
    v_pk_add_f32 v[8:9], v[8:9], v[144:145]
    v_add_f32 v6, v8, v9
    s_nop 1
    v_add_f32_dpp v6, v6, v6 row_ror:8 row_mask:0xf bank_mask:0xf
    v_mov_b32 v7, v6
    s_nop 1
    v_permlane16_swap_b32 v7, v6
    v_add_f32 v6, v6, v7
    v_mov_b32 v7, v6
    s_nop 1
    v_permlane32_swap_b32 v7, v6
    v_add_f32 v6, v6, v7
    v_mul_f32 v6, 0x3acccccd, v6
    v_sub_f32 v66, v66, v6
    v_sub_f32 v67, v67, v6
    v_sub_f32 v68, v68, v6
    v_sub_f32 v69, v69, v6
    v_sub_f32 v70, v70, v6
    v_sub_f32 v71, v71, v6
    v_sub_f32 v72, v72, v6
    v_sub_f32 v73, v73, v6
    v_sub_f32 v74, v74, v6
    v_sub_f32 v75, v75, v6
    v_sub_f32 v76, v76, v6
    v_sub_f32 v77, v77, v6
    v_sub_f32 v78, v78, v6
    v_sub_f32 v79, v79, v6
    v_sub_f32 v80, v80, v6
    v_sub_f32 v81, v81, v6
    v_sub_f32 v82, v82, v6
    v_sub_f32 v83, v83, v6
    v_sub_f32 v84, v84, v6
    v_sub_f32 v85, v85, v6
    v_sub_f32 v86, v86, v6
    v_sub_f32 v87, v87, v6
    v_sub_f32 v88, v88, v6
    v_sub_f32 v89, v89, v6
    v_sub_f32 v90, v90, v6
    v_sub_f32 v91, v91, v6
    v_sub_f32 v92, v92, v6
    v_sub_f32 v93, v93, v6
    v_sub_f32 v94, v94, v6
    v_sub_f32 v95, v95, v6
    v_sub_f32 v96, v96, v6
    v_sub_f32 v97, v97, v6
    v_sub_f32 v98, v98, v6
    v_sub_f32 v99, v99, v6
    v_sub_f32 v100, v100, v6
    v_sub_f32 v101, v101, v6
    v_sub_f32 v102, v102, v6
    v_sub_f32 v103, v103, v6
    v_sub_f32 v104, v104, v6
    v_sub_f32 v105, v105, v6
    v_sub_f32 v106, v106, v6
    v_sub_f32 v107, v107, v6
    v_sub_f32 v108, v108, v6
    v_sub_f32 v109, v109, v6
    v_sub_f32 v110, v110, v6
    v_sub_f32 v111, v111, v6
    v_sub_f32 v112, v112, v6
    v_sub_f32 v113, v113, v6
    v_sub_f32 v114, v114, v6
    v_sub_f32 v115, v115, v6
    v_sub_f32 v116, v116, v6
    v_sub_f32 v117, v117, v6
    v_sub_f32 v118, v118, v6
    v_sub_f32 v119, v119, v6
    v_sub_f32 v120, v120, v6
    v_sub_f32 v121, v121, v6
    v_sub_f32 v122, v122, v6
    v_sub_f32 v123, v123, v6
    v_sub_f32 v124, v124, v6
    v_sub_f32 v125, v125, v6
    v_sub_f32 v126, v126, v6
    v_sub_f32 v127, v127, v6
    v_sub_f32 v128, v128, v6
    v_sub_f32 v129, v129, v6
    v_sub_f32 v130, v130, v6
    v_sub_f32 v131, v131, v6
    v_sub_f32 v132, v132, v6
    v_sub_f32 v133, v133, v6
    v_sub_f32 v134, v134, v6
    v_sub_f32 v135, v135, v6
    v_sub_f32 v136, v136, v6
    v_sub_f32 v137, v137, v6
    v_sub_f32 v138, v138, v6
    v_sub_f32 v139, v139, v6
    v_sub_f32 v140, v140, v6
    v_sub_f32 v141, v141, v6
    v_sub_f32 v142, v142, v6
    v_sub_f32 v143, v143, v6
    v_sub_f32 v144, v144, v6
    v_sub_f32 v145, v145, v6
    v_pk_mul_f32 v[8:9], v[66:67], v[66:67]
    v_pk_fma_f32 v[8:9], v[68:69], v[68:69], v[8:9]
    v_pk_fma_f32 v[8:9], v[70:71], v[70:71], v[8:9]
    v_pk_fma_f32 v[8:9], v[72:73], v[72:73], v[8:9]
    v_pk_fma_f32 v[8:9], v[74:75], v[74:75], v[8:9]
    v_pk_fma_f32 v[8:9], v[76:77], v[76:77], v[8:9]
    v_pk_fma_f32 v[8:9], v[78:79], v[78:79], v[8:9]
    v_pk_fma_f32 v[8:9], v[80:81], v[80:81], v[8:9]
    v_pk_fma_f32 v[8:9], v[82:83], v[82:83], v[8:9]
    v_pk_fma_f32 v[8:9], v[84:85], v[84:85], v[8:9]
    v_pk_fma_f32 v[8:9], v[86:87], v[86:87], v[8:9]
    v_pk_fma_f32 v[8:9], v[88:89], v[88:89], v[8:9]
    v_pk_fma_f32 v[8:9], v[90:91], v[90:91], v[8:9]
    v_pk_fma_f32 v[8:9], v[92:93], v[92:93], v[8:9]
    v_pk_fma_f32 v[8:9], v[94:95], v[94:95], v[8:9]
    v_pk_fma_f32 v[8:9], v[96:97], v[96:97], v[8:9]
    v_pk_fma_f32 v[8:9], v[98:99], v[98:99], v[8:9]
    v_pk_fma_f32 v[8:9], v[100:101], v[100:101], v[8:9]
    v_pk_fma_f32 v[8:9], v[102:103], v[102:103], v[8:9]
    v_pk_fma_f32 v[8:9], v[104:105], v[104:105], v[8:9]
    v_pk_fma_f32 v[8:9], v[106:107], v[106:107], v[8:9]
    v_pk_fma_f32 v[8:9], v[108:109], v[108:109], v[8:9]
    v_pk_fma_f32 v[8:9], v[110:111], v[110:111], v[8:9]
    v_pk_fma_f32 v[8:9], v[112:113], v[112:113], v[8:9]
    v_pk_fma_f32 v[8:9], v[114:115], v[114:115], v[8:9]
    v_pk_fma_f32 v[8:9], v[116:117], v[116:117], v[8:9]
    v_pk_fma_f32 v[8:9], v[118:119], v[118:119], v[8:9]
    v_pk_fma_f32 v[8:9], v[120:121], v[120:121], v[8:9]
    v_pk_fma_f32 v[8:9], v[122:123], v[122:123], v[8:9]
    v_pk_fma_f32 v[8:9], v[124:125], v[124:125], v[8:9]
    v_pk_fma_f32 v[8:9], v[126:127], v[126:127], v[8:9]
    v_pk_fma_f32 v[8:9], v[128:129], v[128:129], v[8:9]
    v_pk_fma_f32 v[8:9], v[130:131], v[130:131], v[8:9]
    v_pk_fma_f32 v[8:9], v[132:133], v[132:133], v[8:9]
    v_pk_fma_f32 v[8:9], v[134:135], v[134:135], v[8:9]
    v_pk_fma_f32 v[8:9], v[136:137], v[136:137], v[8:9]
    v_pk_fma_f32 v[8:9], v[138:139], v[138:139], v[8:9]
    v_pk_fma_f32 v[8:9], v[140:141], v[140:141], v[8:9]
    v_pk_fma_f32 v[8:9], v[142:143], v[142:143], v[8:9]
    v_pk_fma_f32 v[8:9], v[144:145], v[144:145], v[8:9]
    v_add_f32 v6, v8, v9
    s_nop 1
    v_add_f32_dpp v6, v6, v6 row_ror:8 row_mask:0xf bank_mask:0xf
    v_mov_b32 v7, v6
    s_nop 1
    v_permlane16_swap_b32 v7, v6
    v_add_f32 v6, v6, v7
    v_mov_b32 v7, v6
    s_nop 1
    v_permlane32_swap_b32 v7, v6
    v_add_f32 v6, v6, v7
    v_mov_b32 v7, 0x3727c5ac
    v_fmac_f32 v7, 0x3acccccd, v6
    v_rsq_f32 v6, v7
    s_nop 0
    v_mul_f32 v66, v66, v6
    v_mul_f32 v67, v67, v6
    v_mul_f32 v68, v68, v6
    v_mul_f32 v69, v69, v6
    v_mul_f32 v70, v70, v6
    v_mul_f32 v71, v71, v6
    v_mul_f32 v72, v72, v6
    v_mul_f32 v73, v73, v6
    v_cvt_pk_bf16_f32 v66, v66, v67
    v_cvt_pk_bf16_f32 v67, v68, v69
    v_cvt_pk_bf16_f32 v68, v70, v71
    v_cvt_pk_bf16_f32 v69, v72, v73
    s_add_u32 s30, s62, 0
    buffer_store_dwordx4 v[66:69], v12, s[4:7], s30 offen sc1
    v_mul_f32 v74, v74, v6
    v_mul_f32 v75, v75, v6
    v_mul_f32 v76, v76, v6
    v_mul_f32 v77, v77, v6
    v_mul_f32 v78, v78, v6
    v_mul_f32 v79, v79, v6
    v_mul_f32 v80, v80, v6
    v_mul_f32 v81, v81, v6
    v_cvt_pk_bf16_f32 v74, v74, v75
    v_cvt_pk_bf16_f32 v75, v76, v77
    v_cvt_pk_bf16_f32 v76, v78, v79
    v_cvt_pk_bf16_f32 v77, v80, v81
    s_add_u32 s30, s62, 4096
    buffer_store_dwordx4 v[74:77], v12, s[4:7], s30 offen sc1
    v_mul_f32 v82, v82, v6
    v_mul_f32 v83, v83, v6
    v_mul_f32 v84, v84, v6
    v_mul_f32 v85, v85, v6
    v_mul_f32 v86, v86, v6
    v_mul_f32 v87, v87, v6
    v_mul_f32 v88, v88, v6
    v_mul_f32 v89, v89, v6
    v_cvt_pk_bf16_f32 v82, v82, v83
    v_cvt_pk_bf16_f32 v83, v84, v85
    v_cvt_pk_bf16_f32 v84, v86, v87
    v_cvt_pk_bf16_f32 v85, v88, v89
    s_add_u32 s30, s62, 8192
    buffer_store_dwordx4 v[82:85], v12, s[4:7], s30 offen sc1
    v_mul_f32 v90, v90, v6
    v_mul_f32 v91, v91, v6
    v_mul_f32 v92, v92, v6
    v_mul_f32 v93, v93, v6
    v_mul_f32 v94, v94, v6
    v_mul_f32 v95, v95, v6
    v_mul_f32 v96, v96, v6
    v_mul_f32 v97, v97, v6
    v_cvt_pk_bf16_f32 v90, v90, v91
    v_cvt_pk_bf16_f32 v91, v92, v93
    v_cvt_pk_bf16_f32 v92, v94, v95
    v_cvt_pk_bf16_f32 v93, v96, v97
    s_add_u32 s30, s62, 12288
    buffer_store_dwordx4 v[90:93], v12, s[4:7], s30 offen sc1
    v_mul_f32 v98, v98, v6
    v_mul_f32 v99, v99, v6
    v_mul_f32 v100, v100, v6
    v_mul_f32 v101, v101, v6
    v_mul_f32 v102, v102, v6
    v_mul_f32 v103, v103, v6
    v_mul_f32 v104, v104, v6
    v_mul_f32 v105, v105, v6
    v_cvt_pk_bf16_f32 v98, v98, v99
    v_cvt_pk_bf16_f32 v99, v100, v101
    v_cvt_pk_bf16_f32 v100, v102, v103
    v_cvt_pk_bf16_f32 v101, v104, v105
    s_add_u32 s30, s62, 16384
    buffer_store_dwordx4 v[98:101], v12, s[4:7], s30 offen sc1
    v_mul_f32 v106, v106, v6
    v_mul_f32 v107, v107, v6
    v_mul_f32 v108, v108, v6
    v_mul_f32 v109, v109, v6
    v_mul_f32 v110, v110, v6
    v_mul_f32 v111, v111, v6
    v_mul_f32 v112, v112, v6
    v_mul_f32 v113, v113, v6
    v_cvt_pk_bf16_f32 v106, v106, v107
    v_cvt_pk_bf16_f32 v107, v108, v109
    v_cvt_pk_bf16_f32 v108, v110, v111
    v_cvt_pk_bf16_f32 v109, v112, v113
    s_add_u32 s30, s62, 20480
    buffer_store_dwordx4 v[106:109], v12, s[4:7], s30 offen sc1
    v_mul_f32 v114, v114, v6
    v_mul_f32 v115, v115, v6
    v_mul_f32 v116, v116, v6
    v_mul_f32 v117, v117, v6
    v_mul_f32 v118, v118, v6
    v_mul_f32 v119, v119, v6
    v_mul_f32 v120, v120, v6
    v_mul_f32 v121, v121, v6
    v_cvt_pk_bf16_f32 v114, v114, v115
    v_cvt_pk_bf16_f32 v115, v116, v117
    v_cvt_pk_bf16_f32 v116, v118, v119
    v_cvt_pk_bf16_f32 v117, v120, v121
    s_add_u32 s30, s62, 24576
    buffer_store_dwordx4 v[114:117], v12, s[4:7], s30 offen sc1
    v_mul_f32 v122, v122, v6
    v_mul_f32 v123, v123, v6
    v_mul_f32 v124, v124, v6
    v_mul_f32 v125, v125, v6
    v_mul_f32 v126, v126, v6
    v_mul_f32 v127, v127, v6
    v_mul_f32 v128, v128, v6
    v_mul_f32 v129, v129, v6
    v_cvt_pk_bf16_f32 v122, v122, v123
    v_cvt_pk_bf16_f32 v123, v124, v125
    v_cvt_pk_bf16_f32 v124, v126, v127
    v_cvt_pk_bf16_f32 v125, v128, v129
    s_add_u32 s30, s62, 28672
    buffer_store_dwordx4 v[122:125], v12, s[4:7], s30 offen sc1
    v_mul_f32 v130, v130, v6
    v_mul_f32 v131, v131, v6
    v_mul_f32 v132, v132, v6
    v_mul_f32 v133, v133, v6
    v_mul_f32 v134, v134, v6
    v_mul_f32 v135, v135, v6
    v_mul_f32 v136, v136, v6
    v_mul_f32 v137, v137, v6
    v_cvt_pk_bf16_f32 v130, v130, v131
    v_cvt_pk_bf16_f32 v131, v132, v133
    v_cvt_pk_bf16_f32 v132, v134, v135
    v_cvt_pk_bf16_f32 v133, v136, v137
    s_add_u32 s30, s62, 32768
    buffer_store_dwordx4 v[130:133], v12, s[4:7], s30 offen sc1
    v_mul_f32 v138, v138, v6
    v_mul_f32 v139, v139, v6
    v_mul_f32 v140, v140, v6
    v_mul_f32 v141, v141, v6
    v_mul_f32 v142, v142, v6
    v_mul_f32 v143, v143, v6
    v_mul_f32 v144, v144, v6
    v_mul_f32 v145, v145, v6
    v_cvt_pk_bf16_f32 v138, v138, v139
    v_cvt_pk_bf16_f32 v139, v140, v141
    v_cvt_pk_bf16_f32 v140, v142, v143
    v_cvt_pk_bf16_f32 v141, v144, v145
    s_add_u32 s30, s62, 36864
    buffer_store_dwordx4 v[138:141], v12, s[4:7], s30 offen sc1
    s_add_u32 s54, s54, 1
    v_mov_b32 v16, s54
    s_cmp_lg_u32 s54, 1
    s_cbranch_scc1 L_cdone_6
    s_cmp_eq_u32 s33, 1
    s_cbranch_scc1 L_cs_7
    v_mbcnt_lo_u32_b32 v7, -1, 0
    v_bfe_u32 v8, v7, 2, 1
    v_and_b32 v7, 3, v7
    v_lshlrev_b32 v7, 6, v7
    v_lshl_add_u32 v7, v8, 2, v7
L_cen_8:
    global_load_dword v8, v7, s[20:21] sc1
    s_sub_u32 s27, s27, 1
    s_cbranch_scc0 L_ok_10
    s_mov_b32 s28, 10
    s_branch L_bail
L_ok_10:
    s_waitcnt vmcnt(0)
L_cenc_9:
    s_mov_b32 s29, 0
    v_readlane_b32 s30, v8, 0
    s_nop 0
    s_add_u32 s29, s29, s30
    v_readlane_b32 s30, v8, 1
    s_nop 0
    s_add_u32 s29, s29, s30
    v_readlane_b32 s30, v8, 2
    s_nop 0
    s_add_u32 s29, s29, s30
    v_readlane_b32 s30, v8, 3
    s_nop 0
    s_add_u32 s29, s29, s30
    v_readlane_b32 s30, v8, 4
    s_nop 0
    s_add_u32 s29, s29, s30
    v_readlane_b32 s30, v8, 5
    s_nop 0
    s_add_u32 s29, s29, s30
    v_readlane_b32 s30, v8, 6
    s_nop 0
    s_add_u32 s29, s29, s30
    v_readlane_b32 s30, v8, 7
    s_nop 0
    s_add_u32 s29, s29, s30
    s_cmp_lt_u32 s29, 256
    s_cbranch_scc1 L_cen_8
    v_cmp_ne_u32 vcc, 32, v8
    s_cbranch_vccnz L_fallback
L_cs_7:
L_cdone_6:
    s_waitcnt vmcnt(0)
    s_barrier
    buffer_store_dword v16, v10, s[4:7], 0 offen sc1
    s_cmp_lt_u32 s52, 64
    s_cbranch_scc1 L_ln_5
    v_bfe_u32 v2, v1, 0, 3
    v_mul_u32_u24 v11, 1280, v2
    v_bfe_u32 v2, v1, 3, 3
    v_mul_u32_u24 v2, 16, v2
    v_add_u32 v11, v11, v2
    v_bfe_u32 v2, v1, 5, 1
    v_mul_u32_u24 v12, 2048, v2
    v_bfe_u32 v2, v1, 4, 1
    v_mul_u32_u24 v2, 1024, v2
    v_add_u32 v12, v12, v2
    v_bfe_u32 v2, v1, 3, 1
    v_mul_u32_u24 v2, 512, v2
    v_add_u32 v12, v12, v2
    v_bfe_u32 v2, v1, 0, 3
    v_mul_u32_u24 v2, 16, v2
    v_add_u32 v12, v12, v2
    v_lshrrev_b32 v13, 4, v1
    v_min_u32 v13, 2, v13
    v_mul_u32_u24 v13, 640, v13
    v_add_u32 v13, 71334912, v13
    v_bfe_u32 v2, v1, 3, 3
    v_mul_u32_u24 v14, 640, v2
    v_add_u32 v14, 71329792, v14
L_fin_11:
    s_mul_i32 s52, s55, 52429
    s_lshr_b32 s52, s52, 21
    s_mul_i32 s29, s52, 40
    s_sub_u32 s29, s55, s29
    s_mul_i32 s57, s29, 26
    s_lshr_b32 s57, s57, 8
    s_mul_i32 s30, s57, 10
    s_sub_u32 s56, s29, s30
    s_lshr_b32 s58, s56, 1
    s_add_u32 s59, s52, 1
    s_mul_i32 s62, s52, 40960
    s_mul_i32 s29, s57, 10240
    s_add_u32 s62, s62, s29
    s_lshl_b32 s29, s56, 7
    s_add_u32 s62, s62, s29
    s_lshl_b32 s29, s58, 13
    s_and_b32 s30, s56, 1
    s_lshl_b32 s30, s30, 12
    s_add_u32 s29, s29, s30
    s_lshl_b32 s30, s57, 7
    s_add_u32 s29, s29, s30
    s_mul_i32 s60, s52, 327680
    s_add_u32 s60, s60, 109051904
    s_add_u32 s60, s60, s29
    s_mul_i32 s61, s52, 122880
    s_add_u32 s61, s61, 134217728
    s_add_u32 s61, s61, s29
    s_lshl_b32 s58, s58, 7
    buffer_load_dwordx4 v[18:21], v11, s[44:47], s62 offen
L_fl_12:
    buffer_load_dword v15, v13, s[4:7], s58 offen sc1
    s_sub_u32 s27, s27, 1
    s_cbranch_scc0 L_ok_13
    s_mov_b32 s28, 28
    s_branch L_bail
L_ok_13:
    s_waitcnt vmcnt(0)
    v_cmp_gt_u32 vcc, s59, v15
    s_cbranch_vccnz L_fl_12
    s_add_u32 s30, s61, 0
    buffer_load_dwordx4 v[22:25], v12, s[4:7], s30 offen sc1
    s_add_u32 s30, s61, 40960
    buffer_load_dwordx4 v[26:29], v12, s[4:7], s30 offen sc1
    s_add_u32 s30, s61, 81920
    buffer_load_dwordx4 v[30:33], v12, s[4:7], s30 offen sc1
L_fl_14:
    buffer_load_dword v15, v14, s[4:7], s58 offen sc1
    s_sub_u32 s27, s27, 1
    s_cbranch_scc0 L_ok_15
    s_mov_b32 s28, 29
    s_branch L_bail
L_ok_15:
    s_waitcnt vmcnt(0)
    v_cmp_gt_u32 vcc, s59, v15
    s_cbranch_vccnz L_fl_14
    s_add_u32 s30, s60, 0
    buffer_load_dwordx4 v[34:37], v12, s[4:7], s30 offen sc1
    s_add_u32 s30, s60, 40960
    buffer_load_dwordx4 v[38:41], v12, s[4:7], s30 offen sc1
    s_add_u32 s30, s60, 81920
    buffer_load_dwordx4 v[42:45], v12, s[4:7], s30 offen sc1
    s_add_u32 s30, s60, 122880
    buffer_load_dwordx4 v[46:49], v12, s[4:7], s30 offen sc1
    s_add_u32 s30, s60, 163840
    buffer_load_dwordx4 v[50:53], v12, s[4:7], s30 offen sc1
    s_add_u32 s30, s60, 204800
    buffer_load_dwordx4 v[54:57], v12, s[4:7], s30 offen sc1
    s_add_u32 s30, s60, 245760
    buffer_load_dwordx4 v[58:61], v12, s[4:7], s30 offen sc1
    s_add_u32 s30, s60, 286720
    buffer_load_dwordx4 v[62:65], v12, s[4:7], s30 offen sc1
    v_lshlrev_b32 v66, 16, v18
    v_and_b32 v67, 0xffff0000, v18
    v_lshlrev_b32 v68, 16, v19
    v_and_b32 v69, 0xffff0000, v19
    v_lshlrev_b32 v70, 16, v20
    v_and_b32 v71, 0xffff0000, v20
    v_lshlrev_b32 v72, 16, v21
    v_and_b32 v73, 0xffff0000, v21
    v_lshlrev_b32 v74, 16, v22
    v_and_b32 v75, 0xffff0000, v22
    v_pk_add_f32 v[66:67], v[66:67], v[74:75]
    v_lshlrev_b32 v74, 16, v23
    v_and_b32 v75, 0xffff0000, v23
    v_pk_add_f32 v[68:69], v[68:69], v[74:75]
    v_lshlrev_b32 v74, 16, v24
    v_and_b32 v75, 0xffff0000, v24
    v_pk_add_f32 v[70:71], v[70:71], v[74:75]
    v_lshlrev_b32 v74, 16, v25
    v_and_b32 v75, 0xffff0000, v25
    v_pk_add_f32 v[72:73], v[72:73], v[74:75]
    v_lshlrev_b32 v74, 16, v26
    v_and_b32 v75, 0xffff0000, v26
    v_pk_add_f32 v[66:67], v[66:67], v[74:75]
    v_lshlrev_b32 v74, 16, v27
    v_and_b32 v75, 0xffff0000, v27
    v_pk_add_f32 v[68:69], v[68:69], v[74:75]
    v_lshlrev_b32 v74, 16, v28
    v_and_b32 v75, 0xffff0000, v28
    v_pk_add_f32 v[70:71], v[70:71], v[74:75]
    v_lshlrev_b32 v74, 16, v29
    v_and_b32 v75, 0xffff0000, v29
    v_pk_add_f32 v[72:73], v[72:73], v[74:75]
    v_lshlrev_b32 v74, 16, v30
    v_and_b32 v75, 0xffff0000, v30
    v_pk_add_f32 v[66:67], v[66:67], v[74:75]
    v_lshlrev_b32 v74, 16, v31
    v_and_b32 v75, 0xffff0000, v31
    v_pk_add_f32 v[68:69], v[68:69], v[74:75]
    v_lshlrev_b32 v74, 16, v32
    v_and_b32 v75, 0xffff0000, v32
    v_pk_add_f32 v[70:71], v[70:71], v[74:75]
    v_lshlrev_b32 v74, 16, v33
    v_and_b32 v75, 0xffff0000, v33
    v_pk_add_f32 v[72:73], v[72:73], v[74:75]
    s_waitcnt vmcnt(7)
    v_lshlrev_b32 v74, 16, v34
    v_and_b32 v75, 0xffff0000, v34
    v_pk_add_f32 v[66:67], v[66:67], v[74:75]
    v_lshlrev_b32 v74, 16, v35
    v_and_b32 v75, 0xffff0000, v35
    v_pk_add_f32 v[68:69], v[68:69], v[74:75]
    v_lshlrev_b32 v74, 16, v36
    v_and_b32 v75, 0xffff0000, v36
    v_pk_add_f32 v[70:71], v[70:71], v[74:75]
    v_lshlrev_b32 v74, 16, v37
    v_and_b32 v75, 0xffff0000, v37
    v_pk_add_f32 v[72:73], v[72:73], v[74:75]
    s_waitcnt vmcnt(6)
    v_lshlrev_b32 v74, 16, v38
    v_and_b32 v75, 0xffff0000, v38
    v_pk_add_f32 v[66:67], v[66:67], v[74:75]
    v_lshlrev_b32 v74, 16, v39
    v_and_b32 v75, 0xffff0000, v39
    v_pk_add_f32 v[68:69], v[68:69], v[74:75]
    v_lshlrev_b32 v74, 16, v40
    v_and_b32 v75, 0xffff0000, v40
    v_pk_add_f32 v[70:71], v[70:71], v[74:75]
    v_lshlrev_b32 v74, 16, v41
    v_and_b32 v75, 0xffff0000, v41
    v_pk_add_f32 v[72:73], v[72:73], v[74:75]
    s_waitcnt vmcnt(5)
    v_lshlrev_b32 v74, 16, v42
    v_and_b32 v75, 0xffff0000, v42
    v_pk_add_f32 v[66:67], v[66:67], v[74:75]
    v_lshlrev_b32 v74, 16, v43
    v_and_b32 v75, 0xffff0000, v43
    v_pk_add_f32 v[68:69], v[68:69], v[74:75]
    v_lshlrev_b32 v74, 16, v44
    v_and_b32 v75, 0xffff0000, v44
    v_pk_add_f32 v[70:71], v[70:71], v[74:75]
    v_lshlrev_b32 v74, 16, v45
    v_and_b32 v75, 0xffff0000, v45
    v_pk_add_f32 v[72:73], v[72:73], v[74:75]
    s_waitcnt vmcnt(4)
    v_lshlrev_b32 v74, 16, v46
    v_and_b32 v75, 0xffff0000, v46
    v_pk_add_f32 v[66:67], v[66:67], v[74:75]
    v_lshlrev_b32 v74, 16, v47
    v_and_b32 v75, 0xffff0000, v47
    v_pk_add_f32 v[68:69], v[68:69], v[74:75]
    v_lshlrev_b32 v74, 16, v48
    v_and_b32 v75, 0xffff0000, v48
    v_pk_add_f32 v[70:71], v[70:71], v[74:75]
    v_lshlrev_b32 v74, 16, v49
    v_and_b32 v75, 0xffff0000, v49
    v_pk_add_f32 v[72:73], v[72:73], v[74:75]
    s_waitcnt vmcnt(3)
    v_lshlrev_b32 v74, 16, v50
    v_and_b32 v75, 0xffff0000, v50
    v_pk_add_f32 v[66:67], v[66:67], v[74:75]
    v_lshlrev_b32 v74, 16, v51
    v_and_b32 v75, 0xffff0000, v51
    v_pk_add_f32 v[68:69], v[68:69], v[74:75]
    v_lshlrev_b32 v74, 16, v52
    v_and_b32 v75, 0xffff0000, v52
    v_pk_add_f32 v[70:71], v[70:71], v[74:75]
    v_lshlrev_b32 v74, 16, v53
    v_and_b32 v75, 0xffff0000, v53
    v_pk_add_f32 v[72:73], v[72:73], v[74:75]
    s_waitcnt vmcnt(2)
    v_lshlrev_b32 v74, 16, v54
    v_and_b32 v75, 0xffff0000, v54
    v_pk_add_f32 v[66:67], v[66:67], v[74:75]
    v_lshlrev_b32 v74, 16, v55
    v_and_b32 v75, 0xffff0000, v55
    v_pk_add_f32 v[68:69], v[68:69], v[74:75]
    v_lshlrev_b32 v74, 16, v56
    v_and_b32 v75, 0xffff0000, v56
    v_pk_add_f32 v[70:71], v[70:71], v[74:75]
    v_lshlrev_b32 v74, 16, v57
    v_and_b32 v75, 0xffff0000, v57
    v_pk_add_f32 v[72:73], v[72:73], v[74:75]
    s_waitcnt vmcnt(1)
    v_lshlrev_b32 v74, 16, v58
    v_and_b32 v75, 0xffff0000, v58
    v_pk_add_f32 v[66:67], v[66:67], v[74:75]
    v_lshlrev_b32 v74, 16, v59
    v_and_b32 v75, 0xffff0000, v59
    v_pk_add_f32 v[68:69], v[68:69], v[74:75]
    v_lshlrev_b32 v74, 16, v60
    v_and_b32 v75, 0xffff0000, v60
    v_pk_add_f32 v[70:71], v[70:71], v[74:75]
    v_lshlrev_b32 v74, 16, v61
    v_and_b32 v75, 0xffff0000, v61
    v_pk_add_f32 v[72:73], v[72:73], v[74:75]
    s_waitcnt vmcnt(0)
    v_lshlrev_b32 v74, 16, v62
    v_and_b32 v75, 0xffff0000, v62
    v_pk_add_f32 v[66:67], v[66:67], v[74:75]
    v_lshlrev_b32 v74, 16, v63
    v_and_b32 v75, 0xffff0000, v63
    v_pk_add_f32 v[68:69], v[68:69], v[74:75]
    v_lshlrev_b32 v74, 16, v64
    v_and_b32 v75, 0xffff0000, v64
    v_pk_add_f32 v[70:71], v[70:71], v[74:75]
    v_lshlrev_b32 v74, 16, v65
    v_and_b32 v75, 0xffff0000, v65
    v_pk_add_f32 v[72:73], v[72:73], v[74:75]
    v_cvt_pk_bf16_f32 v78, v66, v67
    v_cvt_pk_bf16_f32 v79, v68, v69
    v_cvt_pk_bf16_f32 v80, v70, v71
    v_cvt_pk_bf16_f32 v81, v72, v73
    buffer_store_dwordx4 v[78:81], v11, s[48:51], s62 offen
    s_add_u32 s55, s55, 56
    s_cmp_lt_u32 s55, 2560
    s_cbranch_scc1 L_fin_11
    s_endpgm
L_KV:
    s_getpc_b64 s[28:29]
    v_lshlrev_b32 v1, 4, v0
    global_load_dwordx4 v[252:255], v1, s[28:29]
    v_add_u32 v1, 4096, v1
    global_load_dwordx4 v[252:255], v1, s[28:29]
    v_and_b32 v1, 63, v0
    v_mov_b32 v3, 0
    v_lshlrev_b32 v4, 4, v1
    s_cmp_lt_u32 s24, 32
    s_cselect_b32 s44, s10, s12
    s_cselect_b32 s45, s11, s13
    s_cselect_b32 s49, 0x3e0293ee, 1.0
    s_cselect_b32 s47, 0, 524288
    s_and_b32 s29, s24, 31
    s_lshl_b32 s46, s29, 8
    s_lshl_b32 s29, s29, 21
    s_add_u32 s47, s47, s29
    v_bfe_u32 v2, v1, 4, 1
    v_mul_u32_u24 v10, 4096, v2
    v_bfe_u32 v2, v1, 0, 4
    v_mul_u32_u24 v2, 16, v2
    v_add_u32 v10, v10, v2
    v_bfe_u32 v2, v1, 5, 1
    v_mul_u32_u24 v2, 256, v2
    v_add_u32 v10, v10, v2
    s_mul_i32 s28, s26, 1024
    v_add_u32 v10, s28, v10
    v_mov_b32 v11, 0
    s_mul_i32 s28, s24, 128
    v_add_u32 v11, s28, v11
    v_add_u32 v11, 71305216, v11
    v_mov_b32 v6, 1073741824
    v_cmp_eq_u32 vcc, 0, v0
    s_nop 1
    v_cndmask_b32 v11, v6, v11, vcc
    s_mov_b32 s48, 1073741824
    s_mul_i32 s58, s26, 10240
    s_mov_b32 s60, s44
    s_and_b32 s61, s45, 0xffff
    s_mov_b32 s62, 5242880
    s_mov_b32 s63, 0x20000
    v_bfe_u32 v2, v1, 4, 2
    v_mul_u32_u24 v7, 4, v2
    v_bfe_u32 v2, v1, 0, 4
    v_mul_u32_u24 v8, 1, v2
    v_xor_b32 v7, v7, v8
    v_bfe_u32 v2, v1, 4, 2
    v_mul_u32_u24 v79, 8192, v2
    s_mul_i32 s28, s26, 131072
    v_add_u32 v79, s28, v79
    v_lshl_add_u32 v79, v7, 4, v79
    v_bfe_u32 v2, v1, 2, 2
    v_mul_u32_u24 v7, 4, v2
    v_bfe_u32 v2, v1, 4, 1
    v_mul_u32_u24 v8, 2, v2
    v_bfe_u32 v2, v1, 1, 1
    v_mul_u32_u24 v2, 1, v2
    v_add_u32 v8, v8, v2
    s_mul_i32 s28, s26, 4
    v_add_u32 v8, s28, v8
    v_xor_b32 v7, v7, v8
    v_bfe_u32 v2, v1, 2, 2
    v_mul_u32_u24 v80, 256, v2
    v_bfe_u32 v2, v1, 5, 1
    v_mul_u32_u24 v2, 2048, v2
    v_add_u32 v80, v80, v2
    v_bfe_u32 v2, v1, 0, 1
    v_mul_u32_u24 v2, 8, v2
    v_add_u32 v80, v80, v2
    v_lshl_add_u32 v80, v7, 4, v80
    s_lshl_b32 s64, s26, 12
    s_add_u32 s29, s46, 0
    s_add_u32 m0, s64, 0
    s_nop 0
    buffer_load_dwordx4 v79, s[60:63], s29 offen nt lds
    s_add_u32 s29, s46, 32768
    s_add_u32 m0, s64, 1024
    s_nop 0
    buffer_load_dwordx4 v79, s[60:63], s29 offen nt lds
    s_add_u32 s29, s46, 65536
    s_add_u32 m0, s64, 2048
    s_nop 0
    buffer_load_dwordx4 v79, s[60:63], s29 offen nt lds
    s_add_u32 s29, s46, 98304
    s_add_u32 m0, s64, 3072
    s_nop 0
    buffer_load_dwordx4 v79, s[60:63], s29 offen nt lds
    s_add_u32 s29, s46, 524288
    s_add_u32 m0, s64, 16384
    s_nop 0
    buffer_load_dwordx4 v79, s[60:63], s29 offen nt lds
    s_add_u32 s29, s46, 557056
    s_add_u32 m0, s64, 17408
    s_nop 0
    buffer_load_dwordx4 v79, s[60:63], s29 offen nt lds
    s_add_u32 s29, s46, 589824
    s_add_u32 m0, s64, 18432
    s_nop 0
    buffer_load_dwordx4 v79, s[60:63], s29 offen nt lds
    s_add_u32 s29, s46, 622592
    s_add_u32 m0, s64, 19456
    s_nop 0
    buffer_load_dwordx4 v79, s[60:63], s29 offen nt lds
    s_add_u32 s29, s46, 1048576
    s_add_u32 m0, s64, 32768
    s_nop 0
    buffer_load_dwordx4 v79, s[60:63], s29 offen nt lds
    s_add_u32 s29, s46, 1081344
    s_add_u32 m0, s64, 33792
    s_nop 0
    buffer_load_dwordx4 v79, s[60:63], s29 offen nt lds
    s_add_u32 s29, s46, 1114112
    s_add_u32 m0, s64, 34816
    s_nop 0
    buffer_load_dwordx4 v79, s[60:63], s29 offen nt lds
    s_add_u32 s29, s46, 1146880
    s_add_u32 m0, s64, 35840
    s_nop 0
    buffer_load_dwordx4 v79, s[60:63], s29 offen nt lds
    s_add_u32 s29, s46, 1572864
    s_add_u32 m0, s64, 49152
    s_nop 0
    buffer_load_dwordx4 v79, s[60:63], s29 offen nt lds
    s_add_u32 s29, s46, 1605632
    s_add_u32 m0, s64, 50176
    s_nop 0
    buffer_load_dwordx4 v79, s[60:63], s29 offen nt lds
    s_add_u32 s29, s46, 1638400
    s_add_u32 m0, s64, 51200
    s_nop 0
    buffer_load_dwordx4 v79, s[60:63], s29 offen nt lds
    s_add_u32 s29, s46, 1671168
    s_add_u32 m0, s64, 52224
    s_nop 0
    buffer_load_dwordx4 v79, s[60:63], s29 offen nt lds
    s_add_u32 s29, s46, 2097152
    s_add_u32 m0, s64, 65536
    s_nop 0
    buffer_load_dwordx4 v79, s[60:63], s29 offen nt lds
    s_add_u32 s29, s46, 2129920
    s_add_u32 m0, s64, 66560
    s_nop 0
    buffer_load_dwordx4 v79, s[60:63], s29 offen nt lds
    s_add_u32 s29, s46, 2162688
    s_add_u32 m0, s64, 67584
    s_nop 0
    buffer_load_dwordx4 v79, s[60:63], s29 offen nt lds
    s_add_u32 s29, s46, 2195456
    s_add_u32 m0, s64, 68608
    s_nop 0
    buffer_load_dwordx4 v79, s[60:63], s29 offen nt lds
    s_add_u32 s29, s46, 2621440
    s_add_u32 m0, s64, 81920
    s_nop 0
    buffer_load_dwordx4 v79, s[60:63], s29 offen nt lds
    s_add_u32 s29, s46, 2654208
    s_add_u32 m0, s64, 82944
    s_nop 0
    buffer_load_dwordx4 v79, s[60:63], s29 offen nt lds
    s_add_u32 s29, s46, 2686976
    s_add_u32 m0, s64, 83968
    s_nop 0
    buffer_load_dwordx4 v79, s[60:63], s29 offen nt lds
    s_add_u32 s29, s46, 2719744
    s_add_u32 m0, s64, 84992
    s_nop 0
    buffer_load_dwordx4 v79, s[60:63], s29 offen nt lds
    s_add_u32 s29, s46, 3145728
    s_add_u32 m0, s64, 98304
    s_nop 0
    buffer_load_dwordx4 v79, s[60:63], s29 offen nt lds
    s_add_u32 s29, s46, 3178496
    s_add_u32 m0, s64, 99328
    s_nop 0
    buffer_load_dwordx4 v79, s[60:63], s29 offen nt lds
    s_add_u32 s29, s46, 3211264
    s_add_u32 m0, s64, 100352
    s_nop 0
    buffer_load_dwordx4 v79, s[60:63], s29 offen nt lds
    s_add_u32 s29, s46, 3244032
    s_add_u32 m0, s64, 101376
    s_nop 0
    buffer_load_dwordx4 v79, s[60:63], s29 offen nt lds
    s_add_u32 s29, s46, 3670016
    s_add_u32 m0, s64, 114688
    s_nop 0
    buffer_load_dwordx4 v79, s[60:63], s29 offen nt lds
    s_add_u32 s29, s46, 3702784
    s_add_u32 m0, s64, 115712
    s_nop 0
    buffer_load_dwordx4 v79, s[60:63], s29 offen nt lds
    s_add_u32 s29, s46, 3735552
    s_add_u32 m0, s64, 116736
    s_nop 0
    buffer_load_dwordx4 v79, s[60:63], s29 offen nt lds
    s_add_u32 s29, s46, 3768320
    s_add_u32 m0, s64, 117760
    s_nop 0
    buffer_load_dwordx4 v79, s[60:63], s29 offen nt lds
    s_add_u32 s29, s46, 4194304
    s_add_u32 m0, s64, 131072
    s_nop 0
    buffer_load_dwordx4 v79, s[60:63], s29 offen nt lds
    s_add_u32 s29, s46, 4227072
    s_add_u32 m0, s64, 132096
    s_nop 0
    buffer_load_dwordx4 v79, s[60:63], s29 offen nt lds
    s_add_u32 s29, s46, 4259840
    s_add_u32 m0, s64, 133120
    s_nop 0
    buffer_load_dwordx4 v79, s[60:63], s29 offen nt lds
    s_add_u32 s29, s46, 4292608
    s_add_u32 m0, s64, 134144
    s_nop 0
    buffer_load_dwordx4 v79, s[60:63], s29 offen nt lds
    s_add_u32 s29, s46, 4718592
    s_add_u32 m0, s64, 147456
    s_nop 0
    buffer_load_dwordx4 v79, s[60:63], s29 offen nt lds
    s_add_u32 s29, s46, 4751360
    s_add_u32 m0, s64, 148480
    s_nop 0
    buffer_load_dwordx4 v79, s[60:63], s29 offen nt lds
    s_add_u32 s29, s46, 4784128
    s_add_u32 m0, s64, 149504
    s_nop 0
    buffer_load_dwordx4 v79, s[60:63], s29 offen nt lds
    s_add_u32 s29, s46, 4816896
    s_add_u32 m0, s64, 150528
    s_nop 0
    buffer_load_dwordx4 v79, s[60:63], s29 offen nt lds
    s_waitcnt vmcnt(36)
    s_barrier
    v_add_u32 v6, 0, v80
    ds_read_b64_tr_b16 a[0:1], v6 offset:0
    ds_read_b64_tr_b16 a[2:3], v6 offset:1024
    ds_read_b64_tr_b16 a[4:5], v6 offset:4096
    ds_read_b64_tr_b16 a[6:7], v6 offset:5120
    ds_read_b64_tr_b16 a[8:9], v6 offset:8192
    ds_read_b64_tr_b16 a[10:11], v6 offset:9216
    ds_read_b64_tr_b16 a[12:13], v6 offset:12288
    ds_read_b64_tr_b16 a[14:15], v6 offset:13312
    s_waitcnt lgkmcnt(0)
    s_waitcnt vmcnt(32)
    s_barrier
    v_add_u32 v6, 16384, v80
    ds_read_b64_tr_b16 a[16:17], v6 offset:0
    ds_read_b64_tr_b16 a[18:19], v6 offset:1024
    ds_read_b64_tr_b16 a[20:21], v6 offset:4096
    ds_read_b64_tr_b16 a[22:23], v6 offset:5120
    ds_read_b64_tr_b16 a[24:25], v6 offset:8192
    ds_read_b64_tr_b16 a[26:27], v6 offset:9216
    ds_read_b64_tr_b16 a[28:29], v6 offset:12288
    ds_read_b64_tr_b16 a[30:31], v6 offset:13312
    s_waitcnt lgkmcnt(0)
    s_waitcnt vmcnt(28)
    s_barrier
    v_add_u32 v6, 32768, v80
    ds_read_b64_tr_b16 a[32:33], v6 offset:0
    ds_read_b64_tr_b16 a[34:35], v6 offset:1024
    ds_read_b64_tr_b16 a[36:37], v6 offset:4096
    ds_read_b64_tr_b16 a[38:39], v6 offset:5120
    ds_read_b64_tr_b16 a[40:41], v6 offset:8192
    ds_read_b64_tr_b16 a[42:43], v6 offset:9216
    ds_read_b64_tr_b16 a[44:45], v6 offset:12288
    ds_read_b64_tr_b16 a[46:47], v6 offset:13312
    s_waitcnt lgkmcnt(0)
    s_waitcnt vmcnt(24)
    s_barrier
    v_add_u32 v6, 49152, v80
    ds_read_b64_tr_b16 a[48:49], v6 offset:0
    ds_read_b64_tr_b16 a[50:51], v6 offset:1024
    ds_read_b64_tr_b16 a[52:53], v6 offset:4096
    ds_read_b64_tr_b16 a[54:55], v6 offset:5120
    ds_read_b64_tr_b16 a[56:57], v6 offset:8192
    ds_read_b64_tr_b16 a[58:59], v6 offset:9216
    ds_read_b64_tr_b16 a[60:61], v6 offset:12288
    ds_read_b64_tr_b16 a[62:63], v6 offset:13312
    s_waitcnt lgkmcnt(0)
    s_waitcnt vmcnt(20)
    s_barrier
    v_add_u32 v6, 65536, v80
    ds_read_b64_tr_b16 a[64:65], v6 offset:0
    ds_read_b64_tr_b16 a[66:67], v6 offset:1024
    ds_read_b64_tr_b16 a[68:69], v6 offset:4096
    ds_read_b64_tr_b16 a[70:71], v6 offset:5120
    ds_read_b64_tr_b16 a[72:73], v6 offset:8192
    ds_read_b64_tr_b16 a[74:75], v6 offset:9216
    ds_read_b64_tr_b16 a[76:77], v6 offset:12288
    ds_read_b64_tr_b16 a[78:79], v6 offset:13312
    s_waitcnt lgkmcnt(0)
    s_waitcnt vmcnt(16)
    s_barrier
    v_add_u32 v6, 81920, v80
    ds_read_b64_tr_b16 a[80:81], v6 offset:0
    ds_read_b64_tr_b16 a[82:83], v6 offset:1024
    ds_read_b64_tr_b16 a[84:85], v6 offset:4096
    ds_read_b64_tr_b16 a[86:87], v6 offset:5120
    ds_read_b64_tr_b16 a[88:89], v6 offset:8192
    ds_read_b64_tr_b16 a[90:91], v6 offset:9216
    ds_read_b64_tr_b16 a[92:93], v6 offset:12288
    ds_read_b64_tr_b16 a[94:95], v6 offset:13312
    s_waitcnt lgkmcnt(0)
    s_waitcnt vmcnt(12)
    s_barrier
    v_add_u32 v6, 98304, v80
    ds_read_b64_tr_b16 a[96:97], v6 offset:0
    ds_read_b64_tr_b16 a[98:99], v6 offset:1024
    ds_read_b64_tr_b16 a[100:101], v6 offset:4096
    ds_read_b64_tr_b16 a[102:103], v6 offset:5120
    ds_read_b64_tr_b16 a[104:105], v6 offset:8192
    ds_read_b64_tr_b16 a[106:107], v6 offset:9216
    ds_read_b64_tr_b16 a[108:109], v6 offset:12288
    ds_read_b64_tr_b16 a[110:111], v6 offset:13312
    s_waitcnt lgkmcnt(0)
    s_waitcnt vmcnt(8)
    s_barrier
    v_add_u32 v6, 114688, v80
    ds_read_b64_tr_b16 a[112:113], v6 offset:0
    ds_read_b64_tr_b16 a[114:115], v6 offset:1024
    ds_read_b64_tr_b16 a[116:117], v6 offset:4096
    ds_read_b64_tr_b16 a[118:119], v6 offset:5120
    ds_read_b64_tr_b16 a[120:121], v6 offset:8192
    ds_read_b64_tr_b16 a[122:123], v6 offset:9216
    ds_read_b64_tr_b16 a[124:125], v6 offset:12288
    ds_read_b64_tr_b16 a[126:127], v6 offset:13312
    s_waitcnt lgkmcnt(0)
    s_waitcnt vmcnt(4)
    s_barrier
    v_add_u32 v6, 131072, v80
    ds_read_b64_tr_b16 a[128:129], v6 offset:0
    ds_read_b64_tr_b16 a[130:131], v6 offset:1024
    ds_read_b64_tr_b16 a[132:133], v6 offset:4096
    ds_read_b64_tr_b16 a[134:135], v6 offset:5120
    ds_read_b64_tr_b16 a[136:137], v6 offset:8192
    ds_read_b64_tr_b16 a[138:139], v6 offset:9216
    ds_read_b64_tr_b16 a[140:141], v6 offset:12288
    ds_read_b64_tr_b16 a[142:143], v6 offset:13312
    s_waitcnt lgkmcnt(0)
    s_waitcnt vmcnt(0)
    s_barrier
    v_add_u32 v6, 147456, v80
    ds_read_b64_tr_b16 a[144:145], v6 offset:0
    ds_read_b64_tr_b16 a[146:147], v6 offset:1024
    ds_read_b64_tr_b16 a[148:149], v6 offset:4096
    ds_read_b64_tr_b16 a[150:151], v6 offset:5120
    ds_read_b64_tr_b16 a[152:153], v6 offset:8192
    ds_read_b64_tr_b16 a[154:155], v6 offset:9216
    ds_read_b64_tr_b16 a[156:157], v6 offset:12288
    ds_read_b64_tr_b16 a[158:159], v6 offset:13312
    s_waitcnt lgkmcnt(0)
    s_barrier
    s_cmp_eq_u32 s33, 1
    s_cbranch_scc1 L_cs_16
    v_mbcnt_lo_u32_b32 v7, -1, 0
    v_bfe_u32 v8, v7, 2, 1
    v_and_b32 v7, 3, v7
    v_lshlrev_b32 v7, 6, v7
    v_lshl_add_u32 v7, v8, 2, v7
L_cen_17:
    global_load_dword v8, v7, s[20:21] sc1
    s_sub_u32 s27, s27, 1
    s_cbranch_scc0 L_ok_19
    s_mov_b32 s28, 10
    s_branch L_bail
L_ok_19:
    s_waitcnt vmcnt(0)
L_cenc_18:
    s_mov_b32 s29, 0
    v_readlane_b32 s30, v8, 0
    s_nop 0
    s_add_u32 s29, s29, s30
    v_readlane_b32 s30, v8, 1
    s_nop 0
    s_add_u32 s29, s29, s30
    v_readlane_b32 s30, v8, 2
    s_nop 0
    s_add_u32 s29, s29, s30
    v_readlane_b32 s30, v8, 3
    s_nop 0
    s_add_u32 s29, s29, s30
    v_readlane_b32 s30, v8, 4
    s_nop 0
    s_add_u32 s29, s29, s30
    v_readlane_b32 s30, v8, 5
    s_nop 0
    s_add_u32 s29, s29, s30
    v_readlane_b32 s30, v8, 6
    s_nop 0
    s_add_u32 s29, s29, s30
    v_readlane_b32 s30, v8, 7
    s_nop 0
    s_add_u32 s29, s29, s30
    s_cmp_lt_u32 s29, 256
    s_cbranch_scc1 L_cen_17
    v_cmp_ne_u32 vcc, 32, v8
    s_cbranch_vccnz L_fallback
L_cs_16:
    s_mov_b32 s50, 71303168
    s_mov_b32 s51, 1
L_fl_20:
    buffer_load_dword v77, v3, s[4:7], s50 offen sc1
    s_sub_u32 s27, s27, 1
    s_cbranch_scc0 L_ok_21
    s_mov_b32 s28, 20
    s_branch L_bail
L_ok_21:
    s_waitcnt vmcnt(0)
    v_cmp_gt_u32 vcc, s51, v77
    s_cbranch_vccnz L_fl_20
    s_mov_b32 s53, 0
    s_mov_b32 s55, 0
    s_mul_i32 s56, s53, 40960
    s_add_u32 s56, s56, 75497472
    s_add_u32 s56, s56, s58
    s_add_u32 s57, s55, s58
    s_add_u32 s30, s56, 0
    s_add_u32 m0, s57, 0
    s_nop 0
    buffer_load_dwordx4 v4, s[4:7], s30 offen offset:0 sc1 lds
    s_add_u32 m0, s57, 0
    s_nop 0
    buffer_load_dwordx4 v4, s[4:7], s30 offen offset:1024 sc1 lds
    s_add_u32 m0, s57, 0
    s_nop 0
    buffer_load_dwordx4 v4, s[4:7], s30 offen offset:2048 sc1 lds
    s_add_u32 m0, s57, 0
    s_nop 0
    buffer_load_dwordx4 v4, s[4:7], s30 offen offset:3072 sc1 lds
    s_add_u32 s30, s56, 4096
    s_add_u32 m0, s57, 4096
    s_nop 0
    buffer_load_dwordx4 v4, s[4:7], s30 offen offset:0 sc1 lds
    s_add_u32 m0, s57, 4096
    s_nop 0
    buffer_load_dwordx4 v4, s[4:7], s30 offen offset:1024 sc1 lds
    s_add_u32 m0, s57, 4096
    s_nop 0
    buffer_load_dwordx4 v4, s[4:7], s30 offen offset:2048 sc1 lds
    s_add_u32 m0, s57, 4096
    s_nop 0
    buffer_load_dwordx4 v4, s[4:7], s30 offen offset:3072 sc1 lds
    s_add_u32 s30, s56, 8192
    s_add_u32 m0, s57, 8192
    s_nop 0
    buffer_load_dwordx4 v4, s[4:7], s30 offen offset:0 sc1 lds
    s_add_u32 m0, s57, 8192
    s_nop 0
    buffer_load_dwordx4 v4, s[4:7], s30 offen offset:1024 sc1 lds
    s_mov_b32 s50, 71303296
    s_mov_b32 s51, 1
L_fl_22:
    buffer_load_dword v77, v3, s[4:7], s50 offen sc1
    s_sub_u32 s27, s27, 1
    s_cbranch_scc0 L_ok_23
    s_mov_b32 s28, 20
    s_branch L_bail
L_ok_23:
    s_waitcnt vmcnt(0)
    v_cmp_gt_u32 vcc, s51, v77
    s_cbranch_vccnz L_fl_22
    s_mov_b32 s53, 1
    s_mov_b32 s55, 40960
    s_mul_i32 s56, s53, 40960
    s_add_u32 s56, s56, 75497472
    s_add_u32 s56, s56, s58
    s_add_u32 s57, s55, s58
    s_add_u32 s30, s56, 0
    s_add_u32 m0, s57, 0
    s_nop 0
    buffer_load_dwordx4 v4, s[4:7], s30 offen offset:0 sc1 lds
    s_add_u32 m0, s57, 0
    s_nop 0
    buffer_load_dwordx4 v4, s[4:7], s30 offen offset:1024 sc1 lds
    s_add_u32 m0, s57, 0
    s_nop 0
    buffer_load_dwordx4 v4, s[4:7], s30 offen offset:2048 sc1 lds
    s_add_u32 m0, s57, 0
    s_nop 0
    buffer_load_dwordx4 v4, s[4:7], s30 offen offset:3072 sc1 lds
    s_add_u32 s30, s56, 4096
    s_add_u32 m0, s57, 4096
    s_nop 0
    buffer_load_dwordx4 v4, s[4:7], s30 offen offset:0 sc1 lds
    s_add_u32 m0, s57, 4096
    s_nop 0
    buffer_load_dwordx4 v4, s[4:7], s30 offen offset:1024 sc1 lds
    s_add_u32 m0, s57, 4096
    s_nop 0
    buffer_load_dwordx4 v4, s[4:7], s30 offen offset:2048 sc1 lds
    s_add_u32 m0, s57, 4096
    s_nop 0
    buffer_load_dwordx4 v4, s[4:7], s30 offen offset:3072 sc1 lds
    s_add_u32 s30, s56, 8192
    s_add_u32 m0, s57, 8192
    s_nop 0
    buffer_load_dwordx4 v4, s[4:7], s30 offen offset:0 sc1 lds
    s_add_u32 m0, s57, 8192
    s_nop 0
    buffer_load_dwordx4 v4, s[4:7], s30 offen offset:1024 sc1 lds
    s_mov_b32 s50, 71303424
    s_mov_b32 s51, 1
    buffer_load_dword v77, v3, s[4:7], s50 offen sc1
    s_mov_b32 s52, 0
    s_mov_b32 s53, 2
    s_mov_b32 s54, 0
    s_mov_b32 s55, 81920
    s_waitcnt vmcnt(0)
L_kvtop_24:
    s_waitcnt vmcnt(10)
    s_barrier
    v_add_u32 v76, s54, v4
    ds_read_b128 v[60:63], v76 offset:0
    ds_read_b128 v[64:67], v76 offset:1024
    ds_read_b128 v[68:71], v76 offset:2048
    ds_read_b128 v[72:75], v76 offset:3072
    s_waitcnt lgkmcnt(3)
    v_mfma_f32_32x32x16_bf16 v[28:43], a[0:3], v[60:63], 0
    s_sub_u32 s31, s52, 1
    s_max_i32 s31, s31, 0
    v_mov_b32 v78, s31
    buffer_store_dword v78, v11, s[4:7], 0 offen sc1
    ds_read_b128 v[60:63], v76 offset:4096
    s_waitcnt lgkmcnt(3)
    v_mfma_f32_32x32x16_bf16 v[28:43], a[4:7], v[64:67], v[28:43]
    buffer_load_dwordx4 v[20:23], v10, s[4:7], s48 offen offset:0 sc1
    buffer_load_dwordx4 v[24:27], v10, s[4:7], s48 offen offset:512 sc1
    v_mul_f32 v44, s49, v44
    ds_read_b128 v[64:67], v76 offset:5120
    s_waitcnt lgkmcnt(3)
    v_mfma_f32_32x32x16_bf16 v[28:43], a[8:11], v[68:71], v[28:43]
    v_mul_f32 v45, s49, v45
    v_mul_f32 v46, s49, v46
    v_mul_f32 v47, s49, v47
    ds_read_b128 v[68:71], v76 offset:6144
    s_waitcnt lgkmcnt(3)
    v_mfma_f32_32x32x16_bf16 v[28:43], a[12:15], v[72:75], v[28:43]
    v_mul_f32 v48, s49, v48
    v_mul_f32 v49, s49, v49
    v_mul_f32 v50, s49, v50
    ds_read_b128 v[72:75], v76 offset:7168
    s_waitcnt lgkmcnt(3)
    v_mfma_f32_32x32x16_bf16 v[28:43], a[16:19], v[60:63], v[28:43]
    v_mul_f32 v51, s49, v51
    v_mul_f32 v52, s49, v52
    v_mul_f32 v53, s49, v53
    ds_read_b128 v[60:63], v76 offset:8192
    s_waitcnt lgkmcnt(3)
    v_mfma_f32_32x32x16_bf16 v[28:43], a[20:23], v[64:67], v[28:43]
    v_mul_f32 v54, s49, v54
    v_mul_f32 v55, s49, v55
    v_mul_f32 v56, s49, v56
    ds_read_b128 v[64:67], v76 offset:9216
    s_waitcnt lgkmcnt(3)
    v_mfma_f32_32x32x16_bf16 v[28:43], a[24:27], v[68:71], v[28:43]
    v_mul_f32 v57, s49, v57
    v_mul_f32 v58, s49, v58
    v_mul_f32 v59, s49, v59
    ds_read_b128 v[68:71], v76 offset:10240
    s_waitcnt lgkmcnt(3)
    v_mfma_f32_32x32x16_bf16 v[28:43], a[28:31], v[72:75], v[28:43]
    v_cvt_pk_bf16_f32 v12, v44, v45
    v_cvt_pk_bf16_f32 v13, v46, v47
    v_cvt_pk_bf16_f32 v14, v48, v49
    ds_read_b128 v[72:75], v76 offset:11264
    s_waitcnt lgkmcnt(3)
    v_mfma_f32_32x32x16_bf16 v[28:43], a[32:35], v[60:63], v[28:43]
    v_cvt_pk_bf16_f32 v15, v50, v51
    v_cvt_pk_bf16_f32 v16, v52, v53
    v_cvt_pk_bf16_f32 v17, v54, v55
    ds_read_b128 v[60:63], v76 offset:12288
    s_waitcnt lgkmcnt(3)
    v_mfma_f32_32x32x16_bf16 v[28:43], a[36:39], v[64:67], v[28:43]
    v_cvt_pk_bf16_f32 v18, v56, v57
    v_cvt_pk_bf16_f32 v19, v58, v59
    s_mul_i32 s48, s52, 8192
    s_add_u32 s48, s48, 4294959104
    s_add_u32 s48, s48, s47
    s_cmp_eq_u32 s52, 0
    s_cselect_b32 s48, 1073741824, s48
    ds_read_b128 v[64:67], v76 offset:13312
    s_waitcnt lgkmcnt(3)
    v_mfma_f32_32x32x16_bf16 v[28:43], a[40:43], v[68:71], v[28:43]
    buffer_store_dwordx4 v[12:15], v10, s[4:7], s48 offen offset:0 sc1
    buffer_store_dwordx4 v[16:19], v10, s[4:7], s48 offen offset:512 sc1
    ds_read_b128 v[68:71], v76 offset:14336
    s_waitcnt lgkmcnt(3)
    v_mfma_f32_32x32x16_bf16 v[28:43], a[44:47], v[72:75], v[28:43]
    ds_read_b128 v[72:75], v76 offset:15360
    s_waitcnt lgkmcnt(3)
    v_mfma_f32_32x32x16_bf16 v[28:43], a[48:51], v[60:63], v[28:43]
    s_mul_i32 s56, s53, 40960
    s_add_u32 s56, s56, 75497472
    s_add_u32 s56, s56, s58
    s_add_u32 s57, s55, s58
    v_cmp_gt_u32 vcc, s51, v77
    ds_read_b128 v[60:63], v76 offset:16384
    s_waitcnt lgkmcnt(3)
    v_mfma_f32_32x32x16_bf16 v[28:43], a[52:55], v[64:67], v[28:43]
    s_cbranch_vccnz L_nf_26
L_nfok_27:
    s_add_u32 s53, s53, 1
    s_min_u32 s53, s53, 63
    s_mul_i32 s31, s53, 4682
    s_lshr_b32 s51, s31, 16
    s_mul_i32 s31, s51, 14
    s_sub_u32 s31, s53, s31
    s_lshl_b32 s31, s31, 7
    s_add_u32 s50, s31, 71303168
    s_add_u32 s51, s51, 1
    buffer_load_dword v77, v3, s[4:7], s50 offen sc1
    ds_read_b128 v[64:67], v76 offset:17408
    s_waitcnt lgkmcnt(3)
    v_mfma_f32_32x32x16_bf16 v[28:43], a[56:59], v[68:71], v[28:43]
    s_add_u32 s30, s56, 0
    s_add_u32 m0, s57, 0
    s_nop 0
    buffer_load_dwordx4 v4, s[4:7], s30 offen offset:0 sc1 lds
    ds_read_b128 v[68:71], v76 offset:18432
    s_waitcnt lgkmcnt(3)
    v_mfma_f32_32x32x16_bf16 v[28:43], a[60:63], v[72:75], v[28:43]
    ds_read_b128 v[72:75], v76 offset:19456
    s_waitcnt lgkmcnt(3)
    v_mfma_f32_32x32x16_bf16 v[28:43], a[64:67], v[60:63], v[28:43]
    s_add_u32 m0, s57, 0
    s_nop 0
    buffer_load_dwordx4 v4, s[4:7], s30 offen offset:1024 sc1 lds
    ds_read_b128 v[60:63], v76 offset:20480
    s_waitcnt lgkmcnt(3)
    v_mfma_f32_32x32x16_bf16 v[28:43], a[68:71], v[64:67], v[28:43]
    ds_read_b128 v[64:67], v76 offset:21504
    s_waitcnt lgkmcnt(3)
    v_mfma_f32_32x32x16_bf16 v[28:43], a[72:75], v[68:71], v[28:43]
    s_add_u32 m0, s57, 0
    s_nop 0
    buffer_load_dwordx4 v4, s[4:7], s30 offen offset:2048 sc1 lds
    ds_read_b128 v[68:71], v76 offset:22528
    s_waitcnt lgkmcnt(3)
    v_mfma_f32_32x32x16_bf16 v[28:43], a[76:79], v[72:75], v[28:43]
    ds_read_b128 v[72:75], v76 offset:23552
    s_waitcnt lgkmcnt(3)
    v_mfma_f32_32x32x16_bf16 v[28:43], a[80:83], v[60:63], v[28:43]
    s_add_u32 m0, s57, 0
    s_nop 0
    buffer_load_dwordx4 v4, s[4:7], s30 offen offset:3072 sc1 lds
    ds_read_b128 v[60:63], v76 offset:24576
    s_waitcnt lgkmcnt(3)
    v_mfma_f32_32x32x16_bf16 v[28:43], a[84:87], v[64:67], v[28:43]
    ds_read_b128 v[64:67], v76 offset:25600
    s_waitcnt lgkmcnt(3)
    v_mfma_f32_32x32x16_bf16 v[28:43], a[88:91], v[68:71], v[28:43]
    s_add_u32 s30, s56, 4096
    s_add_u32 m0, s57, 4096
    s_nop 0
    buffer_load_dwordx4 v4, s[4:7], s30 offen offset:0 sc1 lds
    ds_read_b128 v[68:71], v76 offset:26624
    s_waitcnt lgkmcnt(3)
    v_mfma_f32_32x32x16_bf16 v[28:43], a[92:95], v[72:75], v[28:43]
    ds_read_b128 v[72:75], v76 offset:27648
    s_waitcnt lgkmcnt(3)
    v_mfma_f32_32x32x16_bf16 v[28:43], a[96:99], v[60:63], v[28:43]
    s_add_u32 m0, s57, 4096
    s_nop 0
    buffer_load_dwordx4 v4, s[4:7], s30 offen offset:1024 sc1 lds
    ds_read_b128 v[60:63], v76 offset:28672
    s_waitcnt lgkmcnt(3)
    v_mfma_f32_32x32x16_bf16 v[28:43], a[100:103], v[64:67], v[28:43]
    ds_read_b128 v[64:67], v76 offset:29696
    s_waitcnt lgkmcnt(3)
    v_mfma_f32_32x32x16_bf16 v[28:43], a[104:107], v[68:71], v[28:43]
    s_add_u32 m0, s57, 4096
    s_nop 0
    buffer_load_dwordx4 v4, s[4:7], s30 offen offset:2048 sc1 lds
    ds_read_b128 v[68:71], v76 offset:30720
    s_waitcnt lgkmcnt(3)
    v_mfma_f32_32x32x16_bf16 v[28:43], a[108:111], v[72:75], v[28:43]
    ds_read_b128 v[72:75], v76 offset:31744
    s_waitcnt lgkmcnt(3)
    v_mfma_f32_32x32x16_bf16 v[28:43], a[112:115], v[60:63], v[28:43]
    s_add_u32 m0, s57, 4096
    s_nop 0
    buffer_load_dwordx4 v4, s[4:7], s30 offen offset:3072 sc1 lds
    ds_read_b128 v[60:63], v76 offset:32768
    s_waitcnt lgkmcnt(3)
    v_mfma_f32_32x32x16_bf16 v[28:43], a[116:119], v[64:67], v[28:43]
    ds_read_b128 v[64:67], v76 offset:33792
    s_waitcnt lgkmcnt(3)
    v_mfma_f32_32x32x16_bf16 v[28:43], a[120:123], v[68:71], v[28:43]
    s_add_u32 s30, s56, 8192
    s_add_u32 m0, s57, 8192
    s_nop 0
    buffer_load_dwordx4 v4, s[4:7], s30 offen offset:0 sc1 lds
    ds_read_b128 v[68:71], v76 offset:34816
    s_waitcnt lgkmcnt(3)
    v_mfma_f32_32x32x16_bf16 v[28:43], a[124:127], v[72:75], v[28:43]
    ds_read_b128 v[72:75], v76 offset:35840
    s_waitcnt lgkmcnt(3)
    v_mfma_f32_32x32x16_bf16 v[28:43], a[128:131], v[60:63], v[28:43]
    s_add_u32 m0, s57, 8192
    s_nop 0
    buffer_load_dwordx4 v4, s[4:7], s30 offen offset:1024 sc1 lds
    ds_read_b128 v[60:63], v76 offset:36864
    s_waitcnt lgkmcnt(3)
    v_mfma_f32_32x32x16_bf16 v[28:43], a[132:135], v[64:67], v[28:43]
    ds_read_b128 v[64:67], v76 offset:37888
    s_waitcnt lgkmcnt(3)
    v_mfma_f32_32x32x16_bf16 v[28:43], a[136:139], v[68:71], v[28:43]
    ds_read_b128 v[68:71], v76 offset:38912
    s_waitcnt lgkmcnt(3)
    v_mfma_f32_32x32x16_bf16 v[28:43], a[140:143], v[72:75], v[28:43]
    ds_read_b128 v[72:75], v76 offset:39936
    s_waitcnt lgkmcnt(3)
    v_mfma_f32_32x32x16_bf16 v[28:43], a[144:147], v[60:63], v[28:43]
    s_waitcnt lgkmcnt(2)
    v_mfma_f32_32x32x16_bf16 v[28:43], a[148:151], v[64:67], v[28:43]
    s_waitcnt lgkmcnt(1)
    v_mfma_f32_32x32x16_bf16 v[28:43], a[152:155], v[68:71], v[28:43]
    s_waitcnt lgkmcnt(0)
    v_mfma_f32_32x32x16_bf16 v[28:43], a[156:159], v[72:75], v[28:43]
    s_add_u32 s54, s54, 40960
    s_cmp_eq_u32 s54, 122880
    s_cselect_b32 s54, 0, s54
    s_add_u32 s55, s55, 40960
    s_cmp_eq_u32 s55, 122880
    s_cselect_b32 s55, 0, s55
    s_add_u32 s52, s52, 1
    s_waitcnt vmcnt(10)
    s_barrier
    v_add_u32 v76, s54, v4
    ds_read_b128 v[60:63], v76 offset:0
    ds_read_b128 v[64:67], v76 offset:1024
    ds_read_b128 v[68:71], v76 offset:2048
    ds_read_b128 v[72:75], v76 offset:3072
    s_waitcnt lgkmcnt(3)
    v_mfma_f32_32x32x16_bf16 v[44:59], a[0:3], v[60:63], 0
    s_sub_u32 s31, s52, 1
    s_max_i32 s31, s31, 0
    v_mov_b32 v78, s31
    buffer_store_dword v78, v11, s[4:7], 0 offen sc1
    ds_read_b128 v[60:63], v76 offset:4096
    s_waitcnt lgkmcnt(3)
    v_mfma_f32_32x32x16_bf16 v[44:59], a[4:7], v[64:67], v[44:59]
    buffer_load_dwordx4 v[20:23], v10, s[4:7], s48 offen offset:0 sc1
    buffer_load_dwordx4 v[24:27], v10, s[4:7], s48 offen offset:512 sc1
    v_mul_f32 v28, s49, v28
    ds_read_b128 v[64:67], v76 offset:5120
    s_waitcnt lgkmcnt(3)
    v_mfma_f32_32x32x16_bf16 v[44:59], a[8:11], v[68:71], v[44:59]
    v_mul_f32 v29, s49, v29
    v_mul_f32 v30, s49, v30
    v_mul_f32 v31, s49, v31
    ds_read_b128 v[68:71], v76 offset:6144
    s_waitcnt lgkmcnt(3)
    v_mfma_f32_32x32x16_bf16 v[44:59], a[12:15], v[72:75], v[44:59]
    v_mul_f32 v32, s49, v32
    v_mul_f32 v33, s49, v33
    v_mul_f32 v34, s49, v34
    ds_read_b128 v[72:75], v76 offset:7168
    s_waitcnt lgkmcnt(3)
    v_mfma_f32_32x32x16_bf16 v[44:59], a[16:19], v[60:63], v[44:59]
    v_mul_f32 v35, s49, v35
    v_mul_f32 v36, s49, v36
    v_mul_f32 v37, s49, v37
    ds_read_b128 v[60:63], v76 offset:8192
    s_waitcnt lgkmcnt(3)
    v_mfma_f32_32x32x16_bf16 v[44:59], a[20:23], v[64:67], v[44:59]
    v_mul_f32 v38, s49, v38
    v_mul_f32 v39, s49, v39
    v_mul_f32 v40, s49, v40
    ds_read_b128 v[64:67], v76 offset:9216
    s_waitcnt lgkmcnt(3)
    v_mfma_f32_32x32x16_bf16 v[44:59], a[24:27], v[68:71], v[44:59]
    v_mul_f32 v41, s49, v41
    v_mul_f32 v42, s49, v42
    v_mul_f32 v43, s49, v43
    ds_read_b128 v[68:71], v76 offset:10240
    s_waitcnt lgkmcnt(3)
    v_mfma_f32_32x32x16_bf16 v[44:59], a[28:31], v[72:75], v[44:59]
    v_cvt_pk_bf16_f32 v12, v28, v29
    v_cvt_pk_bf16_f32 v13, v30, v31
    v_cvt_pk_bf16_f32 v14, v32, v33
    ds_read_b128 v[72:75], v76 offset:11264
    s_waitcnt lgkmcnt(3)
    v_mfma_f32_32x32x16_bf16 v[44:59], a[32:35], v[60:63], v[44:59]
    v_cvt_pk_bf16_f32 v15, v34, v35
    v_cvt_pk_bf16_f32 v16, v36, v37
    v_cvt_pk_bf16_f32 v17, v38, v39
    ds_read_b128 v[60:63], v76 offset:12288
    s_waitcnt lgkmcnt(3)
    v_mfma_f32_32x32x16_bf16 v[44:59], a[36:39], v[64:67], v[44:59]
    v_cvt_pk_bf16_f32 v18, v40, v41
    v_cvt_pk_bf16_f32 v19, v42, v43
    s_mul_i32 s48, s52, 8192
    s_add_u32 s48, s48, 4294959104
    s_add_u32 s48, s48, s47
    s_cmp_eq_u32 s52, 0
    s_cselect_b32 s48, 1073741824, s48
    ds_read_b128 v[64:67], v76 offset:13312
    s_waitcnt lgkmcnt(3)
    v_mfma_f32_32x32x16_bf16 v[44:59], a[40:43], v[68:71], v[44:59]
    buffer_store_dwordx4 v[12:15], v10, s[4:7], s48 offen offset:0 sc1
    buffer_store_dwordx4 v[16:19], v10, s[4:7], s48 offen offset:512 sc1
    ds_read_b128 v[68:71], v76 offset:14336
    s_waitcnt lgkmcnt(3)
    v_mfma_f32_32x32x16_bf16 v[44:59], a[44:47], v[72:75], v[44:59]
    ds_read_b128 v[72:75], v76 offset:15360
    s_waitcnt lgkmcnt(3)
    v_mfma_f32_32x32x16_bf16 v[44:59], a[48:51], v[60:63], v[44:59]
    s_mul_i32 s56, s53, 40960
    s_add_u32 s56, s56, 75497472
    s_add_u32 s56, s56, s58
    s_add_u32 s57, s55, s58
    v_cmp_gt_u32 vcc, s51, v77
    ds_read_b128 v[60:63], v76 offset:16384
    s_waitcnt lgkmcnt(3)
    v_mfma_f32_32x32x16_bf16 v[44:59], a[52:55], v[64:67], v[44:59]
    s_cbranch_vccnz L_nf_28
L_nfok_29:
    s_add_u32 s53, s53, 1
    s_min_u32 s53, s53, 63
    s_mul_i32 s31, s53, 4682
    s_lshr_b32 s51, s31, 16
    s_mul_i32 s31, s51, 14
    s_sub_u32 s31, s53, s31
    s_lshl_b32 s31, s31, 7
    s_add_u32 s50, s31, 71303168
    s_add_u32 s51, s51, 1
    buffer_load_dword v77, v3, s[4:7], s50 offen sc1
    ds_read_b128 v[64:67], v76 offset:17408
    s_waitcnt lgkmcnt(3)
    v_mfma_f32_32x32x16_bf16 v[44:59], a[56:59], v[68:71], v[44:59]
    s_add_u32 s30, s56, 0
    s_add_u32 m0, s57, 0
    s_nop 0
    buffer_load_dwordx4 v4, s[4:7], s30 offen offset:0 sc1 lds
    ds_read_b128 v[68:71], v76 offset:18432
    s_waitcnt lgkmcnt(3)
    v_mfma_f32_32x32x16_bf16 v[44:59], a[60:63], v[72:75], v[44:59]
    ds_read_b128 v[72:75], v76 offset:19456
    s_waitcnt lgkmcnt(3)
    v_mfma_f32_32x32x16_bf16 v[44:59], a[64:67], v[60:63], v[44:59]
    s_add_u32 m0, s57, 0
    s_nop 0
    buffer_load_dwordx4 v4, s[4:7], s30 offen offset:1024 sc1 lds
    ds_read_b128 v[60:63], v76 offset:20480
    s_waitcnt lgkmcnt(3)
    v_mfma_f32_32x32x16_bf16 v[44:59], a[68:71], v[64:67], v[44:59]
    ds_read_b128 v[64:67], v76 offset:21504
    s_waitcnt lgkmcnt(3)
    v_mfma_f32_32x32x16_bf16 v[44:59], a[72:75], v[68:71], v[44:59]
    s_add_u32 m0, s57, 0
    s_nop 0
    buffer_load_dwordx4 v4, s[4:7], s30 offen offset:2048 sc1 lds
    ds_read_b128 v[68:71], v76 offset:22528
    s_waitcnt lgkmcnt(3)
    v_mfma_f32_32x32x16_bf16 v[44:59], a[76:79], v[72:75], v[44:59]
    ds_read_b128 v[72:75], v76 offset:23552
    s_waitcnt lgkmcnt(3)
    v_mfma_f32_32x32x16_bf16 v[44:59], a[80:83], v[60:63], v[44:59]
    s_add_u32 m0, s57, 0
    s_nop 0
    buffer_load_dwordx4 v4, s[4:7], s30 offen offset:3072 sc1 lds
    ds_read_b128 v[60:63], v76 offset:24576
    s_waitcnt lgkmcnt(3)
    v_mfma_f32_32x32x16_bf16 v[44:59], a[84:87], v[64:67], v[44:59]
    ds_read_b128 v[64:67], v76 offset:25600
    s_waitcnt lgkmcnt(3)
    v_mfma_f32_32x32x16_bf16 v[44:59], a[88:91], v[68:71], v[44:59]
    s_add_u32 s30, s56, 4096
    s_add_u32 m0, s57, 4096
    s_nop 0
    buffer_load_dwordx4 v4, s[4:7], s30 offen offset:0 sc1 lds
    ds_read_b128 v[68:71], v76 offset:26624
    s_waitcnt lgkmcnt(3)
    v_mfma_f32_32x32x16_bf16 v[44:59], a[92:95], v[72:75], v[44:59]
    ds_read_b128 v[72:75], v76 offset:27648
    s_waitcnt lgkmcnt(3)
    v_mfma_f32_32x32x16_bf16 v[44:59], a[96:99], v[60:63], v[44:59]
    s_add_u32 m0, s57, 4096
    s_nop 0
    buffer_load_dwordx4 v4, s[4:7], s30 offen offset:1024 sc1 lds
    ds_read_b128 v[60:63], v76 offset:28672
    s_waitcnt lgkmcnt(3)
    v_mfma_f32_32x32x16_bf16 v[44:59], a[100:103], v[64:67], v[44:59]
    ds_read_b128 v[64:67], v76 offset:29696
    s_waitcnt lgkmcnt(3)
    v_mfma_f32_32x32x16_bf16 v[44:59], a[104:107], v[68:71], v[44:59]
    s_add_u32 m0, s57, 4096
    s_nop 0
    buffer_load_dwordx4 v4, s[4:7], s30 offen offset:2048 sc1 lds
    ds_read_b128 v[68:71], v76 offset:30720
    s_waitcnt lgkmcnt(3)
    v_mfma_f32_32x32x16_bf16 v[44:59], a[108:111], v[72:75], v[44:59]
    ds_read_b128 v[72:75], v76 offset:31744
    s_waitcnt lgkmcnt(3)
    v_mfma_f32_32x32x16_bf16 v[44:59], a[112:115], v[60:63], v[44:59]
    s_add_u32 m0, s57, 4096
    s_nop 0
    buffer_load_dwordx4 v4, s[4:7], s30 offen offset:3072 sc1 lds
    ds_read_b128 v[60:63], v76 offset:32768
    s_waitcnt lgkmcnt(3)
    v_mfma_f32_32x32x16_bf16 v[44:59], a[116:119], v[64:67], v[44:59]
    ds_read_b128 v[64:67], v76 offset:33792
    s_waitcnt lgkmcnt(3)
    v_mfma_f32_32x32x16_bf16 v[44:59], a[120:123], v[68:71], v[44:59]
    s_add_u32 s30, s56, 8192
    s_add_u32 m0, s57, 8192
    s_nop 0
    buffer_load_dwordx4 v4, s[4:7], s30 offen offset:0 sc1 lds
    ds_read_b128 v[68:71], v76 offset:34816
    s_waitcnt lgkmcnt(3)
    v_mfma_f32_32x32x16_bf16 v[44:59], a[124:127], v[72:75], v[44:59]
    ds_read_b128 v[72:75], v76 offset:35840
    s_waitcnt lgkmcnt(3)
    v_mfma_f32_32x32x16_bf16 v[44:59], a[128:131], v[60:63], v[44:59]
    s_add_u32 m0, s57, 8192
    s_nop 0
    buffer_load_dwordx4 v4, s[4:7], s30 offen offset:1024 sc1 lds
    ds_read_b128 v[60:63], v76 offset:36864
    s_waitcnt lgkmcnt(3)
    v_mfma_f32_32x32x16_bf16 v[44:59], a[132:135], v[64:67], v[44:59]
    ds_read_b128 v[64:67], v76 offset:37888
    s_waitcnt lgkmcnt(3)
    v_mfma_f32_32x32x16_bf16 v[44:59], a[136:139], v[68:71], v[44:59]
    ds_read_b128 v[68:71], v76 offset:38912
    s_waitcnt lgkmcnt(3)
    v_mfma_f32_32x32x16_bf16 v[44:59], a[140:143], v[72:75], v[44:59]
    ds_read_b128 v[72:75], v76 offset:39936
    s_waitcnt lgkmcnt(3)
    v_mfma_f32_32x32x16_bf16 v[44:59], a[144:147], v[60:63], v[44:59]
    s_waitcnt lgkmcnt(2)
    v_mfma_f32_32x32x16_bf16 v[44:59], a[148:151], v[64:67], v[44:59]
    s_waitcnt lgkmcnt(1)
    v_mfma_f32_32x32x16_bf16 v[44:59], a[152:155], v[68:71], v[44:59]
    s_waitcnt lgkmcnt(0)
    v_mfma_f32_32x32x16_bf16 v[44:59], a[156:159], v[72:75], v[44:59]
    s_add_u32 s54, s54, 40960
    s_cmp_eq_u32 s54, 122880
    s_cselect_b32 s54, 0, s54
    s_add_u32 s55, s55, 40960
    s_cmp_eq_u32 s55, 122880
    s_cselect_b32 s55, 0, s55
    s_add_u32 s52, s52, 1
    s_cmp_lt_u32 s52, 64
    s_cbranch_scc1 L_kvtop_24
    buffer_load_dwordx4 v[20:23], v10, s[4:7], s48 offen offset:0 sc1
    buffer_load_dwordx4 v[24:27], v10, s[4:7], s48 offen offset:512 sc1
    s_nop 0
    v_mul_f32 v44, s49, v44
    v_mul_f32 v45, s49, v45
    v_mul_f32 v46, s49, v46
    v_mul_f32 v47, s49, v47
    v_mul_f32 v48, s49, v48
    v_mul_f32 v49, s49, v49
    v_mul_f32 v50, s49, v50
    v_mul_f32 v51, s49, v51
    v_mul_f32 v52, s49, v52
    v_mul_f32 v53, s49, v53
    v_mul_f32 v54, s49, v54
    v_mul_f32 v55, s49, v55
    v_mul_f32 v56, s49, v56
    v_mul_f32 v57, s49, v57
    v_mul_f32 v58, s49, v58
    v_mul_f32 v59, s49, v59
    v_cvt_pk_bf16_f32 v12, v44, v45
    v_cvt_pk_bf16_f32 v13, v46, v47
    v_cvt_pk_bf16_f32 v14, v48, v49
    v_cvt_pk_bf16_f32 v15, v50, v51
    v_cvt_pk_bf16_f32 v16, v52, v53
    v_cvt_pk_bf16_f32 v17, v54, v55
    v_cvt_pk_bf16_f32 v18, v56, v57
    v_cvt_pk_bf16_f32 v19, v58, v59
    s_mul_i32 s48, s52, 8192
    s_add_u32 s48, s48, 4294959104
    s_add_u32 s48, s48, s47
    s_cmp_eq_u32 s52, 0
    s_cselect_b32 s48, 1073741824, s48
    buffer_store_dwordx4 v[12:15], v10, s[4:7], s48 offen offset:0 sc1
    buffer_store_dwordx4 v[16:19], v10, s[4:7], s48 offen offset:512 sc1
    s_waitcnt vmcnt(0)
    s_barrier
    v_mov_b32 v78, 64
    buffer_store_dword v78, v11, s[4:7], 0 offen sc1
    s_endpgm
L_nf_26:
L_fl_30:
    buffer_load_dword v77, v3, s[4:7], s50 offen sc1
    s_sub_u32 s27, s27, 1
    s_cbranch_scc0 L_ok_31
    s_mov_b32 s28, 21
    s_branch L_bail
L_ok_31:
    s_waitcnt vmcnt(0)
    v_cmp_gt_u32 vcc, s51, v77
    s_cbranch_vccnz L_fl_30
    s_branch L_nfok_27
L_nf_28:
L_fl_32:
    buffer_load_dword v77, v3, s[4:7], s50 offen sc1
    s_sub_u32 s27, s27, 1
    s_cbranch_scc0 L_ok_33
    s_mov_b32 s28, 21
    s_branch L_bail
L_ok_33:
    s_waitcnt vmcnt(0)
    v_cmp_gt_u32 vcc, s51, v77
    s_cbranch_vccnz L_fl_32
    s_branch L_nfok_29
L_QA:
    s_getpc_b64 s[28:29]
    v_lshlrev_b32 v1, 4, v0
    global_load_dwordx4 v[252:255], v1, s[28:29]
    v_add_u32 v1, 4096, v1
    global_load_dwordx4 v[252:255], v1, s[28:29]
    v_and_b32 v1, 63, v0
    v_mov_b32 v3, 0
    v_lshlrev_b32 v4, 4, v1
    v_mov_b32 v10, 0
    s_mul_i32 s28, s24, 128
    v_add_u32 v10, s28, v10
    v_add_u32 v10, 71321600, v10
    v_mov_b32 v6, 1073741824
    v_cmp_eq_u32 vcc, 0, v0
    s_nop 1
    v_cndmask_b32 v10, v6, v10, vcc
    s_lshl_b32 s44, s24, 8
    s_lshl_b32 s45, s24, 21
    s_add_u32 s45, s45, 0
    s_mul_i32 s50, s26, 10240
    s_mov_b32 s58, 0x3e0293ee
    s_and_b32 s29, s26, 1
    s_lshr_b32 s30, s26, 1
    v_mov_b32 v14, 2147483648
    v_bfe_u32 v2, v1, 5, 1
    v_mul_u32_u24 v15, 4096, v2
    s_mul_i32 s28, s24, 128
    v_add_u32 v15, s28, v15
    v_add_u32 v15, 71305216, v15
    v_bfe_u32 v2, v1, 4, 1
    v_mul_u32_u24 v19, 4096, v2
    v_bfe_u32 v2, v1, 0, 4
    v_mul_u32_u24 v2, 16, v2
    v_add_u32 v19, v19, v2
    v_bfe_u32 v2, v1, 5, 1
    v_mul_u32_u24 v2, 256, v2
    v_add_u32 v19, v19, v2
    s_mul_i32 s28, s26, 1024
    v_add_u32 v19, s28, v19
    v_add_u32 v19, 114688, v19
    v_bfe_u32 v2, v1, 0, 6
    v_mul_u32_u24 v20, 16, v2
    s_mul_i32 s28, s29, 4096
    v_add_u32 v20, s28, v20
    v_add_u32 v20, 114688, v20
    v_bfe_u32 v2, v1, 0, 6
    v_mul_u32_u24 v23, 8, v2
    s_mul_i32 s28, s26, 512
    v_add_u32 v23, s28, v23
    v_bfe_u32 v2, v1, 0, 6
    v_mul_u32_u24 v24, 8, v2
    s_mul_i32 s28, s30, 1024
    v_add_u32 v24, s28, v24
    v_add_u32 v24, 2048, v24
    v_bfe_u32 v2, v1, 0, 4
    v_mul_u32_u24 v25, 32, v2
    v_bfe_u32 v2, v1, 4, 2
    v_mul_u32_u24 v2, 8, v2
    v_add_u32 v25, v25, v2
    s_mul_i32 s28, s26, 1024
    v_add_u32 v25, s28, v25
    v_add_u32 v25, 122880, v25
    v_bfe_u32 v2, v1, 5, 1
    v_mul_u32_u24 v26, 512, v2
    v_bfe_u32 v2, v1, 4, 1
    v_mul_u32_u24 v2, 128, v2
    v_add_u32 v26, v26, v2
    v_bfe_u32 v2, v1, 2, 2
    v_mul_u32_u24 v2, 32, v2
    v_add_u32 v26, v26, v2
    v_bfe_u32 v2, v1, 0, 2
    v_mul_u32_u24 v2, 8, v2
    v_add_u32 v26, v26, v2
    v_add_u32 v26, 122880, v26
    v_bfe_u32 v2, v1, 5, 1
    v_mul_u32_u24 v28, 1024, v2
    v_bfe_u32 v2, v1, 4, 1
    v_mul_u32_u24 v2, 512, v2
    v_add_u32 v28, v28, v2
    v_bfe_u32 v2, v1, 0, 4
    v_mul_u32_u24 v2, 16, v2
    v_add_u32 v28, v28, v2
    s_mul_i32 s28, s29, 256
    v_add_u32 v28, s28, v28
    s_mul_i32 s28, s30, 4096
    v_add_u32 v28, s28, v28
    s_mul_i32 s28, s24, 8192
    v_add_u32 v28, s28, v28
    v_bfe_u32 v2, v1, 4, 2
    v_mul_u32_u24 v22, 64, v2
    v_bfe_u32 v2, v1, 2, 2
    v_mul_u32_u24 v2, 16, v2
    v_add_u32 v22, v22, v2
    v_bfe_u32 v2, v1, 0, 1
    v_mul_u32_u24 v2, 256, v2
    v_add_u32 v22, v22, v2
    v_bfe_u32 v2, v1, 1, 1
    v_mul_u32_u24 v2, 8, v2
    v_add_u32 v22, v22, v2
    s_mul_i32 s28, s30, 2048
    v_add_u32 v22, s28, v22
    v_add_u32 v22, 8192, v22
    v_bfe_u32 v2, v1, 0, 4
    v_mul_u32_u24 v7, 1, v2
    s_mul_i32 s28, s29, 16
    v_add_u32 v7, s28, v7
    v_bfe_u32 v2, v1, 4, 2
    v_mul_u32_u24 v8, 4, v2
    v_sub_u32 v7, v7, v8
    v_mov_b32 v8, 0xf149f2ca
    v_cmp_gt_i32 vcc, 0, v7
    s_nop 1
    v_cndmask_b32 v210, v3, v8, vcc
    v_cmp_gt_i32 vcc, 1, v7
    s_nop 1
    v_cndmask_b32 v211, v3, v8, vcc
    v_cmp_gt_i32 vcc, 2, v7
    s_nop 1
    v_cndmask_b32 v212, v3, v8, vcc
    v_cmp_gt_i32 vcc, 3, v7
    s_nop 1
    v_cndmask_b32 v213, v3, v8, vcc
    v_cmp_gt_i32 vcc, 16, v7
    s_nop 1
    v_cndmask_b32 v214, v3, v8, vcc
    v_cmp_gt_i32 vcc, 17, v7
    s_nop 1
    v_cndmask_b32 v215, v3, v8, vcc
    v_cmp_gt_i32 vcc, 18, v7
    s_nop 1
    v_cndmask_b32 v216, v3, v8, vcc
    v_cmp_gt_i32 vcc, 19, v7
    s_nop 1
    v_cndmask_b32 v217, v3, v8, vcc
    v_mov_b32 v206, 0x3f803f80
    v_mov_b32 v207, 0x3f803f80
    v_mov_b32 v208, 0x3f803f80
    v_mov_b32 v209, 0x3f803f80
    v_mov_b32 v172, 0
    v_mov_b32 v173, 0
    v_mov_b32 v174, 0
    v_mov_b32 v175, 0
    v_mov_b32 v176, 0
    v_mov_b32 v177, 0
    v_mov_b32 v178, 0
    v_mov_b32 v179, 0
    v_mov_b32 v180, 0
    v_mov_b32 v181, 0
    v_mov_b32 v182, 0
    v_mov_b32 v183, 0
    v_mov_b32 v184, 0
    v_mov_b32 v185, 0
    s_cmp_eq_u32 s33, 1
    s_cbranch_scc1 L_cs_34
    v_mbcnt_lo_u32_b32 v7, -1, 0
    v_bfe_u32 v8, v7, 2, 1
    v_and_b32 v7, 3, v7
    v_lshlrev_b32 v7, 6, v7
    v_lshl_add_u32 v7, v8, 2, v7
L_cen_35:
    global_load_dword v8, v7, s[20:21] sc1
    s_sub_u32 s27, s27, 1
    s_cbranch_scc0 L_ok_37
    s_mov_b32 s28, 10
    s_branch L_bail
L_ok_37:
    s_waitcnt vmcnt(0)
L_cenc_36:
    s_mov_b32 s29, 0
    v_readlane_b32 s30, v8, 0
    s_nop 0
    s_add_u32 s29, s29, s30
    v_readlane_b32 s30, v8, 1
    s_nop 0
    s_add_u32 s29, s29, s30
    v_readlane_b32 s30, v8, 2
    s_nop 0
    s_add_u32 s29, s29, s30
    v_readlane_b32 s30, v8, 3
    s_nop 0
    s_add_u32 s29, s29, s30
    v_readlane_b32 s30, v8, 4
    s_nop 0
    s_add_u32 s29, s29, s30
    v_readlane_b32 s30, v8, 5
    s_nop 0
    s_add_u32 s29, s29, s30
    v_readlane_b32 s30, v8, 6
    s_nop 0
    s_add_u32 s29, s29, s30
    v_readlane_b32 s30, v8, 7
    s_nop 0
    s_add_u32 s29, s29, s30
    s_cmp_lt_u32 s29, 256
    s_cbranch_scc1 L_cen_35
    v_cmp_ne_u32 vcc, 32, v8
    s_cbranch_vccnz L_fallback
L_cs_34:
    s_lshl_b32 s54, s33, 2
    v_mov_b32 v8, s54
L_par_38:
    global_load_dword v7, v8, s[20:21] offset:48 sc1
    s_sub_u32 s27, s27, 1
    s_cbranch_scc0 L_ok_39
    s_mov_b32 s28, 32
    s_branch L_bail
L_ok_39:
    s_waitcnt vmcnt(0)
    v_readfirstlane_b32 s54, v7
    s_nop 0
    s_cmp_eq_u32 s54, 0
    s_cbranch_scc1 L_par_38
    s_xor_b32 s54, s54, s24
    s_and_b32 s54, s54, 1
    s_lshl_b32 s54, s54, 13
    s_add_u32 s54, s54, s45
    s_add_u32 s54, s54, 1048576
    v_bfe_u32 v2, v1, 0, 6
    v_mul_u32_u24 v13, 16, v2
    s_mul_i32 s28, s26, 1024
    v_add_u32 v13, s28, v13
    v_mov_b32 v218, 2147483648
    v_mov_b32 v219, 2147483648
    v_mov_b32 v220, 2147483648
    v_mov_b32 v221, 2147483648
    s_add_u32 s53, s54, 0
    buffer_store_dwordx4 v[218:221], v13, s[4:7], s53 offen sc1
    s_add_u32 s53, s54, 4096
    buffer_store_dwordx4 v[218:221], v13, s[4:7], s53 offen sc1
    s_add_u32 s53, s54, 16384
    buffer_store_dwordx4 v[218:221], v13, s[4:7], s53 offen sc1
    s_add_u32 s53, s54, 20480
    buffer_store_dwordx4 v[218:221], v13, s[4:7], s53 offen sc1
    s_add_u32 s53, s54, 32768
    buffer_store_dwordx4 v[218:221], v13, s[4:7], s53 offen sc1
    s_add_u32 s53, s54, 36864
    buffer_store_dwordx4 v[218:221], v13, s[4:7], s53 offen sc1
    s_add_u32 s53, s54, 49152
    buffer_store_dwordx4 v[218:221], v13, s[4:7], s53 offen sc1
    s_add_u32 s53, s54, 53248
    buffer_store_dwordx4 v[218:221], v13, s[4:7], s53 offen sc1
    s_lshl_b32 s29, s33, 17
    s_add_u32 s51, s54, s29
    s_add_u32 s53, s51, 524288
    buffer_store_dwordx4 v[218:221], v13, s[4:7], s53 offen sc1
    s_add_u32 s53, s51, 528384
    buffer_store_dwordx4 v[218:221], v13, s[4:7], s53 offen sc1
    s_add_u32 s53, s51, 540672
    buffer_store_dwordx4 v[218:221], v13, s[4:7], s53 offen sc1
    s_add_u32 s53, s51, 544768
    buffer_store_dwordx4 v[218:221], v13, s[4:7], s53 offen sc1
    s_add_u32 s53, s51, 557056
    buffer_store_dwordx4 v[218:221], v13, s[4:7], s53 offen sc1
    s_add_u32 s53, s51, 561152
    buffer_store_dwordx4 v[218:221], v13, s[4:7], s53 offen sc1
    s_add_u32 s53, s51, 573440
    buffer_store_dwordx4 v[218:221], v13, s[4:7], s53 offen sc1
    s_add_u32 s53, s51, 577536
    buffer_store_dwordx4 v[218:221], v13, s[4:7], s53 offen sc1
    s_mul_i32 s51, s33, 2097152
    v_mov_b32 v62, -1
    v_mov_b32 v63, -1
    v_mov_b32 v64, -1
    v_mov_b32 v65, -1
    s_and_b32 s53, s24, 15
    s_mul_i32 s53, s53, 20480
    s_lshr_b32 s29, s24, 4
    s_lshl_b32 s29, s29, 19
    s_add_u32 s53, s53, s29
    s_add_u32 s53, s53, s51
    s_add_u32 s52, s53, 67108864
    buffer_store_dwordx4 v[62:65], v13, s[4:7], s52 offen sc1
    s_add_u32 s52, s53, 67112960
    buffer_store_dwordx4 v[62:65], v13, s[4:7], s52 offen sc1
    s_add_u32 s52, s53, 67117056
    buffer_store_dwordx4 v[62:65], v13, s[4:7], s52 offen sc1
    s_add_u32 s52, s53, 67121152
    buffer_store_dwordx4 v[62:65], v13, s[4:7], s52 offen sc1
    s_add_u32 s52, s53, 67125248
    buffer_store_dwordx4 v[62:65], v13, s[4:7], s52 offen sc1
    s_lshr_b32 s53, s24, 1
    s_and_b32 s29, s24, 1
    s_lshl_b32 s29, s29, 13
    s_add_u32 s29, s29, 68419584
    s_sub_u32 s30, s24, 16
    s_cmp_lt_u32 s24, 16
    s_cselect_b32 s53, s53, s30
    s_cselect_b32 s29, s29, 68157440
    s_lshl_b32 s52, s53, 15
    s_add_u32 s52, s52, s29
    s_add_u32 s52, s52, s51
    s_cmp_ge_u32 s24, 24
    s_cbranch_scc1 L_noimg_40
    s_and_b32 s29, s53, 3
    s_cmp_eq_u32 s29, 3
    s_cbranch_scc1 L_img0_41
    buffer_store_dwordx4 v[218:221], v13, s[4:7], s52 offen sc1
    s_add_u32 s52, s52, 4096
    buffer_store_dwordx4 v[218:221], v13, s[4:7], s52 offen sc1
    s_branch L_noimg_40
L_img0_41:
    s_mov_b32 s64, s18
    s_and_b32 s65, s19, 0xffff
    s_mov_b32 s66, 10240
    s_mov_b32 s67, 0x20000
    s_lshr_b32 s29, s53, 2
    s_mul_i32 s29, s29, 640
    v_bfe_u32 v2, v1, 2, 2
    v_mul_u32_u24 v7, 2560, v2
    v_bfe_u32 v2, v1, 0, 1
    v_mul_u32_u24 v2, 1280, v2
    v_add_u32 v7, v7, v2
    v_bfe_u32 v2, v1, 1, 1
    v_mul_u32_u24 v2, 16, v2
    v_add_u32 v7, v7, v2
    v_bfe_u32 v2, v1, 4, 2
    v_mul_u32_u24 v2, 32, v2
    v_add_u32 v7, v7, v2
    v_bfe_u32 v2, v1, 2, 2
    v_mul_u32_u24 v8, 2560, v2
    v_bfe_u32 v2, v1, 0, 1
    v_mul_u32_u24 v2, 1280, v2
    v_add_u32 v8, v8, v2
    v_bfe_u32 v2, v1, 1, 1
    v_mul_u32_u24 v2, 128, v2
    v_add_u32 v8, v8, v2
    v_bfe_u32 v2, v1, 4, 2
    v_mul_u32_u24 v2, 32, v2
    v_add_u32 v8, v8, v2
    v_add_u32 v8, 128, v8
    buffer_load_dwordx4 v[86:89], v7, s[64:67], s29 offen
    buffer_load_dwordx4 v[90:93], v8, s[64:67], s29 offen offset:0
    buffer_load_dwordx4 v[94:97], v8, s[64:67], s29 offen offset:16
    buffer_load_dwordx4 v[98:101], v8, s[64:67], s29 offen offset:256
    buffer_load_dwordx4 v[102:105], v8, s[64:67], s29 offen offset:272
    s_cmp_eq_u32 s26, 0
    s_cselect_b32 s52, s52, 1073741824
    s_waitcnt vmcnt(0)
    v_max_i32 v86, 2147483649, v86
    s_add_u32 s53, s52, 0
    buffer_store_dwordx4 v[86:89], v4, s[4:7], s53 offen sc1
    v_max_i32 v90, 2147483649, v90
    s_add_u32 s53, s52, 1024
    buffer_store_dwordx4 v[90:93], v4, s[4:7], s53 offen sc1
    v_max_i32 v94, 2147483649, v94
    s_add_u32 s53, s52, 2048
    buffer_store_dwordx4 v[94:97], v4, s[4:7], s53 offen sc1
    v_max_i32 v98, 2147483649, v98
    s_add_u32 s53, s52, 3072
    buffer_store_dwordx4 v[98:101], v4, s[4:7], s53 offen sc1
    v_max_i32 v102, 2147483649, v102
    s_add_u32 s53, s52, 4096
    buffer_store_dwordx4 v[102:105], v4, s[4:7], s53 offen sc1
L_noimg_40:
    s_waitcnt vmcnt(0)
    s_barrier
    s_cmp_lg_u32 s26, 0
    s_cbranch_scc1 L_qarr_42
    s_lshl_b32 s29, s33, 2
    v_mov_b32 v7, s29
    v_mov_b32 v8, 1
    s_mov_b64 exec, 1
    global_atomic_add v7, v8, s[20:21] offset:40
    s_mov_b64 exec, -1
L_qarr_42:
    s_mov_b32 s29, 71305216
    s_mov_b32 s30, 4
L_fl_43:
    buffer_load_dword v7, v3, s[4:7], s29 offen sc1
    s_sub_u32 s27, s27, 1
    s_cbranch_scc0 L_ok_44
    s_mov_b32 s28, 30
    s_branch L_bail
L_ok_44:
    s_waitcnt vmcnt(0)
    v_cmp_gt_u32 vcc, s30, v7
    s_cbranch_vccnz L_fl_43
    s_mov_b32 s68, s8
    s_and_b32 s69, s9, 0xffff
    s_mov_b32 s70, 5242880
    s_mov_b32 s71, 0x20000
    v_bfe_u32 v2, v1, 4, 2
    v_mul_u32_u24 v7, 4, v2
    v_bfe_u32 v2, v1, 0, 4
    v_mul_u32_u24 v8, 1, v2
    v_xor_b32 v7, v7, v8
    v_bfe_u32 v2, v1, 4, 2
    v_mul_u32_u24 v222, 8192, v2
    s_mul_i32 s28, s26, 131072
    v_add_u32 v222, s28, v222
    v_lshl_add_u32 v222, v7, 4, v222
    v_bfe_u32 v2, v1, 2, 2
    v_mul_u32_u24 v7, 4, v2
    v_bfe_u32 v2, v1, 4, 1
    v_mul_u32_u24 v8, 2, v2
    v_bfe_u32 v2, v1, 1, 1
    v_mul_u32_u24 v2, 1, v2
    v_add_u32 v8, v8, v2
    s_mul_i32 s28, s26, 4
    v_add_u32 v8, s28, v8
    v_xor_b32 v7, v7, v8
    v_bfe_u32 v2, v1, 2, 2
    v_mul_u32_u24 v223, 256, v2
    v_bfe_u32 v2, v1, 5, 1
    v_mul_u32_u24 v2, 2048, v2
    v_add_u32 v223, v223, v2
    v_bfe_u32 v2, v1, 0, 1
    v_mul_u32_u24 v2, 8, v2
    v_add_u32 v223, v223, v2
    v_lshl_add_u32 v223, v7, 4, v223
    s_lshl_b32 s72, s26, 12
    s_add_u32 s29, s44, 0
    s_add_u32 m0, s72, 0
    s_nop 0
    buffer_load_dwordx4 v222, s[68:71], s29 offen nt lds
    s_add_u32 s29, s44, 32768
    s_add_u32 m0, s72, 1024
    s_nop 0
    buffer_load_dwordx4 v222, s[68:71], s29 offen nt lds
    s_add_u32 s29, s44, 65536
    s_add_u32 m0, s72, 2048
    s_nop 0
    buffer_load_dwordx4 v222, s[68:71], s29 offen nt lds
    s_add_u32 s29, s44, 98304
    s_add_u32 m0, s72, 3072
    s_nop 0
    buffer_load_dwordx4 v222, s[68:71], s29 offen nt lds
    s_add_u32 s29, s44, 524288
    s_add_u32 m0, s72, 16384
    s_nop 0
    buffer_load_dwordx4 v222, s[68:71], s29 offen nt lds
    s_add_u32 s29, s44, 557056
    s_add_u32 m0, s72, 17408
    s_nop 0
    buffer_load_dwordx4 v222, s[68:71], s29 offen nt lds
    s_add_u32 s29, s44, 589824
    s_add_u32 m0, s72, 18432
    s_nop 0
    buffer_load_dwordx4 v222, s[68:71], s29 offen nt lds
    s_add_u32 s29, s44, 622592
    s_add_u32 m0, s72, 19456
    s_nop 0
    buffer_load_dwordx4 v222, s[68:71], s29 offen nt lds
    s_add_u32 s29, s44, 1048576
    s_add_u32 m0, s72, 32768
    s_nop 0
    buffer_load_dwordx4 v222, s[68:71], s29 offen nt lds
    s_add_u32 s29, s44, 1081344
    s_add_u32 m0, s72, 33792
    s_nop 0
    buffer_load_dwordx4 v222, s[68:71], s29 offen nt lds
    s_add_u32 s29, s44, 1114112
    s_add_u32 m0, s72, 34816
    s_nop 0
    buffer_load_dwordx4 v222, s[68:71], s29 offen nt lds
    s_add_u32 s29, s44, 1146880
    s_add_u32 m0, s72, 35840
    s_nop 0
    buffer_load_dwordx4 v222, s[68:71], s29 offen nt lds
    s_add_u32 s29, s44, 1572864
    s_add_u32 m0, s72, 49152
    s_nop 0
    buffer_load_dwordx4 v222, s[68:71], s29 offen nt lds
    s_add_u32 s29, s44, 1605632
    s_add_u32 m0, s72, 50176
    s_nop 0
    buffer_load_dwordx4 v222, s[68:71], s29 offen nt lds
    s_add_u32 s29, s44, 1638400
    s_add_u32 m0, s72, 51200
    s_nop 0
    buffer_load_dwordx4 v222, s[68:71], s29 offen nt lds
    s_add_u32 s29, s44, 1671168
    s_add_u32 m0, s72, 52224
    s_nop 0
    buffer_load_dwordx4 v222, s[68:71], s29 offen nt lds
    s_add_u32 s29, s44, 2097152
    s_add_u32 m0, s72, 65536
    s_nop 0
    buffer_load_dwordx4 v222, s[68:71], s29 offen nt lds
    s_add_u32 s29, s44, 2129920
    s_add_u32 m0, s72, 66560
    s_nop 0
    buffer_load_dwordx4 v222, s[68:71], s29 offen nt lds
    s_add_u32 s29, s44, 2162688
    s_add_u32 m0, s72, 67584
    s_nop 0
    buffer_load_dwordx4 v222, s[68:71], s29 offen nt lds
    s_add_u32 s29, s44, 2195456
    s_add_u32 m0, s72, 68608
    s_nop 0
    buffer_load_dwordx4 v222, s[68:71], s29 offen nt lds
    s_add_u32 s29, s44, 2621440
    s_add_u32 m0, s72, 81920
    s_nop 0
    buffer_load_dwordx4 v222, s[68:71], s29 offen nt lds
    s_add_u32 s29, s44, 2654208
    s_add_u32 m0, s72, 82944
    s_nop 0
    buffer_load_dwordx4 v222, s[68:71], s29 offen nt lds
    s_add_u32 s29, s44, 2686976
    s_add_u32 m0, s72, 83968
    s_nop 0
    buffer_load_dwordx4 v222, s[68:71], s29 offen nt lds
    s_add_u32 s29, s44, 2719744
    s_add_u32 m0, s72, 84992
    s_nop 0
    buffer_load_dwordx4 v222, s[68:71], s29 offen nt lds
    s_add_u32 s29, s44, 3145728
    s_add_u32 m0, s72, 98304
    s_nop 0
    buffer_load_dwordx4 v222, s[68:71], s29 offen nt lds
    s_add_u32 s29, s44, 3178496
    s_add_u32 m0, s72, 99328
    s_nop 0
    buffer_load_dwordx4 v222, s[68:71], s29 offen nt lds
    s_add_u32 s29, s44, 3211264
    s_add_u32 m0, s72, 100352
    s_nop 0
    buffer_load_dwordx4 v222, s[68:71], s29 offen nt lds
    s_add_u32 s29, s44, 3244032
    s_add_u32 m0, s72, 101376
    s_nop 0
    buffer_load_dwordx4 v222, s[68:71], s29 offen nt lds
    s_add_u32 s29, s44, 3670016
    s_add_u32 m0, s72, 114688
    s_nop 0
    buffer_load_dwordx4 v222, s[68:71], s29 offen nt lds
    s_add_u32 s29, s44, 3702784
    s_add_u32 m0, s72, 115712
    s_nop 0
    buffer_load_dwordx4 v222, s[68:71], s29 offen nt lds
    s_add_u32 s29, s44, 3735552
    s_add_u32 m0, s72, 116736
    s_nop 0
    buffer_load_dwordx4 v222, s[68:71], s29 offen nt lds
    s_add_u32 s29, s44, 3768320
    s_add_u32 m0, s72, 117760
    s_nop 0
    buffer_load_dwordx4 v222, s[68:71], s29 offen nt lds
    s_add_u32 s29, s44, 4194304
    s_add_u32 m0, s72, 131072
    s_nop 0
    buffer_load_dwordx4 v222, s[68:71], s29 offen nt lds
    s_add_u32 s29, s44, 4227072
    s_add_u32 m0, s72, 132096
    s_nop 0
    buffer_load_dwordx4 v222, s[68:71], s29 offen nt lds
    s_add_u32 s29, s44, 4259840
    s_add_u32 m0, s72, 133120
    s_nop 0
    buffer_load_dwordx4 v222, s[68:71], s29 offen nt lds
    s_add_u32 s29, s44, 4292608
    s_add_u32 m0, s72, 134144
    s_nop 0
    buffer_load_dwordx4 v222, s[68:71], s29 offen nt lds
    s_add_u32 s29, s44, 4718592
    s_add_u32 m0, s72, 147456
    s_nop 0
    buffer_load_dwordx4 v222, s[68:71], s29 offen nt lds
    s_add_u32 s29, s44, 4751360
    s_add_u32 m0, s72, 148480
    s_nop 0
    buffer_load_dwordx4 v222, s[68:71], s29 offen nt lds
    s_add_u32 s29, s44, 4784128
    s_add_u32 m0, s72, 149504
    s_nop 0
    buffer_load_dwordx4 v222, s[68:71], s29 offen nt lds
    s_add_u32 s29, s44, 4816896
    s_add_u32 m0, s72, 150528
    s_nop 0
    buffer_load_dwordx4 v222, s[68:71], s29 offen nt lds
    s_waitcnt vmcnt(36)
    s_barrier
    v_add_u32 v6, 0, v223
    ds_read_b64_tr_b16 a[0:1], v6 offset:0
    ds_read_b64_tr_b16 a[2:3], v6 offset:1024
    ds_read_b64_tr_b16 a[4:5], v6 offset:4096
    ds_read_b64_tr_b16 a[6:7], v6 offset:5120
    ds_read_b64_tr_b16 a[8:9], v6 offset:8192
    ds_read_b64_tr_b16 a[10:11], v6 offset:9216
    ds_read_b64_tr_b16 a[12:13], v6 offset:12288
    ds_read_b64_tr_b16 a[14:15], v6 offset:13312
    s_waitcnt lgkmcnt(0)
    s_waitcnt vmcnt(32)
    s_barrier
    v_add_u32 v6, 16384, v223
    ds_read_b64_tr_b16 a[16:17], v6 offset:0
    ds_read_b64_tr_b16 a[18:19], v6 offset:1024
    ds_read_b64_tr_b16 a[20:21], v6 offset:4096
    ds_read_b64_tr_b16 a[22:23], v6 offset:5120
    ds_read_b64_tr_b16 a[24:25], v6 offset:8192
    ds_read_b64_tr_b16 a[26:27], v6 offset:9216
    ds_read_b64_tr_b16 a[28:29], v6 offset:12288
    ds_read_b64_tr_b16 a[30:31], v6 offset:13312
    s_waitcnt lgkmcnt(0)
    s_waitcnt vmcnt(28)
    s_barrier
    v_add_u32 v6, 32768, v223
    ds_read_b64_tr_b16 a[32:33], v6 offset:0
    ds_read_b64_tr_b16 a[34:35], v6 offset:1024
    ds_read_b64_tr_b16 a[36:37], v6 offset:4096
    ds_read_b64_tr_b16 a[38:39], v6 offset:5120
    ds_read_b64_tr_b16 a[40:41], v6 offset:8192
    ds_read_b64_tr_b16 a[42:43], v6 offset:9216
    ds_read_b64_tr_b16 a[44:45], v6 offset:12288
    ds_read_b64_tr_b16 a[46:47], v6 offset:13312
    s_waitcnt lgkmcnt(0)
    s_waitcnt vmcnt(24)
    s_barrier
    v_add_u32 v6, 49152, v223
    ds_read_b64_tr_b16 a[48:49], v6 offset:0
    ds_read_b64_tr_b16 a[50:51], v6 offset:1024
    ds_read_b64_tr_b16 a[52:53], v6 offset:4096
    ds_read_b64_tr_b16 a[54:55], v6 offset:5120
    ds_read_b64_tr_b16 a[56:57], v6 offset:8192
    ds_read_b64_tr_b16 a[58:59], v6 offset:9216
    ds_read_b64_tr_b16 a[60:61], v6 offset:12288
    ds_read_b64_tr_b16 a[62:63], v6 offset:13312
    s_waitcnt lgkmcnt(0)
    s_waitcnt vmcnt(20)
    s_barrier
    v_add_u32 v6, 65536, v223
    ds_read_b64_tr_b16 a[64:65], v6 offset:0
    ds_read_b64_tr_b16 a[66:67], v6 offset:1024
    ds_read_b64_tr_b16 a[68:69], v6 offset:4096
    ds_read_b64_tr_b16 a[70:71], v6 offset:5120
    ds_read_b64_tr_b16 a[72:73], v6 offset:8192
    ds_read_b64_tr_b16 a[74:75], v6 offset:9216
    ds_read_b64_tr_b16 a[76:77], v6 offset:12288
    ds_read_b64_tr_b16 a[78:79], v6 offset:13312
    s_waitcnt lgkmcnt(0)
    s_waitcnt vmcnt(16)
    s_barrier
    v_add_u32 v6, 81920, v223
    ds_read_b64_tr_b16 a[80:81], v6 offset:0
    ds_read_b64_tr_b16 a[82:83], v6 offset:1024
    ds_read_b64_tr_b16 a[84:85], v6 offset:4096
    ds_read_b64_tr_b16 a[86:87], v6 offset:5120
    ds_read_b64_tr_b16 a[88:89], v6 offset:8192
    ds_read_b64_tr_b16 a[90:91], v6 offset:9216
    ds_read_b64_tr_b16 a[92:93], v6 offset:12288
    ds_read_b64_tr_b16 a[94:95], v6 offset:13312
    s_waitcnt lgkmcnt(0)
    s_waitcnt vmcnt(12)
    s_barrier
    v_add_u32 v6, 98304, v223
    ds_read_b64_tr_b16 a[96:97], v6 offset:0
    ds_read_b64_tr_b16 a[98:99], v6 offset:1024
    ds_read_b64_tr_b16 a[100:101], v6 offset:4096
    ds_read_b64_tr_b16 a[102:103], v6 offset:5120
    ds_read_b64_tr_b16 a[104:105], v6 offset:8192
    ds_read_b64_tr_b16 a[106:107], v6 offset:9216
    ds_read_b64_tr_b16 a[108:109], v6 offset:12288
    ds_read_b64_tr_b16 a[110:111], v6 offset:13312
    s_waitcnt lgkmcnt(0)
    s_waitcnt vmcnt(8)
    s_barrier
    v_add_u32 v6, 114688, v223
    ds_read_b64_tr_b16 a[112:113], v6 offset:0
    ds_read_b64_tr_b16 a[114:115], v6 offset:1024
    ds_read_b64_tr_b16 a[116:117], v6 offset:4096
    ds_read_b64_tr_b16 a[118:119], v6 offset:5120
    ds_read_b64_tr_b16 a[120:121], v6 offset:8192
    ds_read_b64_tr_b16 a[122:123], v6 offset:9216
    ds_read_b64_tr_b16 a[124:125], v6 offset:12288
    ds_read_b64_tr_b16 a[126:127], v6 offset:13312
    s_waitcnt lgkmcnt(0)
    s_waitcnt vmcnt(4)
    s_barrier
    v_add_u32 v6, 131072, v223
    ds_read_b64_tr_b16 a[128:129], v6 offset:0
    ds_read_b64_tr_b16 a[130:131], v6 offset:1024
    ds_read_b64_tr_b16 a[132:133], v6 offset:4096
    ds_read_b64_tr_b16 a[134:135], v6 offset:5120
    ds_read_b64_tr_b16 a[136:137], v6 offset:8192
    ds_read_b64_tr_b16 a[138:139], v6 offset:9216
    ds_read_b64_tr_b16 a[140:141], v6 offset:12288
    ds_read_b64_tr_b16 a[142:143], v6 offset:13312
    s_waitcnt lgkmcnt(0)
    s_waitcnt vmcnt(0)
    s_barrier
    v_add_u32 v6, 147456, v223
    ds_read_b64_tr_b16 a[144:145], v6 offset:0
    ds_read_b64_tr_b16 a[146:147], v6 offset:1024
    ds_read_b64_tr_b16 a[148:149], v6 offset:4096
    ds_read_b64_tr_b16 a[150:151], v6 offset:5120
    ds_read_b64_tr_b16 a[152:153], v6 offset:8192
    ds_read_b64_tr_b16 a[154:155], v6 offset:9216
    ds_read_b64_tr_b16 a[156:157], v6 offset:12288
    ds_read_b64_tr_b16 a[158:159], v6 offset:13312
    s_waitcnt lgkmcnt(0)
    s_barrier
    s_mov_b32 s47, 0
    s_mul_i32 s48, s47, 40960
    s_add_u32 s48, s48, 75497472
    s_add_u32 s48, s48, s50
    s_and_b32 s57, s47, 1
    s_mul_i32 s49, s57, 40960
    s_add_u32 s49, s49, s50
    s_lshl_b32 s51, s47, 13
    s_add_u32 s51, s51, s45
    s_lshl_b32 s31, s26, 11
    s_add_u32 s51, s51, s31
    s_lshl_b32 s52, s57, 14
    s_add_u32 s52, s52, s31
    s_add_u32 s59, s47, 1
    s_mov_b32 s60, 71303168
    s_mov_b32 s61, 1
L_fl_45:
    buffer_load_dword v12, v3, s[4:7], s60 offen sc1
    s_sub_u32 s27, s27, 1
    s_cbranch_scc0 L_ok_46
    s_mov_b32 s28, 23
    s_branch L_bail
L_ok_46:
    s_waitcnt vmcnt(0)
    v_cmp_gt_u32 vcc, s61, v12
    s_cbranch_vccnz L_fl_45
    s_add_u32 s30, s48, 0
    s_add_u32 m0, s49, 0
    s_nop 0
    buffer_load_dwordx4 v4, s[4:7], s30 offen offset:0 sc1 lds
    s_add_u32 m0, s49, 0
    s_nop 0
    buffer_load_dwordx4 v4, s[4:7], s30 offen offset:1024 sc1 lds
    s_add_u32 m0, s49, 0
    s_nop 0
    buffer_load_dwordx4 v4, s[4:7], s30 offen offset:2048 sc1 lds
    s_add_u32 m0, s49, 0
    s_nop 0
    buffer_load_dwordx4 v4, s[4:7], s30 offen offset:3072 sc1 lds
    s_add_u32 s30, s48, 4096
    s_add_u32 m0, s49, 4096
    s_nop 0
    buffer_load_dwordx4 v4, s[4:7], s30 offen offset:0 sc1 lds
    s_add_u32 m0, s49, 4096
    s_nop 0
    buffer_load_dwordx4 v4, s[4:7], s30 offen offset:1024 sc1 lds
    s_add_u32 m0, s49, 4096
    s_nop 0
    buffer_load_dwordx4 v4, s[4:7], s30 offen offset:2048 sc1 lds
    s_add_u32 m0, s49, 4096
    s_nop 0
    buffer_load_dwordx4 v4, s[4:7], s30 offen offset:3072 sc1 lds
    s_add_u32 s30, s48, 8192
    s_add_u32 m0, s49, 8192
    s_nop 0
    buffer_load_dwordx4 v4, s[4:7], s30 offen offset:0 sc1 lds
    s_add_u32 m0, s49, 8192
    s_nop 0
    buffer_load_dwordx4 v4, s[4:7], s30 offen offset:1024 sc1 lds
L_fl_47:
    buffer_load_dword v16, v15, s[4:7], 0 offen sc1
    s_sub_u32 s27, s27, 1
    s_cbranch_scc0 L_ok_48
    s_mov_b32 s28, 24
    s_branch L_bail
L_ok_48:
    s_waitcnt vmcnt(0)
    v_cmp_gt_u32 vcc, s59, v16
    s_cbranch_vccnz L_fl_47
    s_add_u32 s30, s51, 0
    s_add_u32 m0, s52, 81920
    s_nop 0
    buffer_load_dwordx4 v4, s[4:7], s30 offen offset:0 sc1 lds
    s_add_u32 s30, s51, 0
    s_add_u32 m0, s52, 81920
    s_nop 0
    buffer_load_dwordx4 v4, s[4:7], s30 offen offset:1024 sc1 lds
    s_add_u32 s30, s51, 524288
    s_add_u32 m0, s52, 90112
    s_nop 0
    buffer_load_dwordx4 v4, s[4:7], s30 offen offset:0 sc1 lds
    s_add_u32 s30, s51, 524288
    s_add_u32 m0, s52, 90112
    s_nop 0
    buffer_load_dwordx4 v4, s[4:7], s30 offen offset:1024 sc1 lds
    s_mov_b32 s60, 71303296
    s_mov_b32 s61, 1
    buffer_load_dword v12, v3, s[4:7], s60 offen sc1
    s_mov_b32 s46, 0
    s_mov_b32 s47, 1
    s_waitcnt vmcnt(0)
L_qatop_49:
    s_waitcnt vmcnt(3)
    s_barrier
    s_and_b32 s31, s46, 1
    s_mul_i32 s29, s31, 40960
    v_add_u32 v18, s29, v4
    s_lshl_b32 s31, s31, 14
    s_add_u32 s31, s31, 81920
    v_add_u32 v21, s31, v4
    v_add_u32 v27, s31, v22
    ds_read_b128 v[46:49], v18 offset:0
    ds_read_b128 v[50:53], v18 offset:1024
    ds_read_b128 v[54:57], v18 offset:2048
    ds_read_b128 v[58:61], v18 offset:3072
    s_waitcnt lgkmcnt(3)
    v_mfma_f32_32x32x16_bf16 v[30:45], a[0:3], v[46:49], 0
    s_mul_i32 s48, s47, 40960
    s_add_u32 s48, s48, 75497472
    s_add_u32 s48, s48, s50
    s_and_b32 s57, s47, 1
    s_mul_i32 s49, s57, 40960
    s_add_u32 s49, s49, s50
    s_lshl_b32 s51, s47, 13
    s_add_u32 s51, s51, s45
    s_lshl_b32 s31, s26, 11
    s_add_u32 s51, s51, s31
    s_lshl_b32 s52, s57, 14
    s_add_u32 s52, s52, s31
    s_add_u32 s59, s47, 1
    v_cmp_gt_u32 vcc, s61, v12
    ds_read_b128 v[46:49], v18 offset:4096
    s_waitcnt lgkmcnt(3)
    v_mfma_f32_32x32x16_bf16 v[30:45], a[4:7], v[50:53], v[30:45]
    ds_read_b128 v[50:53], v18 offset:5120
    s_waitcnt lgkmcnt(3)
    v_mfma_f32_32x32x16_bf16 v[30:45], a[8:11], v[54:57], v[30:45]
    s_cbranch_vccnz L_qa_50
L_qa_51:
    v_cmp_gt_u32 vcc, s59, v16
    ds_read_b128 v[54:57], v18 offset:6144
    s_waitcnt lgkmcnt(3)
    v_mfma_f32_32x32x16_bf16 v[30:45], a[12:15], v[58:61], v[30:45]
    ds_read_b128 v[58:61], v18 offset:7168
    s_waitcnt lgkmcnt(3)
    v_mfma_f32_32x32x16_bf16 v[30:45], a[16:19], v[46:49], v[30:45]
    s_cbranch_vccnz L_qa_52
L_qa_53:
    ds_read_b128 v[46:49], v18 offset:8192
    s_waitcnt lgkmcnt(3)
    v_mfma_f32_32x32x16_bf16 v[30:45], a[20:23], v[50:53], v[30:45]
    s_add_u32 s30, s48, 0
    s_add_u32 m0, s49, 0
    s_nop 0
    buffer_load_dwordx4 v4, s[4:7], s30 offen offset:0 sc1 lds
    ds_read_b128 v[50:53], v18 offset:9216
    s_waitcnt lgkmcnt(3)
    v_mfma_f32_32x32x16_bf16 v[30:45], a[24:27], v[54:57], v[30:45]
    ds_read_b128 v[54:57], v18 offset:10240
    s_waitcnt lgkmcnt(3)
    v_mfma_f32_32x32x16_bf16 v[30:45], a[28:31], v[58:61], v[30:45]
    s_add_u32 m0, s49, 0
    s_nop 0
    buffer_load_dwordx4 v4, s[4:7], s30 offen offset:1024 sc1 lds
    ds_read_b128 v[58:61], v18 offset:11264
    s_waitcnt lgkmcnt(3)
    v_mfma_f32_32x32x16_bf16 v[30:45], a[32:35], v[46:49], v[30:45]
    ds_read_b128 v[46:49], v18 offset:12288
    s_waitcnt lgkmcnt(3)
    v_mfma_f32_32x32x16_bf16 v[30:45], a[36:39], v[50:53], v[30:45]
    s_add_u32 m0, s49, 0
    s_nop 0
    buffer_load_dwordx4 v4, s[4:7], s30 offen offset:2048 sc1 lds
    ds_read_b128 v[50:53], v18 offset:13312
    s_waitcnt lgkmcnt(3)
    v_mfma_f32_32x32x16_bf16 v[30:45], a[40:43], v[54:57], v[30:45]
    ds_read_b128 v[54:57], v18 offset:14336
    s_waitcnt lgkmcnt(3)
    v_mfma_f32_32x32x16_bf16 v[30:45], a[44:47], v[58:61], v[30:45]
    s_add_u32 m0, s49, 0
    s_nop 0
    buffer_load_dwordx4 v4, s[4:7], s30 offen offset:3072 sc1 lds
    ds_read_b128 v[58:61], v18 offset:15360
    s_waitcnt lgkmcnt(3)
    v_mfma_f32_32x32x16_bf16 v[30:45], a[48:51], v[46:49], v[30:45]
    ds_read_b128 v[46:49], v18 offset:16384
    s_waitcnt lgkmcnt(3)
    v_mfma_f32_32x32x16_bf16 v[30:45], a[52:55], v[50:53], v[30:45]
    s_add_u32 s30, s48, 4096
    s_add_u32 m0, s49, 4096
    s_nop 0
    buffer_load_dwordx4 v4, s[4:7], s30 offen offset:0 sc1 lds
    ds_read_b128 v[50:53], v18 offset:17408
    s_waitcnt lgkmcnt(3)
    v_mfma_f32_32x32x16_bf16 v[30:45], a[56:59], v[54:57], v[30:45]
    ds_read_b128 v[54:57], v18 offset:18432
    s_waitcnt lgkmcnt(3)
    v_mfma_f32_32x32x16_bf16 v[30:45], a[60:63], v[58:61], v[30:45]
    s_add_u32 m0, s49, 4096
    s_nop 0
    buffer_load_dwordx4 v4, s[4:7], s30 offen offset:1024 sc1 lds
    ds_read_b128 v[58:61], v18 offset:19456
    s_waitcnt lgkmcnt(3)
    v_mfma_f32_32x32x16_bf16 v[30:45], a[64:67], v[46:49], v[30:45]
    ds_read_b128 v[46:49], v18 offset:20480
    s_waitcnt lgkmcnt(3)
    v_mfma_f32_32x32x16_bf16 v[30:45], a[68:71], v[50:53], v[30:45]
    s_add_u32 m0, s49, 4096
    s_nop 0
    buffer_load_dwordx4 v4, s[4:7], s30 offen offset:2048 sc1 lds
    ds_read_b128 v[50:53], v18 offset:21504
    s_waitcnt lgkmcnt(3)
    v_mfma_f32_32x32x16_bf16 v[30:45], a[72:75], v[54:57], v[30:45]
    ds_read_b128 v[54:57], v18 offset:22528
    s_waitcnt lgkmcnt(3)
    v_mfma_f32_32x32x16_bf16 v[30:45], a[76:79], v[58:61], v[30:45]
    s_add_u32 m0, s49, 4096
    s_nop 0
    buffer_load_dwordx4 v4, s[4:7], s30 offen offset:3072 sc1 lds
    ds_read_b128 v[58:61], v18 offset:23552
    s_waitcnt lgkmcnt(3)
    v_mfma_f32_32x32x16_bf16 v[30:45], a[80:83], v[46:49], v[30:45]
    s_waitcnt vmcnt(8)
    s_barrier
    v_mov_b32 v17, s46
    buffer_store_dword v17, v10, s[4:7], 0 offen sc1
    ds_read_b128 v[46:49], v18 offset:24576
    s_waitcnt lgkmcnt(3)
    v_mfma_f32_32x32x16_bf16 v[30:45], a[84:87], v[50:53], v[30:45]
    s_add_u32 s30, s48, 8192
    s_add_u32 m0, s49, 8192
    s_nop 0
    buffer_load_dwordx4 v4, s[4:7], s30 offen offset:0 sc1 lds
    ds_read_b128 v[50:53], v18 offset:25600
    s_waitcnt lgkmcnt(3)
    v_mfma_f32_32x32x16_bf16 v[30:45], a[88:91], v[54:57], v[30:45]
    ds_read_b128 v[54:57], v18 offset:26624
    s_waitcnt lgkmcnt(3)
    v_mfma_f32_32x32x16_bf16 v[30:45], a[92:95], v[58:61], v[30:45]
    s_add_u32 m0, s49, 8192
    s_nop 0
    buffer_load_dwordx4 v4, s[4:7], s30 offen offset:1024 sc1 lds
    ds_read_b128 v[58:61], v18 offset:27648
    s_waitcnt lgkmcnt(3)
    v_mfma_f32_32x32x16_bf16 v[30:45], a[96:99], v[46:49], v[30:45]
    ds_read_b128 v[46:49], v18 offset:28672
    s_waitcnt lgkmcnt(3)
    v_mfma_f32_32x32x16_bf16 v[30:45], a[100:103], v[50:53], v[30:45]
    s_add_u32 s30, s51, 0
    s_add_u32 m0, s52, 81920
    s_nop 0
    buffer_load_dwordx4 v4, s[4:7], s30 offen offset:0 sc1 lds
    ds_read_b128 v[50:53], v18 offset:29696
    s_waitcnt lgkmcnt(3)
    v_mfma_f32_32x32x16_bf16 v[30:45], a[104:107], v[54:57], v[30:45]
    ds_read_b128 v[54:57], v18 offset:30720
    s_waitcnt lgkmcnt(3)
    v_mfma_f32_32x32x16_bf16 v[30:45], a[108:111], v[58:61], v[30:45]
    s_add_u32 s30, s51, 0
    s_add_u32 m0, s52, 81920
    s_nop 0
    buffer_load_dwordx4 v4, s[4:7], s30 offen offset:1024 sc1 lds
    ds_read_b128 v[58:61], v18 offset:31744
    s_waitcnt lgkmcnt(3)
    v_mfma_f32_32x32x16_bf16 v[30:45], a[112:115], v[46:49], v[30:45]
    ds_read_b128 v[46:49], v18 offset:32768
    s_waitcnt lgkmcnt(3)
    v_mfma_f32_32x32x16_bf16 v[30:45], a[116:119], v[50:53], v[30:45]
    s_add_u32 s30, s51, 524288
    s_add_u32 m0, s52, 90112
    s_nop 0
    buffer_load_dwordx4 v4, s[4:7], s30 offen offset:0 sc1 lds
    ds_read_b128 v[50:53], v18 offset:33792
    s_waitcnt lgkmcnt(3)
    v_mfma_f32_32x32x16_bf16 v[30:45], a[120:123], v[54:57], v[30:45]
    ds_read_b128 v[54:57], v18 offset:34816
    s_waitcnt lgkmcnt(3)
    v_mfma_f32_32x32x16_bf16 v[30:45], a[124:127], v[58:61], v[30:45]
    s_add_u32 s30, s51, 524288
    s_add_u32 m0, s52, 90112
    s_nop 0
    buffer_load_dwordx4 v4, s[4:7], s30 offen offset:1024 sc1 lds
    ds_read_b128 v[58:61], v18 offset:35840
    s_waitcnt lgkmcnt(3)
    v_mfma_f32_32x32x16_bf16 v[30:45], a[128:131], v[46:49], v[30:45]
    ds_read_b128 v[46:49], v18 offset:36864
    s_waitcnt lgkmcnt(3)
    v_mfma_f32_32x32x16_bf16 v[30:45], a[132:135], v[50:53], v[30:45]
    ds_read_b128 v[50:53], v18 offset:37888
    s_waitcnt lgkmcnt(3)
    v_mfma_f32_32x32x16_bf16 v[30:45], a[136:139], v[54:57], v[30:45]
    ds_read_b128 v[54:57], v18 offset:38912
    s_waitcnt lgkmcnt(3)
    v_mfma_f32_32x32x16_bf16 v[30:45], a[140:143], v[58:61], v[30:45]
    ds_read_b128 v[58:61], v18 offset:39936
    s_waitcnt lgkmcnt(3)
    v_mfma_f32_32x32x16_bf16 v[30:45], a[144:147], v[46:49], v[30:45]
    s_waitcnt lgkmcnt(2)
    v_mfma_f32_32x32x16_bf16 v[30:45], a[148:151], v[50:53], v[30:45]
    s_waitcnt lgkmcnt(1)
    v_mfma_f32_32x32x16_bf16 v[30:45], a[152:155], v[54:57], v[30:45]
    s_add_u32 s47, s47, 1
    s_min_u32 s47, s47, 63
    s_mul_i32 s31, s47, 4682
    s_lshr_b32 s61, s31, 16
    s_mul_i32 s31, s61, 14
    s_sub_u32 s31, s47, s31
    s_lshl_b32 s31, s31, 7
    s_add_u32 s60, s31, 71303168
    s_add_u32 s61, s61, 1
    buffer_load_dword v12, v3, s[4:7], s60 offen sc1
    buffer_load_dword v16, v15, s[4:7], 0 offen sc1
    s_waitcnt lgkmcnt(0)
    v_mfma_f32_32x32x16_bf16 v[30:45], a[156:159], v[58:61], v[30:45]
    ds_read_b128 v[86:89], v21 offset:0
    ds_read_b128 v[90:93], v21 offset:1024
    ds_read_b128 v[94:97], v21 offset:2048
    ds_read_b128 v[98:101], v21 offset:3072
    ds_read_b128 v[102:105], v21 offset:4096
    ds_read_b128 v[106:109], v21 offset:5120
    ds_read_b128 v[110:113], v21 offset:6144
    ds_read_b128 v[114:117], v21 offset:7168
    s_add_u32 s55, s46, 1
    s_bfe_u32 s56, s46, 0x20001
    s_lshl_b32 s56, s56, 14
    s_and_b32 s31, s46, 1
    s_lshl_b32 s31, s31, 12
    s_add_u32 s56, s56, s31
    s_add_u32 s56, s56, s54
    s_mul_i32 s53, s46, 262144
    s_add_u32 s53, s53, 88080384
    buffer_load_dwordx2 v[150:151], v23, s[4:7], s56 offen sc1
    buffer_load_dwordx2 v[152:153], v24, s[4:7], s56 offen sc1
    buffer_load_dwordx2 v[154:155], v24, s[4:7], s56 offen offset:512 sc1
    v_cvt_pk_bf16_f32 v62, v30, v31
    v_cvt_pk_bf16_f32 v63, v32, v33
    v_cvt_pk_bf16_f32 v64, v34, v35
    v_cvt_pk_bf16_f32 v65, v36, v37
    v_cvt_pk_bf16_f32 v66, v38, v39
    v_cvt_pk_bf16_f32 v67, v40, v41
    v_cvt_pk_bf16_f32 v68, v42, v43
    v_cvt_pk_bf16_f32 v69, v44, v45
    ds_write_b128 v19, v[62:65] offset:0
    ds_write_b128 v19, v[66:69] offset:512
    s_waitcnt lgkmcnt(0)
    s_barrier
    ds_read_b128 v[70:73], v20 offset:0
    ds_read_b128 v[74:77], v20 offset:1024
    ds_read_b128 v[78:81], v20 offset:2048
    ds_read_b128 v[82:85], v20 offset:3072
    ds_read_b64_tr_b16 v[118:119], v27 offset:0
    ds_read_b64_tr_b16 v[120:121], v27 offset:4096
    ds_read_b64_tr_b16 v[122:123], v27 offset:512
    ds_read_b64_tr_b16 v[124:125], v27 offset:4608
    ds_read_b64_tr_b16 v[126:127], v27 offset:1024
    ds_read_b64_tr_b16 v[128:129], v27 offset:5120
    ds_read_b64_tr_b16 v[130:131], v27 offset:1536
    ds_read_b64_tr_b16 v[132:133], v27 offset:5632
    s_waitcnt lgkmcnt(11)
    v_mfma_f32_16x16x32_bf16 v[156:159], v[86:89], v[70:73], v[210:213]
    v_mfma_f32_16x16x32_bf16 v[160:163], v[102:105], v[70:73], v[214:217]
    s_waitcnt lgkmcnt(10)
    v_mfma_f32_16x16x32_bf16 v[156:159], v[90:93], v[74:77], v[156:159]
    v_mfma_f32_16x16x32_bf16 v[160:163], v[106:109], v[74:77], v[160:163]
    s_waitcnt lgkmcnt(9)
    v_mfma_f32_16x16x32_bf16 v[156:159], v[94:97], v[78:81], v[156:159]
    v_mfma_f32_16x16x32_bf16 v[160:163], v[110:113], v[78:81], v[160:163]
    s_waitcnt lgkmcnt(8)
    v_mfma_f32_16x16x32_bf16 v[156:159], v[98:101], v[82:85], v[156:159]
    v_mfma_f32_16x16x32_bf16 v[160:163], v[114:117], v[82:85], v[160:163]
    s_nop 4
    v_max3_f32 v6, v156, v157, v158
    s_nop 1
    v_max3_f32 v6, v6, v159, v160
    v_max3_f32 v6, v6, v161, v162
    v_max_f32 v6, v6, v163
    s_branch L_qa_55
L_qa_54:
    s_sub_u32 s27, s27, 1
    s_cbranch_scc0 L_ok_56
    s_mov_b32 s28, 27
    s_branch L_bail
L_ok_56:
    buffer_load_dwordx2 v[150:151], v23, s[4:7], s56 offen sc1
    buffer_load_dwordx2 v[152:153], v24, s[4:7], s56 offen sc1
    buffer_load_dwordx2 v[154:155], v24, s[4:7], s56 offen offset:512 sc1
L_qa_55:
    s_waitcnt vmcnt(0)
    v_min3_i32 v7, v150, v152, v154
    v_cmp_eq_u32 vcc, v14, v7
    s_cbranch_vccnz L_qa_54
    ds_write2_b32 v25, v150, v151 offset0:0 offset1:128
    s_waitcnt lgkmcnt(0)
    s_barrier
    buffer_store_dwordx4 v[218:221], v13, s[4:7], s56 offen sc1
    ds_read_b64_tr_b16 v[134:135], v26 offset:0
    ds_read_b64_tr_b16 v[136:137], v26 offset:256
    ds_read_b64_tr_b16 v[138:139], v26 offset:1024
    ds_read_b64_tr_b16 v[140:141], v26 offset:1280
    ds_read_b64_tr_b16 v[142:143], v26 offset:2048
    ds_read_b64_tr_b16 v[144:145], v26 offset:2304
    ds_read_b64_tr_b16 v[146:147], v26 offset:3072
    ds_read_b64_tr_b16 v[148:149], v26 offset:3328
    s_waitcnt lgkmcnt(6)
    v_mfma_f32_16x16x32_bf16 v[164:167], v[134:137], v[70:73], 0
    s_waitcnt lgkmcnt(4)
    v_mfma_f32_16x16x32_bf16 v[164:167], v[138:141], v[74:77], v[164:167]
    s_waitcnt lgkmcnt(2)
    v_mfma_f32_16x16x32_bf16 v[164:167], v[142:145], v[78:81], v[164:167]
    s_waitcnt lgkmcnt(0)
    v_mfma_f32_16x16x32_bf16 v[164:167], v[146:149], v[82:85], v[164:167]
    s_nop 7
    v_mul_f32 v164, s58, v164
    v_mul_f32 v165, s58, v165
    v_max3_f32 v6, v6, v164, v165
    v_mov_b32 v7, v6
    s_nop 1
    v_permlane32_swap_b32 v7, v6
    v_max_f32 v6, v6, v7
    v_mov_b32 v7, v6
    s_nop 1
    v_permlane16_swap_b32 v7, v6
    v_max_f32 v6, v6, v7
    v_sub_f32 v156, v156, v6
    v_exp_f32 v156, v156
    v_sub_f32 v157, v157, v6
    v_exp_f32 v157, v157
    v_sub_f32 v158, v158, v6
    v_exp_f32 v158, v158
    v_sub_f32 v159, v159, v6
    v_exp_f32 v159, v159
    v_sub_f32 v160, v160, v6
    v_exp_f32 v160, v160
    v_sub_f32 v161, v161, v6
    v_exp_f32 v161, v161
    v_sub_f32 v162, v162, v6
    v_exp_f32 v162, v162
    v_sub_f32 v163, v163, v6
    v_exp_f32 v163, v163
    v_sub_f32 v164, v164, v6
    v_exp_f32 v164, v164
    v_sub_f32 v165, v165, v6
    v_exp_f32 v165, v165
    v_cvt_pk_bf16_f32 v168, v156, v157
    v_cvt_pk_bf16_f32 v169, v158, v159
    v_cvt_pk_bf16_f32 v170, v160, v161
    v_cvt_pk_bf16_f32 v171, v162, v163
    v_cvt_pk_bf16_f32 v175, v164, v165
    v_cvt_pk_bf16_f32 v182, v164, v165
    v_mfma_f32_16x16x32_bf16 v[202:205], v[206:209], v[168:171], 0
    s_nop 0
    v_mfma_f32_16x16x32_bf16 v[202:205], v[206:209], v[182:185], v[202:205]
    v_mfma_f32_16x16x32_bf16 v[186:189], v[118:121], v[168:171], 0
    v_mfma_f32_16x16x32_bf16 v[186:189], v[152:155], v[182:185], v[186:189]
    v_mfma_f32_16x16x32_bf16 v[190:193], v[122:125], v[168:171], 0
    v_mfma_f32_16x16x32_bf16 v[190:193], v[152:155], v[174:177], v[190:193]
    v_rcp_f32 v6, v202
    v_mfma_f32_16x16x32_bf16 v[194:197], v[126:129], v[168:171], 0
    v_mfma_f32_16x16x32_bf16 v[194:197], v[152:155], v[180:183], v[194:197]
    v_mfma_f32_16x16x32_bf16 v[198:201], v[130:133], v[168:171], 0
    v_mfma_f32_16x16x32_bf16 v[198:201], v[152:155], v[172:175], v[198:201]
    v_mul_f32 v186, v186, v6
    v_mul_f32 v187, v187, v6
    v_mul_f32 v188, v188, v6
    v_mul_f32 v189, v189, v6
    v_mul_f32 v190, v190, v6
    v_mul_f32 v191, v191, v6
    v_mul_f32 v192, v192, v6
    v_mul_f32 v193, v193, v6
    v_cvt_pk_bf16_f32 v62, v186, v187
    v_cvt_pk_bf16_f32 v63, v188, v189
    v_cvt_pk_bf16_f32 v64, v190, v191
    v_cvt_pk_bf16_f32 v65, v192, v193
    buffer_store_dwordx4 v[62:65], v28, s[4:7], s53 offen offset:0 sc1
    v_mul_f32 v194, v194, v6
    v_mul_f32 v195, v195, v6
    v_mul_f32 v196, v196, v6
    v_mul_f32 v197, v197, v6
    v_mul_f32 v198, v198, v6
    v_mul_f32 v199, v199, v6
    v_mul_f32 v200, v200, v6
    v_mul_f32 v201, v201, v6
    v_cvt_pk_bf16_f32 v66, v194, v195
    v_cvt_pk_bf16_f32 v67, v196, v197
    v_cvt_pk_bf16_f32 v68, v198, v199
    v_cvt_pk_bf16_f32 v69, v200, v201
    buffer_store_dwordx4 v[66:69], v28, s[4:7], s53 offen offset:2048 sc1
    s_add_u32 s46, s46, 1
    s_cmp_lt_u32 s46, 64
    s_cbranch_scc1 L_qatop_49
    s_waitcnt vmcnt(0)
    s_barrier
    v_mov_b32 v17, 64
    buffer_store_dword v17, v10, s[4:7], 0 offen sc1
    s_endpgm
L_qa_50:
L_fl_57:
    buffer_load_dword v12, v3, s[4:7], s60 offen sc1
    s_sub_u32 s27, s27, 1
    s_cbranch_scc0 L_ok_58
    s_mov_b32 s28, 25
    s_branch L_bail
L_ok_58:
    s_waitcnt vmcnt(0)
    v_cmp_gt_u32 vcc, s61, v12
    s_cbranch_vccnz L_fl_57
    s_branch L_qa_51
L_qa_52:
L_fl_59:
    buffer_load_dword v16, v15, s[4:7], 0 offen sc1
    s_sub_u32 s27, s27, 1
    s_cbranch_scc0 L_ok_60
    s_mov_b32 s28, 26
    s_branch L_bail
L_ok_60:
    s_waitcnt vmcnt(0)
    v_cmp_gt_u32 vcc, s59, v16
    s_cbranch_vccnz L_fl_59
    s_branch L_qa_53
L_G2:
    s_getpc_b64 s[28:29]
    v_lshlrev_b32 v1, 4, v0
    global_load_dwordx4 v[252:255], v1, s[28:29]
    v_add_u32 v1, 4096, v1
    global_load_dwordx4 v[252:255], v1, s[28:29]
    v_and_b32 v1, 63, v0
    v_mov_b32 v3, 0
    v_lshlrev_b32 v4, 4, v1
    v_mov_b32 v10, 0
    s_mul_i32 s28, s24, 128
    v_add_u32 v10, s28, v10
    v_add_u32 v10, 71325696, v10
    v_mov_b32 v6, 1073741824
    v_cmp_eq_u32 vcc, 0, v0
    s_nop 1
    v_cndmask_b32 v10, v6, v10, vcc
    s_lshl_b32 s45, s24, 7
    s_lshl_b32 s47, s24, 12
    s_lshl_b32 s29, s26, 10
    s_add_u32 s47, s47, s29
    s_mul_i32 s64, s26, 10240
    s_cmp_eq_u32 s33, 1
    s_cbranch_scc1 L_cs_61
    v_mbcnt_lo_u32_b32 v7, -1, 0
    v_bfe_u32 v8, v7, 2, 1
    v_and_b32 v7, 3, v7
    v_lshlrev_b32 v7, 6, v7
    v_lshl_add_u32 v7, v8, 2, v7
L_cen_62:
    global_load_dword v8, v7, s[20:21] sc1
    s_sub_u32 s27, s27, 1
    s_cbranch_scc0 L_ok_64
    s_mov_b32 s28, 10
    s_branch L_bail
L_ok_64:
    s_waitcnt vmcnt(0)
L_cenc_63:
    s_mov_b32 s29, 0
    v_readlane_b32 s30, v8, 0
    s_nop 0
    s_add_u32 s29, s29, s30
    v_readlane_b32 s30, v8, 1
    s_nop 0
    s_add_u32 s29, s29, s30
    v_readlane_b32 s30, v8, 2
    s_nop 0
    s_add_u32 s29, s29, s30
    v_readlane_b32 s30, v8, 3
    s_nop 0
    s_add_u32 s29, s29, s30
    v_readlane_b32 s30, v8, 4
    s_nop 0
    s_add_u32 s29, s29, s30
    v_readlane_b32 s30, v8, 5
    s_nop 0
    s_add_u32 s29, s29, s30
    v_readlane_b32 s30, v8, 6
    s_nop 0
    s_add_u32 s29, s29, s30
    v_readlane_b32 s30, v8, 7
    s_nop 0
    s_add_u32 s29, s29, s30
    s_cmp_lt_u32 s29, 256
    s_cbranch_scc1 L_cen_62
    v_cmp_ne_u32 vcc, 32, v8
    s_cbranch_vccnz L_fallback
L_cs_61:
    s_mov_b32 s29, 71305216
    s_mov_b32 s30, 14
L_fl_65:
    buffer_load_dword v7, v3, s[4:7], s29 offen sc1
    s_sub_u32 s27, s27, 1
    s_cbranch_scc0 L_ok_66
    s_mov_b32 s28, 30
    s_branch L_bail
L_ok_66:
    s_waitcnt vmcnt(0)
    v_cmp_gt_u32 vcc, s30, v7
    s_cbranch_vccnz L_fl_65
    s_mov_b32 s48, s36
    s_and_b32 s49, s37, 0xffff
    s_mov_b32 s50, 2211840
    s_mov_b32 s51, 0x20000
    v_bfe_u32 v2, v1, 4, 1
    v_mul_u32_u24 v7, 2, v2
    v_bfe_u32 v2, v1, 0, 3
    v_mul_u32_u24 v8, 1, v2
    v_xor_b32 v7, v7, v8
    v_bfe_u32 v2, v1, 3, 3
    v_mul_u32_u24 v16, 3456, v2
    s_mul_i32 s28, s26, 55296
    v_add_u32 v16, s28, v16
    v_lshl_add_u32 v16, v7, 4, v16
    s_mov_b32 s52, s38
    s_and_b32 s53, s39, 0xffff
    s_mov_b32 s54, 2211840
    s_mov_b32 s55, 0x20000
    v_bfe_u32 v2, v1, 4, 1
    v_mul_u32_u24 v7, 2, v2
    v_add_u32 v7, 4, v7
    v_bfe_u32 v2, v1, 0, 3
    v_mul_u32_u24 v8, 1, v2
    v_xor_b32 v7, v7, v8
    v_bfe_u32 v2, v1, 3, 3
    v_mul_u32_u24 v17, 3456, v2
    s_mul_i32 s28, s26, 55296
    v_add_u32 v17, s28, v17
    v_lshl_add_u32 v17, v7, 4, v17
    v_bfe_u32 v2, v1, 4, 1
    v_mul_u32_u24 v7, 4, v2
    v_bfe_u32 v2, v1, 3, 1
    v_mul_u32_u24 v2, 2, v2
    v_add_u32 v7, v7, v2
    v_bfe_u32 v2, v1, 1, 1
    v_mul_u32_u24 v8, 1, v2
    s_mul_i32 s28, s26, 2
    v_add_u32 v8, s28, v8
    v_xor_b32 v7, v7, v8
    v_bfe_u32 v2, v1, 2, 2
    v_mul_u32_u24 v18, 128, v2
    v_bfe_u32 v2, v1, 5, 1
    v_mul_u32_u24 v2, 1024, v2
    v_add_u32 v18, v18, v2
    v_bfe_u32 v2, v1, 4, 1
    v_mul_u32_u24 v2, 8192, v2
    v_add_u32 v18, v18, v2
    v_bfe_u32 v2, v1, 0, 1
    v_mul_u32_u24 v2, 8, v2
    v_add_u32 v18, v18, v2
    v_lshl_add_u32 v18, v7, 4, v18
    s_lshl_b32 s46, s26, 11
    s_add_u32 s29, s45, 0
    s_add_u32 m0, s46, 0
    s_nop 0
    buffer_load_dwordx4 v16, s[48:51], s29 offen nt lds
    s_add_u32 s29, s45, 27648
    s_add_u32 m0, s46, 1024
    s_nop 0
    buffer_load_dwordx4 v16, s[48:51], s29 offen nt lds
    s_add_u32 s29, s45, 0
    s_add_u32 m0, s46, 8192
    s_nop 0
    buffer_load_dwordx4 v17, s[52:55], s29 offen nt lds
    s_add_u32 s29, s45, 27648
    s_add_u32 m0, s46, 9216
    s_nop 0
    buffer_load_dwordx4 v17, s[52:55], s29 offen nt lds
    s_add_u32 s29, s45, 221184
    s_add_u32 m0, s46, 16384
    s_nop 0
    buffer_load_dwordx4 v16, s[48:51], s29 offen nt lds
    s_add_u32 s29, s45, 248832
    s_add_u32 m0, s46, 17408
    s_nop 0
    buffer_load_dwordx4 v16, s[48:51], s29 offen nt lds
    s_add_u32 s29, s45, 221184
    s_add_u32 m0, s46, 24576
    s_nop 0
    buffer_load_dwordx4 v17, s[52:55], s29 offen nt lds
    s_add_u32 s29, s45, 248832
    s_add_u32 m0, s46, 25600
    s_nop 0
    buffer_load_dwordx4 v17, s[52:55], s29 offen nt lds
    s_add_u32 s29, s45, 442368
    s_add_u32 m0, s46, 32768
    s_nop 0
    buffer_load_dwordx4 v16, s[48:51], s29 offen nt lds
    s_add_u32 s29, s45, 470016
    s_add_u32 m0, s46, 33792
    s_nop 0
    buffer_load_dwordx4 v16, s[48:51], s29 offen nt lds
    s_add_u32 s29, s45, 442368
    s_add_u32 m0, s46, 40960
    s_nop 0
    buffer_load_dwordx4 v17, s[52:55], s29 offen nt lds
    s_add_u32 s29, s45, 470016
    s_add_u32 m0, s46, 41984
    s_nop 0
    buffer_load_dwordx4 v17, s[52:55], s29 offen nt lds
    s_add_u32 s29, s45, 663552
    s_add_u32 m0, s46, 49152
    s_nop 0
    buffer_load_dwordx4 v16, s[48:51], s29 offen nt lds
    s_add_u32 s29, s45, 691200
    s_add_u32 m0, s46, 50176
    s_nop 0
    buffer_load_dwordx4 v16, s[48:51], s29 offen nt lds
    s_add_u32 s29, s45, 663552
    s_add_u32 m0, s46, 57344
    s_nop 0
    buffer_load_dwordx4 v17, s[52:55], s29 offen nt lds
    s_add_u32 s29, s45, 691200
    s_add_u32 m0, s46, 58368
    s_nop 0
    buffer_load_dwordx4 v17, s[52:55], s29 offen nt lds
    s_add_u32 s29, s45, 884736
    s_add_u32 m0, s46, 65536
    s_nop 0
    buffer_load_dwordx4 v16, s[48:51], s29 offen nt lds
    s_add_u32 s29, s45, 912384
    s_add_u32 m0, s46, 66560
    s_nop 0
    buffer_load_dwordx4 v16, s[48:51], s29 offen nt lds
    s_add_u32 s29, s45, 884736
    s_add_u32 m0, s46, 73728
    s_nop 0
    buffer_load_dwordx4 v17, s[52:55], s29 offen nt lds
    s_add_u32 s29, s45, 912384
    s_add_u32 m0, s46, 74752
    s_nop 0
    buffer_load_dwordx4 v17, s[52:55], s29 offen nt lds
    s_add_u32 s29, s45, 1105920
    s_add_u32 m0, s46, 81920
    s_nop 0
    buffer_load_dwordx4 v16, s[48:51], s29 offen nt lds
    s_add_u32 s29, s45, 1133568
    s_add_u32 m0, s46, 82944
    s_nop 0
    buffer_load_dwordx4 v16, s[48:51], s29 offen nt lds
    s_add_u32 s29, s45, 1105920
    s_add_u32 m0, s46, 90112
    s_nop 0
    buffer_load_dwordx4 v17, s[52:55], s29 offen nt lds
    s_add_u32 s29, s45, 1133568
    s_add_u32 m0, s46, 91136
    s_nop 0
    buffer_load_dwordx4 v17, s[52:55], s29 offen nt lds
    s_add_u32 s29, s45, 1327104
    s_add_u32 m0, s46, 98304
    s_nop 0
    buffer_load_dwordx4 v16, s[48:51], s29 offen nt lds
    s_add_u32 s29, s45, 1354752
    s_add_u32 m0, s46, 99328
    s_nop 0
    buffer_load_dwordx4 v16, s[48:51], s29 offen nt lds
    s_add_u32 s29, s45, 1327104
    s_add_u32 m0, s46, 106496
    s_nop 0
    buffer_load_dwordx4 v17, s[52:55], s29 offen nt lds
    s_add_u32 s29, s45, 1354752
    s_add_u32 m0, s46, 107520
    s_nop 0
    buffer_load_dwordx4 v17, s[52:55], s29 offen nt lds
    s_add_u32 s29, s45, 1548288
    s_add_u32 m0, s46, 114688
    s_nop 0
    buffer_load_dwordx4 v16, s[48:51], s29 offen nt lds
    s_add_u32 s29, s45, 1575936
    s_add_u32 m0, s46, 115712
    s_nop 0
    buffer_load_dwordx4 v16, s[48:51], s29 offen nt lds
    s_add_u32 s29, s45, 1548288
    s_add_u32 m0, s46, 122880
    s_nop 0
    buffer_load_dwordx4 v17, s[52:55], s29 offen nt lds
    s_add_u32 s29, s45, 1575936
    s_add_u32 m0, s46, 123904
    s_nop 0
    buffer_load_dwordx4 v17, s[52:55], s29 offen nt lds
    s_add_u32 s29, s45, 1769472
    s_add_u32 m0, s46, 131072
    s_nop 0
    buffer_load_dwordx4 v16, s[48:51], s29 offen nt lds
    s_add_u32 s29, s45, 1797120
    s_add_u32 m0, s46, 132096
    s_nop 0
    buffer_load_dwordx4 v16, s[48:51], s29 offen nt lds
    s_add_u32 s29, s45, 1769472
    s_add_u32 m0, s46, 139264
    s_nop 0
    buffer_load_dwordx4 v17, s[52:55], s29 offen nt lds
    s_add_u32 s29, s45, 1797120
    s_add_u32 m0, s46, 140288
    s_nop 0
    buffer_load_dwordx4 v17, s[52:55], s29 offen nt lds
    s_add_u32 s29, s45, 1990656
    s_add_u32 m0, s46, 147456
    s_nop 0
    buffer_load_dwordx4 v16, s[48:51], s29 offen nt lds
    s_add_u32 s29, s45, 2018304
    s_add_u32 m0, s46, 148480
    s_nop 0
    buffer_load_dwordx4 v16, s[48:51], s29 offen nt lds
    s_add_u32 s29, s45, 1990656
    s_add_u32 m0, s46, 155648
    s_nop 0
    buffer_load_dwordx4 v17, s[52:55], s29 offen nt lds
    s_add_u32 s29, s45, 2018304
    s_add_u32 m0, s46, 156672
    s_nop 0
    buffer_load_dwordx4 v17, s[52:55], s29 offen nt lds
    s_waitcnt vmcnt(36)
    s_barrier
    v_add_u32 v6, 0, v18
    ds_read_b64_tr_b16 a[0:1], v6 offset:0
    ds_read_b64_tr_b16 a[2:3], v6 offset:512
    ds_read_b64_tr_b16 a[4:5], v6 offset:2048
    ds_read_b64_tr_b16 a[6:7], v6 offset:2560
    ds_read_b64_tr_b16 a[8:9], v6 offset:4096
    ds_read_b64_tr_b16 a[10:11], v6 offset:4608
    ds_read_b64_tr_b16 a[12:13], v6 offset:6144
    ds_read_b64_tr_b16 a[14:15], v6 offset:6656
    s_waitcnt lgkmcnt(0)
    s_waitcnt vmcnt(32)
    s_barrier
    v_add_u32 v6, 16384, v18
    ds_read_b64_tr_b16 a[16:17], v6 offset:0
    ds_read_b64_tr_b16 a[18:19], v6 offset:512
    ds_read_b64_tr_b16 a[20:21], v6 offset:2048
    ds_read_b64_tr_b16 a[22:23], v6 offset:2560
    ds_read_b64_tr_b16 a[24:25], v6 offset:4096
    ds_read_b64_tr_b16 a[26:27], v6 offset:4608
    ds_read_b64_tr_b16 a[28:29], v6 offset:6144
    ds_read_b64_tr_b16 a[30:31], v6 offset:6656
    s_waitcnt lgkmcnt(0)
    s_waitcnt vmcnt(28)
    s_barrier
    v_add_u32 v6, 32768, v18
    ds_read_b64_tr_b16 a[32:33], v6 offset:0
    ds_read_b64_tr_b16 a[34:35], v6 offset:512
    ds_read_b64_tr_b16 a[36:37], v6 offset:2048
    ds_read_b64_tr_b16 a[38:39], v6 offset:2560
    ds_read_b64_tr_b16 a[40:41], v6 offset:4096
    ds_read_b64_tr_b16 a[42:43], v6 offset:4608
    ds_read_b64_tr_b16 a[44:45], v6 offset:6144
    ds_read_b64_tr_b16 a[46:47], v6 offset:6656
    s_waitcnt lgkmcnt(0)
    s_waitcnt vmcnt(24)
    s_barrier
    v_add_u32 v6, 49152, v18
    ds_read_b64_tr_b16 a[48:49], v6 offset:0
    ds_read_b64_tr_b16 a[50:51], v6 offset:512
    ds_read_b64_tr_b16 a[52:53], v6 offset:2048
    ds_read_b64_tr_b16 a[54:55], v6 offset:2560
    ds_read_b64_tr_b16 a[56:57], v6 offset:4096
    ds_read_b64_tr_b16 a[58:59], v6 offset:4608
    ds_read_b64_tr_b16 a[60:61], v6 offset:6144
    ds_read_b64_tr_b16 a[62:63], v6 offset:6656
    s_waitcnt lgkmcnt(0)
    s_waitcnt vmcnt(20)
    s_barrier
    v_add_u32 v6, 65536, v18
    ds_read_b64_tr_b16 a[64:65], v6 offset:0
    ds_read_b64_tr_b16 a[66:67], v6 offset:512
    ds_read_b64_tr_b16 a[68:69], v6 offset:2048
    ds_read_b64_tr_b16 a[70:71], v6 offset:2560
    ds_read_b64_tr_b16 a[72:73], v6 offset:4096
    ds_read_b64_tr_b16 a[74:75], v6 offset:4608
    ds_read_b64_tr_b16 a[76:77], v6 offset:6144
    ds_read_b64_tr_b16 a[78:79], v6 offset:6656
    s_waitcnt lgkmcnt(0)
    s_waitcnt vmcnt(16)
    s_barrier
    v_add_u32 v6, 81920, v18
    ds_read_b64_tr_b16 a[80:81], v6 offset:0
    ds_read_b64_tr_b16 a[82:83], v6 offset:512
    ds_read_b64_tr_b16 a[84:85], v6 offset:2048
    ds_read_b64_tr_b16 a[86:87], v6 offset:2560
    ds_read_b64_tr_b16 a[88:89], v6 offset:4096
    ds_read_b64_tr_b16 a[90:91], v6 offset:4608
    ds_read_b64_tr_b16 a[92:93], v6 offset:6144
    ds_read_b64_tr_b16 a[94:95], v6 offset:6656
    s_waitcnt lgkmcnt(0)
    s_waitcnt vmcnt(12)
    s_barrier
    v_add_u32 v6, 98304, v18
    ds_read_b64_tr_b16 a[96:97], v6 offset:0
    ds_read_b64_tr_b16 a[98:99], v6 offset:512
    ds_read_b64_tr_b16 a[100:101], v6 offset:2048
    ds_read_b64_tr_b16 a[102:103], v6 offset:2560
    ds_read_b64_tr_b16 a[104:105], v6 offset:4096
    ds_read_b64_tr_b16 a[106:107], v6 offset:4608
    ds_read_b64_tr_b16 a[108:109], v6 offset:6144
    ds_read_b64_tr_b16 a[110:111], v6 offset:6656
    s_waitcnt lgkmcnt(0)
    s_waitcnt vmcnt(8)
    s_barrier
    v_add_u32 v6, 114688, v18
    ds_read_b64_tr_b16 a[112:113], v6 offset:0
    ds_read_b64_tr_b16 a[114:115], v6 offset:512
    ds_read_b64_tr_b16 a[116:117], v6 offset:2048
    ds_read_b64_tr_b16 a[118:119], v6 offset:2560
    ds_read_b64_tr_b16 a[120:121], v6 offset:4096
    ds_read_b64_tr_b16 a[122:123], v6 offset:4608
    ds_read_b64_tr_b16 a[124:125], v6 offset:6144
    ds_read_b64_tr_b16 a[126:127], v6 offset:6656
    s_waitcnt lgkmcnt(0)
    s_waitcnt vmcnt(4)
    s_barrier
    v_add_u32 v6, 131072, v18
    ds_read_b64_tr_b16 a[128:129], v6 offset:0
    ds_read_b64_tr_b16 a[130:131], v6 offset:512
    ds_read_b64_tr_b16 a[132:133], v6 offset:2048
    ds_read_b64_tr_b16 a[134:135], v6 offset:2560
    ds_read_b64_tr_b16 a[136:137], v6 offset:4096
    ds_read_b64_tr_b16 a[138:139], v6 offset:4608
    ds_read_b64_tr_b16 a[140:141], v6 offset:6144
    ds_read_b64_tr_b16 a[142:143], v6 offset:6656
    s_waitcnt lgkmcnt(0)
    s_waitcnt vmcnt(0)
    s_barrier
    v_add_u32 v6, 147456, v18
    ds_read_b64_tr_b16 a[144:145], v6 offset:0
    ds_read_b64_tr_b16 a[146:147], v6 offset:512
    ds_read_b64_tr_b16 a[148:149], v6 offset:2048
    ds_read_b64_tr_b16 a[150:151], v6 offset:2560
    ds_read_b64_tr_b16 a[152:153], v6 offset:4096
    ds_read_b64_tr_b16 a[154:155], v6 offset:4608
    ds_read_b64_tr_b16 a[156:157], v6 offset:6144
    ds_read_b64_tr_b16 a[158:159], v6 offset:6656
    s_waitcnt lgkmcnt(0)
    s_barrier
    s_mov_b32 s56, 71303168
    s_mov_b32 s57, 1
L_fl_67:
    buffer_load_dword v69, v3, s[4:7], s56 offen sc1
    s_sub_u32 s27, s27, 1
    s_cbranch_scc0 L_ok_68
    s_mov_b32 s28, 20
    s_branch L_bail
L_ok_68:
    s_waitcnt vmcnt(0)
    v_cmp_gt_u32 vcc, s57, v69
    s_cbranch_vccnz L_fl_67
    s_mov_b32 s59, 0
    s_mov_b32 s61, 0
    s_mul_i32 s62, s59, 40960
    s_add_u32 s62, s62, 75497472
    s_add_u32 s62, s62, s64
    s_add_u32 s63, s61, s64
    s_add_u32 s30, s62, 0
    s_add_u32 m0, s63, 0
    s_nop 0
    buffer_load_dwordx4 v4, s[4:7], s30 offen offset:0 sc1 lds
    s_add_u32 m0, s63, 0
    s_nop 0
    buffer_load_dwordx4 v4, s[4:7], s30 offen offset:1024 sc1 lds
    s_add_u32 m0, s63, 0
    s_nop 0
    buffer_load_dwordx4 v4, s[4:7], s30 offen offset:2048 sc1 lds
    s_add_u32 m0, s63, 0
    s_nop 0
    buffer_load_dwordx4 v4, s[4:7], s30 offen offset:3072 sc1 lds
    s_add_u32 s30, s62, 4096
    s_add_u32 m0, s63, 4096
    s_nop 0
    buffer_load_dwordx4 v4, s[4:7], s30 offen offset:0 sc1 lds
    s_add_u32 m0, s63, 4096
    s_nop 0
    buffer_load_dwordx4 v4, s[4:7], s30 offen offset:1024 sc1 lds
    s_add_u32 m0, s63, 4096
    s_nop 0
    buffer_load_dwordx4 v4, s[4:7], s30 offen offset:2048 sc1 lds
    s_add_u32 m0, s63, 4096
    s_nop 0
    buffer_load_dwordx4 v4, s[4:7], s30 offen offset:3072 sc1 lds
    s_add_u32 s30, s62, 8192
    s_add_u32 m0, s63, 8192
    s_nop 0
    buffer_load_dwordx4 v4, s[4:7], s30 offen offset:0 sc1 lds
    s_add_u32 m0, s63, 8192
    s_nop 0
    buffer_load_dwordx4 v4, s[4:7], s30 offen offset:1024 sc1 lds
    s_mov_b32 s56, 71303296
    s_mov_b32 s57, 1
L_fl_69:
    buffer_load_dword v69, v3, s[4:7], s56 offen sc1
    s_sub_u32 s27, s27, 1
    s_cbranch_scc0 L_ok_70
    s_mov_b32 s28, 20
    s_branch L_bail
L_ok_70:
    s_waitcnt vmcnt(0)
    v_cmp_gt_u32 vcc, s57, v69
    s_cbranch_vccnz L_fl_69
    s_mov_b32 s59, 1
    s_mov_b32 s61, 40960
    s_mul_i32 s62, s59, 40960
    s_add_u32 s62, s62, 75497472
    s_add_u32 s62, s62, s64
    s_add_u32 s63, s61, s64
    s_add_u32 s30, s62, 0
    s_add_u32 m0, s63, 0
    s_nop 0
    buffer_load_dwordx4 v4, s[4:7], s30 offen offset:0 sc1 lds
    s_add_u32 m0, s63, 0
    s_nop 0
    buffer_load_dwordx4 v4, s[4:7], s30 offen offset:1024 sc1 lds
    s_add_u32 m0, s63, 0
    s_nop 0
    buffer_load_dwordx4 v4, s[4:7], s30 offen offset:2048 sc1 lds
    s_add_u32 m0, s63, 0
    s_nop 0
    buffer_load_dwordx4 v4, s[4:7], s30 offen offset:3072 sc1 lds
    s_add_u32 s30, s62, 4096
    s_add_u32 m0, s63, 4096
    s_nop 0
    buffer_load_dwordx4 v4, s[4:7], s30 offen offset:0 sc1 lds
    s_add_u32 m0, s63, 4096
    s_nop 0
    buffer_load_dwordx4 v4, s[4:7], s30 offen offset:1024 sc1 lds
    s_add_u32 m0, s63, 4096
    s_nop 0
    buffer_load_dwordx4 v4, s[4:7], s30 offen offset:2048 sc1 lds
    s_add_u32 m0, s63, 4096
    s_nop 0
    buffer_load_dwordx4 v4, s[4:7], s30 offen offset:3072 sc1 lds
    s_add_u32 s30, s62, 8192
    s_add_u32 m0, s63, 8192
    s_nop 0
    buffer_load_dwordx4 v4, s[4:7], s30 offen offset:0 sc1 lds
    s_add_u32 m0, s63, 8192
    s_nop 0
    buffer_load_dwordx4 v4, s[4:7], s30 offen offset:1024 sc1 lds
    s_mov_b32 s56, 71303424
    s_mov_b32 s57, 1
    buffer_load_dword v69, v3, s[4:7], s56 offen sc1
    s_mov_b32 s58, 0
    s_mov_b32 s59, 2
    s_mov_b32 s60, 0
    s_mov_b32 s61, 81920
    s_waitcnt vmcnt(0)
L_g2top_71:
    s_waitcnt vmcnt(10)
    s_barrier
    v_add_u32 v68, s60, v4
    ds_read_b128 v[52:55], v68 offset:0
    ds_read_b128 v[56:59], v68 offset:1024
    ds_read_b128 v[60:63], v68 offset:2048
    ds_read_b128 v[64:67], v68 offset:3072
    s_waitcnt lgkmcnt(3)
    v_mfma_f32_32x32x16_bf16 v[20:35], a[0:3], v[52:55], 0
    s_sub_u32 s31, s58, 1
    s_max_i32 s31, s31, 0
    v_mov_b32 v70, s31
    buffer_store_dword v70, v10, s[4:7], 0 offen sc1
    ds_read_b128 v[52:55], v68 offset:4096
    s_waitcnt lgkmcnt(3)
    v_mfma_f32_32x32x16_bf16 v[20:35], a[4:7], v[56:59], v[20:35]
    v_mul_f32 v36, 0xbfb8aa3b, v36
    v_exp_f32 v36, v36
    v_mul_f32 v37, 0xbfb8aa3b, v37
    v_exp_f32 v37, v37
    ds_read_b128 v[56:59], v68 offset:5120
    s_waitcnt lgkmcnt(3)
    v_mfma_f32_32x32x16_bf16 v[20:35], a[8:11], v[60:63], v[20:35]
    v_mul_f32 v38, 0xbfb8aa3b, v38
    v_exp_f32 v38, v38
    v_mul_f32 v39, 0xbfb8aa3b, v39
    v_exp_f32 v39, v39
    ds_read_b128 v[60:63], v68 offset:6144
    s_waitcnt lgkmcnt(3)
    v_mfma_f32_32x32x16_bf16 v[20:35], a[12:15], v[64:67], v[20:35]
    v_mul_f32 v40, 0xbfb8aa3b, v40
    v_exp_f32 v40, v40
    v_mul_f32 v41, 0xbfb8aa3b, v41
    v_exp_f32 v41, v41
    ds_read_b128 v[64:67], v68 offset:7168
    s_waitcnt lgkmcnt(3)
    v_mfma_f32_32x32x16_bf16 v[20:35], a[16:19], v[52:55], v[20:35]
    v_mul_f32 v42, 0xbfb8aa3b, v42
    v_exp_f32 v42, v42
    v_mul_f32 v43, 0xbfb8aa3b, v43
    v_exp_f32 v43, v43
    ds_read_b128 v[52:55], v68 offset:8192
    s_waitcnt lgkmcnt(3)
    v_mfma_f32_32x32x16_bf16 v[20:35], a[20:23], v[56:59], v[20:35]
    v_add_f32 v36, 1.0, v36
    v_rcp_f32 v36, v36
    v_add_f32 v37, 1.0, v37
    v_rcp_f32 v37, v37
    ds_read_b128 v[56:59], v68 offset:9216
    s_waitcnt lgkmcnt(3)
    v_mfma_f32_32x32x16_bf16 v[20:35], a[24:27], v[60:63], v[20:35]
    v_add_f32 v38, 1.0, v38
    v_rcp_f32 v38, v38
    v_add_f32 v39, 1.0, v39
    v_rcp_f32 v39, v39
    ds_read_b128 v[60:63], v68 offset:10240
    s_waitcnt lgkmcnt(3)
    v_mfma_f32_32x32x16_bf16 v[20:35], a[28:31], v[64:67], v[20:35]
    v_add_f32 v40, 1.0, v40
    v_rcp_f32 v40, v40
    v_add_f32 v41, 1.0, v41
    v_rcp_f32 v41, v41
    ds_read_b128 v[64:67], v68 offset:11264
    s_waitcnt lgkmcnt(3)
    v_mfma_f32_32x32x16_bf16 v[20:35], a[32:35], v[52:55], v[20:35]
    v_add_f32 v42, 1.0, v42
    v_rcp_f32 v42, v42
    v_add_f32 v43, 1.0, v43
    v_rcp_f32 v43, v43
    ds_read_b128 v[52:55], v68 offset:12288
    s_waitcnt lgkmcnt(3)
    v_mfma_f32_32x32x16_bf16 v[20:35], a[36:39], v[56:59], v[20:35]
    v_mul_f32 v36, v36, v44
    v_mul_f32 v37, v37, v45
    v_mul_f32 v38, v38, v46
    v_mul_f32 v39, v39, v47
    ds_read_b128 v[56:59], v68 offset:13312
    s_waitcnt lgkmcnt(3)
    v_mfma_f32_32x32x16_bf16 v[20:35], a[40:43], v[60:63], v[20:35]
    v_mul_f32 v40, v40, v48
    v_mul_f32 v41, v41, v49
    v_mul_f32 v42, v42, v50
    v_mul_f32 v43, v43, v51
    ds_read_b128 v[60:63], v68 offset:14336
    s_waitcnt lgkmcnt(3)
    v_mfma_f32_32x32x16_bf16 v[20:35], a[44:47], v[64:67], v[20:35]
    v_cvt_pk_bf16_f32 v12, v36, v37
    v_cvt_pk_bf16_f32 v13, v38, v39
    v_cvt_pk_bf16_f32 v14, v40, v41
    v_cvt_pk_bf16_f32 v15, v42, v43
    ds_read_b128 v[64:67], v68 offset:15360
    s_waitcnt lgkmcnt(3)
    v_mfma_f32_32x32x16_bf16 v[20:35], a[48:51], v[52:55], v[20:35]
    s_mul_i32 s44, s58, 110592
    s_add_u32 s44, s44, 79581184
    s_add_u32 s44, s44, s47
    s_cmp_eq_u32 s58, 0
    s_cselect_b32 s44, 1073741824, s44
    buffer_store_dwordx4 v[12:15], v4, s[4:7], s44 offen sc1
    ds_read_b128 v[52:55], v68 offset:16384
    s_waitcnt lgkmcnt(3)
    v_mfma_f32_32x32x16_bf16 v[20:35], a[52:55], v[56:59], v[20:35]
    ds_read_b128 v[56:59], v68 offset:17408
    s_waitcnt lgkmcnt(3)
    v_mfma_f32_32x32x16_bf16 v[20:35], a[56:59], v[60:63], v[20:35]
    s_mul_i32 s62, s59, 40960
    s_add_u32 s62, s62, 75497472
    s_add_u32 s62, s62, s64
    s_add_u32 s63, s61, s64
    v_cmp_gt_u32 vcc, s57, v69
    ds_read_b128 v[60:63], v68 offset:18432
    s_waitcnt lgkmcnt(3)
    v_mfma_f32_32x32x16_bf16 v[20:35], a[60:63], v[64:67], v[20:35]
    s_cbranch_vccnz L_nf_73
L_nfok_74:
    s_add_u32 s59, s59, 1
    s_min_u32 s59, s59, 63
    s_mul_i32 s31, s59, 4682
    s_lshr_b32 s57, s31, 16
    s_mul_i32 s31, s57, 14
    s_sub_u32 s31, s59, s31
    s_lshl_b32 s31, s31, 7
    s_add_u32 s56, s31, 71303168
    s_add_u32 s57, s57, 1
    buffer_load_dword v69, v3, s[4:7], s56 offen sc1
    ds_read_b128 v[64:67], v68 offset:19456
    s_waitcnt lgkmcnt(3)
    v_mfma_f32_32x32x16_bf16 v[20:35], a[64:67], v[52:55], v[20:35]
    s_add_u32 s30, s62, 0
    s_add_u32 m0, s63, 0
    s_nop 0
    buffer_load_dwordx4 v4, s[4:7], s30 offen offset:0 sc1 lds
    ds_read_b128 v[52:55], v68 offset:20480
    s_waitcnt lgkmcnt(3)
    v_mfma_f32_32x32x16_bf16 v[20:35], a[68:71], v[56:59], v[20:35]
    ds_read_b128 v[56:59], v68 offset:21504
    s_waitcnt lgkmcnt(3)
    v_mfma_f32_32x32x16_bf16 v[20:35], a[72:75], v[60:63], v[20:35]
    s_add_u32 m0, s63, 0
    s_nop 0
    buffer_load_dwordx4 v4, s[4:7], s30 offen offset:1024 sc1 lds
    ds_read_b128 v[60:63], v68 offset:22528
    s_waitcnt lgkmcnt(3)
    v_mfma_f32_32x32x16_bf16 v[20:35], a[76:79], v[64:67], v[20:35]
    ds_read_b128 v[64:67], v68 offset:23552
    s_waitcnt lgkmcnt(3)
    v_mfma_f32_32x32x16_bf16 v[20:35], a[80:83], v[52:55], v[20:35]
    s_add_u32 m0, s63, 0
    s_nop 0
    buffer_load_dwordx4 v4, s[4:7], s30 offen offset:2048 sc1 lds
    ds_read_b128 v[52:55], v68 offset:24576
    s_waitcnt lgkmcnt(3)
    v_mfma_f32_32x32x16_bf16 v[20:35], a[84:87], v[56:59], v[20:35]
    ds_read_b128 v[56:59], v68 offset:25600
    s_waitcnt lgkmcnt(3)
    v_mfma_f32_32x32x16_bf16 v[20:35], a[88:91], v[60:63], v[20:35]
    s_add_u32 m0, s63, 0
    s_nop 0
    buffer_load_dwordx4 v4, s[4:7], s30 offen offset:3072 sc1 lds
    ds_read_b128 v[60:63], v68 offset:26624
    s_waitcnt lgkmcnt(3)
    v_mfma_f32_32x32x16_bf16 v[20:35], a[92:95], v[64:67], v[20:35]
    ds_read_b128 v[64:67], v68 offset:27648
    s_waitcnt lgkmcnt(3)
    v_mfma_f32_32x32x16_bf16 v[20:35], a[96:99], v[52:55], v[20:35]
    s_add_u32 s30, s62, 4096
    s_add_u32 m0, s63, 4096
    s_nop 0
    buffer_load_dwordx4 v4, s[4:7], s30 offen offset:0 sc1 lds
    ds_read_b128 v[52:55], v68 offset:28672
    s_waitcnt lgkmcnt(3)
    v_mfma_f32_32x32x16_bf16 v[20:35], a[100:103], v[56:59], v[20:35]
    ds_read_b128 v[56:59], v68 offset:29696
    s_waitcnt lgkmcnt(3)
    v_mfma_f32_32x32x16_bf16 v[20:35], a[104:107], v[60:63], v[20:35]
    s_add_u32 m0, s63, 4096
    s_nop 0
    buffer_load_dwordx4 v4, s[4:7], s30 offen offset:1024 sc1 lds
    ds_read_b128 v[60:63], v68 offset:30720
    s_waitcnt lgkmcnt(3)
    v_mfma_f32_32x32x16_bf16 v[20:35], a[108:111], v[64:67], v[20:35]
    ds_read_b128 v[64:67], v68 offset:31744
    s_waitcnt lgkmcnt(3)
    v_mfma_f32_32x32x16_bf16 v[20:35], a[112:115], v[52:55], v[20:35]
    s_add_u32 m0, s63, 4096
    s_nop 0
    buffer_load_dwordx4 v4, s[4:7], s30 offen offset:2048 sc1 lds
    ds_read_b128 v[52:55], v68 offset:32768
    s_waitcnt lgkmcnt(3)
    v_mfma_f32_32x32x16_bf16 v[20:35], a[116:119], v[56:59], v[20:35]
    ds_read_b128 v[56:59], v68 offset:33792
    s_waitcnt lgkmcnt(3)
    v_mfma_f32_32x32x16_bf16 v[20:35], a[120:123], v[60:63], v[20:35]
    s_add_u32 m0, s63, 4096
    s_nop 0
    buffer_load_dwordx4 v4, s[4:7], s30 offen offset:3072 sc1 lds
    ds_read_b128 v[60:63], v68 offset:34816
    s_waitcnt lgkmcnt(3)
    v_mfma_f32_32x32x16_bf16 v[20:35], a[124:127], v[64:67], v[20:35]
    ds_read_b128 v[64:67], v68 offset:35840
    s_waitcnt lgkmcnt(3)
    v_mfma_f32_32x32x16_bf16 v[20:35], a[128:131], v[52:55], v[20:35]
    s_add_u32 s30, s62, 8192
    s_add_u32 m0, s63, 8192
    s_nop 0
    buffer_load_dwordx4 v4, s[4:7], s30 offen offset:0 sc1 lds
    ds_read_b128 v[52:55], v68 offset:36864
    s_waitcnt lgkmcnt(3)
    v_mfma_f32_32x32x16_bf16 v[20:35], a[132:135], v[56:59], v[20:35]
    ds_read_b128 v[56:59], v68 offset:37888
    s_waitcnt lgkmcnt(3)
    v_mfma_f32_32x32x16_bf16 v[20:35], a[136:139], v[60:63], v[20:35]
    s_add_u32 m0, s63, 8192
    s_nop 0
    buffer_load_dwordx4 v4, s[4:7], s30 offen offset:1024 sc1 lds
    ds_read_b128 v[60:63], v68 offset:38912
    s_waitcnt lgkmcnt(3)
    v_mfma_f32_32x32x16_bf16 v[20:35], a[140:143], v[64:67], v[20:35]
    ds_read_b128 v[64:67], v68 offset:39936
    s_waitcnt lgkmcnt(3)
    v_mfma_f32_32x32x16_bf16 v[20:35], a[144:147], v[52:55], v[20:35]
    s_waitcnt lgkmcnt(2)
    v_mfma_f32_32x32x16_bf16 v[20:35], a[148:151], v[56:59], v[20:35]
    s_waitcnt lgkmcnt(1)
    v_mfma_f32_32x32x16_bf16 v[20:35], a[152:155], v[60:63], v[20:35]
    s_waitcnt lgkmcnt(0)
    v_mfma_f32_32x32x16_bf16 v[20:35], a[156:159], v[64:67], v[20:35]
    s_add_u32 s60, s60, 40960
    s_cmp_eq_u32 s60, 122880
    s_cselect_b32 s60, 0, s60
    s_add_u32 s61, s61, 40960
    s_cmp_eq_u32 s61, 122880
    s_cselect_b32 s61, 0, s61
    s_add_u32 s58, s58, 1
    s_waitcnt vmcnt(10)
    s_barrier
    v_add_u32 v68, s60, v4
    ds_read_b128 v[52:55], v68 offset:0
    ds_read_b128 v[56:59], v68 offset:1024
    ds_read_b128 v[60:63], v68 offset:2048
    ds_read_b128 v[64:67], v68 offset:3072
    s_waitcnt lgkmcnt(3)
    v_mfma_f32_32x32x16_bf16 v[36:51], a[0:3], v[52:55], 0
    s_sub_u32 s31, s58, 1
    s_max_i32 s31, s31, 0
    v_mov_b32 v70, s31
    buffer_store_dword v70, v10, s[4:7], 0 offen sc1
    ds_read_b128 v[52:55], v68 offset:4096
    s_waitcnt lgkmcnt(3)
    v_mfma_f32_32x32x16_bf16 v[36:51], a[4:7], v[56:59], v[36:51]
    v_mul_f32 v20, 0xbfb8aa3b, v20
    v_exp_f32 v20, v20
    v_mul_f32 v21, 0xbfb8aa3b, v21
    v_exp_f32 v21, v21
    ds_read_b128 v[56:59], v68 offset:5120
    s_waitcnt lgkmcnt(3)
    v_mfma_f32_32x32x16_bf16 v[36:51], a[8:11], v[60:63], v[36:51]
    v_mul_f32 v22, 0xbfb8aa3b, v22
    v_exp_f32 v22, v22
    v_mul_f32 v23, 0xbfb8aa3b, v23
    v_exp_f32 v23, v23
    ds_read_b128 v[60:63], v68 offset:6144
    s_waitcnt lgkmcnt(3)
    v_mfma_f32_32x32x16_bf16 v[36:51], a[12:15], v[64:67], v[36:51]
    v_mul_f32 v24, 0xbfb8aa3b, v24
    v_exp_f32 v24, v24
    v_mul_f32 v25, 0xbfb8aa3b, v25
    v_exp_f32 v25, v25
    ds_read_b128 v[64:67], v68 offset:7168
    s_waitcnt lgkmcnt(3)
    v_mfma_f32_32x32x16_bf16 v[36:51], a[16:19], v[52:55], v[36:51]
    v_mul_f32 v26, 0xbfb8aa3b, v26
    v_exp_f32 v26, v26
    v_mul_f32 v27, 0xbfb8aa3b, v27
    v_exp_f32 v27, v27
    ds_read_b128 v[52:55], v68 offset:8192
    s_waitcnt lgkmcnt(3)
    v_mfma_f32_32x32x16_bf16 v[36:51], a[20:23], v[56:59], v[36:51]
    v_add_f32 v20, 1.0, v20
    v_rcp_f32 v20, v20
    v_add_f32 v21, 1.0, v21
    v_rcp_f32 v21, v21
    ds_read_b128 v[56:59], v68 offset:9216
    s_waitcnt lgkmcnt(3)
    v_mfma_f32_32x32x16_bf16 v[36:51], a[24:27], v[60:63], v[36:51]
    v_add_f32 v22, 1.0, v22
    v_rcp_f32 v22, v22
    v_add_f32 v23, 1.0, v23
    v_rcp_f32 v23, v23
    ds_read_b128 v[60:63], v68 offset:10240
    s_waitcnt lgkmcnt(3)
    v_mfma_f32_32x32x16_bf16 v[36:51], a[28:31], v[64:67], v[36:51]
    v_add_f32 v24, 1.0, v24
    v_rcp_f32 v24, v24
    v_add_f32 v25, 1.0, v25
    v_rcp_f32 v25, v25
    ds_read_b128 v[64:67], v68 offset:11264
    s_waitcnt lgkmcnt(3)
    v_mfma_f32_32x32x16_bf16 v[36:51], a[32:35], v[52:55], v[36:51]
    v_add_f32 v26, 1.0, v26
    v_rcp_f32 v26, v26
    v_add_f32 v27, 1.0, v27
    v_rcp_f32 v27, v27
    ds_read_b128 v[52:55], v68 offset:12288
    s_waitcnt lgkmcnt(3)
    v_mfma_f32_32x32x16_bf16 v[36:51], a[36:39], v[56:59], v[36:51]
    v_mul_f32 v20, v20, v28
    v_mul_f32 v21, v21, v29
    v_mul_f32 v22, v22, v30
    v_mul_f32 v23, v23, v31
    ds_read_b128 v[56:59], v68 offset:13312
    s_waitcnt lgkmcnt(3)
    v_mfma_f32_32x32x16_bf16 v[36:51], a[40:43], v[60:63], v[36:51]
    v_mul_f32 v24, v24, v32
    v_mul_f32 v25, v25, v33
    v_mul_f32 v26, v26, v34
    v_mul_f32 v27, v27, v35
    ds_read_b128 v[60:63], v68 offset:14336
    s_waitcnt lgkmcnt(3)
    v_mfma_f32_32x32x16_bf16 v[36:51], a[44:47], v[64:67], v[36:51]
    v_cvt_pk_bf16_f32 v12, v20, v21
    v_cvt_pk_bf16_f32 v13, v22, v23
    v_cvt_pk_bf16_f32 v14, v24, v25
    v_cvt_pk_bf16_f32 v15, v26, v27
    ds_read_b128 v[64:67], v68 offset:15360
    s_waitcnt lgkmcnt(3)
    v_mfma_f32_32x32x16_bf16 v[36:51], a[48:51], v[52:55], v[36:51]
    s_mul_i32 s44, s58, 110592
    s_add_u32 s44, s44, 79581184
    s_add_u32 s44, s44, s47
    s_cmp_eq_u32 s58, 0
    s_cselect_b32 s44, 1073741824, s44
    buffer_store_dwordx4 v[12:15], v4, s[4:7], s44 offen sc1
    ds_read_b128 v[52:55], v68 offset:16384
    s_waitcnt lgkmcnt(3)
    v_mfma_f32_32x32x16_bf16 v[36:51], a[52:55], v[56:59], v[36:51]
    ds_read_b128 v[56:59], v68 offset:17408
    s_waitcnt lgkmcnt(3)
    v_mfma_f32_32x32x16_bf16 v[36:51], a[56:59], v[60:63], v[36:51]
    s_mul_i32 s62, s59, 40960
    s_add_u32 s62, s62, 75497472
    s_add_u32 s62, s62, s64
    s_add_u32 s63, s61, s64
    v_cmp_gt_u32 vcc, s57, v69
    ds_read_b128 v[60:63], v68 offset:18432
    s_waitcnt lgkmcnt(3)
    v_mfma_f32_32x32x16_bf16 v[36:51], a[60:63], v[64:67], v[36:51]
    s_cbranch_vccnz L_nf_75
L_nfok_76:
    s_add_u32 s59, s59, 1
    s_min_u32 s59, s59, 63
    s_mul_i32 s31, s59, 4682
    s_lshr_b32 s57, s31, 16
    s_mul_i32 s31, s57, 14
    s_sub_u32 s31, s59, s31
    s_lshl_b32 s31, s31, 7
    s_add_u32 s56, s31, 71303168
    s_add_u32 s57, s57, 1
    buffer_load_dword v69, v3, s[4:7], s56 offen sc1
    ds_read_b128 v[64:67], v68 offset:19456
    s_waitcnt lgkmcnt(3)
    v_mfma_f32_32x32x16_bf16 v[36:51], a[64:67], v[52:55], v[36:51]
    s_add_u32 s30, s62, 0
    s_add_u32 m0, s63, 0
    s_nop 0
    buffer_load_dwordx4 v4, s[4:7], s30 offen offset:0 sc1 lds
    ds_read_b128 v[52:55], v68 offset:20480
    s_waitcnt lgkmcnt(3)
    v_mfma_f32_32x32x16_bf16 v[36:51], a[68:71], v[56:59], v[36:51]
    ds_read_b128 v[56:59], v68 offset:21504
    s_waitcnt lgkmcnt(3)
    v_mfma_f32_32x32x16_bf16 v[36:51], a[72:75], v[60:63], v[36:51]
    s_add_u32 m0, s63, 0
    s_nop 0
    buffer_load_dwordx4 v4, s[4:7], s30 offen offset:1024 sc1 lds
    ds_read_b128 v[60:63], v68 offset:22528
    s_waitcnt lgkmcnt(3)
    v_mfma_f32_32x32x16_bf16 v[36:51], a[76:79], v[64:67], v[36:51]
    ds_read_b128 v[64:67], v68 offset:23552
    s_waitcnt lgkmcnt(3)
    v_mfma_f32_32x32x16_bf16 v[36:51], a[80:83], v[52:55], v[36:51]
    s_add_u32 m0, s63, 0
    s_nop 0
    buffer_load_dwordx4 v4, s[4:7], s30 offen offset:2048 sc1 lds
    ds_read_b128 v[52:55], v68 offset:24576
    s_waitcnt lgkmcnt(3)
    v_mfma_f32_32x32x16_bf16 v[36:51], a[84:87], v[56:59], v[36:51]
    ds_read_b128 v[56:59], v68 offset:25600
    s_waitcnt lgkmcnt(3)
    v_mfma_f32_32x32x16_bf16 v[36:51], a[88:91], v[60:63], v[36:51]
    s_add_u32 m0, s63, 0
    s_nop 0
    buffer_load_dwordx4 v4, s[4:7], s30 offen offset:3072 sc1 lds
    ds_read_b128 v[60:63], v68 offset:26624
    s_waitcnt lgkmcnt(3)
    v_mfma_f32_32x32x16_bf16 v[36:51], a[92:95], v[64:67], v[36:51]
    ds_read_b128 v[64:67], v68 offset:27648
    s_waitcnt lgkmcnt(3)
    v_mfma_f32_32x32x16_bf16 v[36:51], a[96:99], v[52:55], v[36:51]
    s_add_u32 s30, s62, 4096
    s_add_u32 m0, s63, 4096
    s_nop 0
    buffer_load_dwordx4 v4, s[4:7], s30 offen offset:0 sc1 lds
    ds_read_b128 v[52:55], v68 offset:28672
    s_waitcnt lgkmcnt(3)
    v_mfma_f32_32x32x16_bf16 v[36:51], a[100:103], v[56:59], v[36:51]
    ds_read_b128 v[56:59], v68 offset:29696
    s_waitcnt lgkmcnt(3)
    v_mfma_f32_32x32x16_bf16 v[36:51], a[104:107], v[60:63], v[36:51]
    s_add_u32 m0, s63, 4096
    s_nop 0
    buffer_load_dwordx4 v4, s[4:7], s30 offen offset:1024 sc1 lds
    ds_read_b128 v[60:63], v68 offset:30720
    s_waitcnt lgkmcnt(3)
    v_mfma_f32_32x32x16_bf16 v[36:51], a[108:111], v[64:67], v[36:51]
    ds_read_b128 v[64:67], v68 offset:31744
    s_waitcnt lgkmcnt(3)
    v_mfma_f32_32x32x16_bf16 v[36:51], a[112:115], v[52:55], v[36:51]
    s_add_u32 m0, s63, 4096
    s_nop 0
    buffer_load_dwordx4 v4, s[4:7], s30 offen offset:2048 sc1 lds
    ds_read_b128 v[52:55], v68 offset:32768
    s_waitcnt lgkmcnt(3)
    v_mfma_f32_32x32x16_bf16 v[36:51], a[116:119], v[56:59], v[36:51]
    ds_read_b128 v[56:59], v68 offset:33792
    s_waitcnt lgkmcnt(3)
    v_mfma_f32_32x32x16_bf16 v[36:51], a[120:123], v[60:63], v[36:51]
    s_add_u32 m0, s63, 4096
    s_nop 0
    buffer_load_dwordx4 v4, s[4:7], s30 offen offset:3072 sc1 lds
    ds_read_b128 v[60:63], v68 offset:34816
    s_waitcnt lgkmcnt(3)
    v_mfma_f32_32x32x16_bf16 v[36:51], a[124:127], v[64:67], v[36:51]
    ds_read_b128 v[64:67], v68 offset:35840
    s_waitcnt lgkmcnt(3)
    v_mfma_f32_32x32x16_bf16 v[36:51], a[128:131], v[52:55], v[36:51]
    s_add_u32 s30, s62, 8192
    s_add_u32 m0, s63, 8192
    s_nop 0
    buffer_load_dwordx4 v4, s[4:7], s30 offen offset:0 sc1 lds
    ds_read_b128 v[52:55], v68 offset:36864
    s_waitcnt lgkmcnt(3)
    v_mfma_f32_32x32x16_bf16 v[36:51], a[132:135], v[56:59], v[36:51]
    ds_read_b128 v[56:59], v68 offset:37888
    s_waitcnt lgkmcnt(3)
    v_mfma_f32_32x32x16_bf16 v[36:51], a[136:139], v[60:63], v[36:51]
    s_add_u32 m0, s63, 8192
    s_nop 0
    buffer_load_dwordx4 v4, s[4:7], s30 offen offset:1024 sc1 lds
    ds_read_b128 v[60:63], v68 offset:38912
    s_waitcnt lgkmcnt(3)
    v_mfma_f32_32x32x16_bf16 v[36:51], a[140:143], v[64:67], v[36:51]
    ds_read_b128 v[64:67], v68 offset:39936
    s_waitcnt lgkmcnt(3)
    v_mfma_f32_32x32x16_bf16 v[36:51], a[144:147], v[52:55], v[36:51]
    s_waitcnt lgkmcnt(2)
    v_mfma_f32_32x32x16_bf16 v[36:51], a[148:151], v[56:59], v[36:51]
    s_waitcnt lgkmcnt(1)
    v_mfma_f32_32x32x16_bf16 v[36:51], a[152:155], v[60:63], v[36:51]
    s_waitcnt lgkmcnt(0)
    v_mfma_f32_32x32x16_bf16 v[36:51], a[156:159], v[64:67], v[36:51]
    s_add_u32 s60, s60, 40960
    s_cmp_eq_u32 s60, 122880
    s_cselect_b32 s60, 0, s60
    s_add_u32 s61, s61, 40960
    s_cmp_eq_u32 s61, 122880
    s_cselect_b32 s61, 0, s61
    s_add_u32 s58, s58, 1
    s_cmp_lt_u32 s58, 64
    s_cbranch_scc1 L_g2top_71
    s_nop 2
    v_mul_f32 v36, 0xbfb8aa3b, v36
    v_exp_f32 v36, v36
    v_mul_f32 v37, 0xbfb8aa3b, v37
    v_exp_f32 v37, v37
    v_mul_f32 v38, 0xbfb8aa3b, v38
    v_exp_f32 v38, v38
    v_mul_f32 v39, 0xbfb8aa3b, v39
    v_exp_f32 v39, v39
    v_mul_f32 v40, 0xbfb8aa3b, v40
    v_exp_f32 v40, v40
    v_mul_f32 v41, 0xbfb8aa3b, v41
    v_exp_f32 v41, v41
    v_mul_f32 v42, 0xbfb8aa3b, v42
    v_exp_f32 v42, v42
    v_mul_f32 v43, 0xbfb8aa3b, v43
    v_exp_f32 v43, v43
    v_add_f32 v36, 1.0, v36
    v_rcp_f32 v36, v36
    v_add_f32 v37, 1.0, v37
    v_rcp_f32 v37, v37
    v_add_f32 v38, 1.0, v38
    v_rcp_f32 v38, v38
    v_add_f32 v39, 1.0, v39
    v_rcp_f32 v39, v39
    v_add_f32 v40, 1.0, v40
    v_rcp_f32 v40, v40
    v_add_f32 v41, 1.0, v41
    v_rcp_f32 v41, v41
    v_add_f32 v42, 1.0, v42
    v_rcp_f32 v42, v42
    v_add_f32 v43, 1.0, v43
    v_rcp_f32 v43, v43
    v_mul_f32 v36, v36, v44
    v_mul_f32 v37, v37, v45
    v_mul_f32 v38, v38, v46
    v_mul_f32 v39, v39, v47
    v_mul_f32 v40, v40, v48
    v_mul_f32 v41, v41, v49
    v_mul_f32 v42, v42, v50
    v_mul_f32 v43, v43, v51
    v_cvt_pk_bf16_f32 v12, v36, v37
    v_cvt_pk_bf16_f32 v13, v38, v39
    v_cvt_pk_bf16_f32 v14, v40, v41
    v_cvt_pk_bf16_f32 v15, v42, v43
    s_mul_i32 s44, s58, 110592
    s_add_u32 s44, s44, 79581184
    s_add_u32 s44, s44, s47
    s_cmp_eq_u32 s58, 0
    s_cselect_b32 s44, 1073741824, s44
    buffer_store_dwordx4 v[12:15], v4, s[4:7], s44 offen sc1
    s_waitcnt vmcnt(0)
    s_barrier
    v_mov_b32 v70, 64
    buffer_store_dword v70, v10, s[4:7], 0 offen sc1
    s_endpgm
L_nf_73:
L_fl_77:
    buffer_load_dword v69, v3, s[4:7], s56 offen sc1
    s_sub_u32 s27, s27, 1
    s_cbranch_scc0 L_ok_78
    s_mov_b32 s28, 21
    s_branch L_bail
L_ok_78:
    s_waitcnt vmcnt(0)
    v_cmp_gt_u32 vcc, s57, v69
    s_cbranch_vccnz L_fl_77
    s_branch L_nfok_74
L_nf_75:
L_fl_79:
    buffer_load_dword v69, v3, s[4:7], s56 offen sc1
    s_sub_u32 s27, s27, 1
    s_cbranch_scc0 L_ok_80
    s_mov_b32 s28, 21
    s_branch L_bail
L_ok_80:
    s_waitcnt vmcnt(0)
    v_cmp_gt_u32 vcc, s57, v69
    s_cbranch_vccnz L_fl_79
    s_branch L_nfok_76
L_G3:
    s_getpc_b64 s[28:29]
    v_lshlrev_b32 v1, 4, v0
    global_load_dwordx4 v[252:255], v1, s[28:29]
    v_add_u32 v1, 4096, v1
    global_load_dwordx4 v[252:255], v1, s[28:29]
    v_and_b32 v1, 63, v0
    v_mov_b32 v3, 0
    v_lshlrev_b32 v4, 4, v1
    s_mul_i32 s44, s24, 52
    s_lshr_b32 s44, s44, 8
    s_mul_i32 s45, s44, 5
    s_sub_u32 s45, s24, s45
    v_mov_b32 v10, 0
    s_mul_i32 s28, s24, 128
    v_add_u32 v10, s28, v10
    v_add_u32 v10, 71334912, v10
    v_mov_b32 v6, 1073741824
    v_cmp_eq_u32 vcc, 0, v0
    s_nop 1
    v_cndmask_b32 v10, v6, v10, vcc
    v_lshrrev_b32 v11, 2, v1
    v_min_u32 v11, 8, v11
    v_lshlrev_b32 v11, 7, v11
    s_mul_i32 s29, s44, 1152
    s_add_u32 s29, s29, 71325696
    v_add_u32 v11, s29, v11
    s_mul_i32 s47, s44, 737280
    s_lshl_b32 s29, s45, 8
    s_add_u32 s47, s47, s29
    s_lshl_b32 s48, s24, 13
    s_lshl_b32 s29, s26, 11
    s_add_u32 s48, s48, s29
    s_mul_i32 s49, s44, 36864
    s_mov_b32 s50, 0
    s_mul_i32 s58, s26, 9216
    s_cmp_eq_u32 s33, 1
    s_cbranch_scc1 L_cs_81
    v_mbcnt_lo_u32_b32 v7, -1, 0
    v_bfe_u32 v8, v7, 2, 1
    v_and_b32 v7, 3, v7
    v_lshlrev_b32 v7, 6, v7
    v_lshl_add_u32 v7, v8, 2, v7
L_cen_82:
    global_load_dword v8, v7, s[20:21] sc1
    s_sub_u32 s27, s27, 1
    s_cbranch_scc0 L_ok_84
    s_mov_b32 s28, 10
    s_branch L_bail
L_ok_84:
    s_waitcnt vmcnt(0)
L_cenc_83:
    s_mov_b32 s29, 0
    v_readlane_b32 s30, v8, 0
    s_nop 0
    s_add_u32 s29, s29, s30
    v_readlane_b32 s30, v8, 1
    s_nop 0
    s_add_u32 s29, s29, s30
    v_readlane_b32 s30, v8, 2
    s_nop 0
    s_add_u32 s29, s29, s30
    v_readlane_b32 s30, v8, 3
    s_nop 0
    s_add_u32 s29, s29, s30
    v_readlane_b32 s30, v8, 4
    s_nop 0
    s_add_u32 s29, s29, s30
    v_readlane_b32 s30, v8, 5
    s_nop 0
    s_add_u32 s29, s29, s30
    v_readlane_b32 s30, v8, 6
    s_nop 0
    s_add_u32 s29, s29, s30
    v_readlane_b32 s30, v8, 7
    s_nop 0
    s_add_u32 s29, s29, s30
    s_cmp_lt_u32 s29, 256
    s_cbranch_scc1 L_cen_82
    v_cmp_ne_u32 vcc, 32, v8
    s_cbranch_vccnz L_fallback
L_cs_81:
    s_mov_b32 s29, 71305216
    s_mov_b32 s30, 16
L_fl_85:
    buffer_load_dword v7, v3, s[4:7], s29 offen sc1
    s_sub_u32 s27, s27, 1
    s_cbranch_scc0 L_ok_86
    s_mov_b32 s28, 30
    s_branch L_bail
L_ok_86:
    s_waitcnt vmcnt(0)
    v_cmp_gt_u32 vcc, s30, v7
    s_cbranch_vccnz L_fl_85
    s_mov_b32 s60, s40
    s_and_b32 s61, s41, 0xffff
    s_mov_b32 s62, 2211840
    s_mov_b32 s63, 0x20000
    v_bfe_u32 v2, v1, 4, 2
    v_mul_u32_u24 v7, 4, v2
    v_bfe_u32 v2, v1, 0, 4
    v_mul_u32_u24 v8, 1, v2
    v_xor_b32 v7, v7, v8
    v_bfe_u32 v2, v1, 4, 2
    v_mul_u32_u24 v71, 1280, v2
    s_mul_i32 s28, s26, 20480
    v_add_u32 v71, s28, v71
    v_lshl_add_u32 v71, v7, 4, v71
    v_bfe_u32 v2, v1, 2, 2
    v_mul_u32_u24 v7, 4, v2
    v_bfe_u32 v2, v1, 4, 1
    v_mul_u32_u24 v8, 2, v2
    v_bfe_u32 v2, v1, 1, 1
    v_mul_u32_u24 v2, 1, v2
    v_add_u32 v8, v8, v2
    s_mul_i32 s28, s26, 4
    v_add_u32 v8, s28, v8
    v_xor_b32 v7, v7, v8
    v_bfe_u32 v2, v1, 2, 2
    v_mul_u32_u24 v72, 256, v2
    v_bfe_u32 v2, v1, 5, 1
    v_mul_u32_u24 v2, 1024, v2
    v_add_u32 v72, v72, v2
    v_bfe_u32 v2, v1, 0, 1
    v_mul_u32_u24 v2, 8, v2
    v_add_u32 v72, v72, v2
    v_lshl_add_u32 v72, v7, 4, v72
    s_lshl_b32 s64, s26, 12
    s_add_u32 s29, s47, 0
    s_add_u32 m0, s64, 0
    s_nop 0
    buffer_load_dwordx4 v71, s[60:63], s29 offen nt lds
    s_add_u32 s29, s47, 5120
    s_add_u32 m0, s64, 1024
    s_nop 0
    buffer_load_dwordx4 v71, s[60:63], s29 offen nt lds
    s_add_u32 s29, s47, 10240
    s_add_u32 m0, s64, 2048
    s_nop 0
    buffer_load_dwordx4 v71, s[60:63], s29 offen nt lds
    s_add_u32 s29, s47, 15360
    s_add_u32 m0, s64, 3072
    s_nop 0
    buffer_load_dwordx4 v71, s[60:63], s29 offen nt lds
    s_add_u32 s29, s47, 81920
    s_add_u32 m0, s64, 16384
    s_nop 0
    buffer_load_dwordx4 v71, s[60:63], s29 offen nt lds
    s_add_u32 s29, s47, 87040
    s_add_u32 m0, s64, 17408
    s_nop 0
    buffer_load_dwordx4 v71, s[60:63], s29 offen nt lds
    s_add_u32 s29, s47, 92160
    s_add_u32 m0, s64, 18432
    s_nop 0
    buffer_load_dwordx4 v71, s[60:63], s29 offen nt lds
    s_add_u32 s29, s47, 97280
    s_add_u32 m0, s64, 19456
    s_nop 0
    buffer_load_dwordx4 v71, s[60:63], s29 offen nt lds
    s_add_u32 s29, s47, 163840
    s_add_u32 m0, s64, 32768
    s_nop 0
    buffer_load_dwordx4 v71, s[60:63], s29 offen nt lds
    s_add_u32 s29, s47, 168960
    s_add_u32 m0, s64, 33792
    s_nop 0
    buffer_load_dwordx4 v71, s[60:63], s29 offen nt lds
    s_add_u32 s29, s47, 174080
    s_add_u32 m0, s64, 34816
    s_nop 0
    buffer_load_dwordx4 v71, s[60:63], s29 offen nt lds
    s_add_u32 s29, s47, 179200
    s_add_u32 m0, s64, 35840
    s_nop 0
    buffer_load_dwordx4 v71, s[60:63], s29 offen nt lds
    s_add_u32 s29, s47, 245760
    s_add_u32 m0, s64, 49152
    s_nop 0
    buffer_load_dwordx4 v71, s[60:63], s29 offen nt lds
    s_add_u32 s29, s47, 250880
    s_add_u32 m0, s64, 50176
    s_nop 0
    buffer_load_dwordx4 v71, s[60:63], s29 offen nt lds
    s_add_u32 s29, s47, 256000
    s_add_u32 m0, s64, 51200
    s_nop 0
    buffer_load_dwordx4 v71, s[60:63], s29 offen nt lds
    s_add_u32 s29, s47, 261120
    s_add_u32 m0, s64, 52224
    s_nop 0
    buffer_load_dwordx4 v71, s[60:63], s29 offen nt lds
    s_add_u32 s29, s47, 327680
    s_add_u32 m0, s64, 65536
    s_nop 0
    buffer_load_dwordx4 v71, s[60:63], s29 offen nt lds
    s_add_u32 s29, s47, 332800
    s_add_u32 m0, s64, 66560
    s_nop 0
    buffer_load_dwordx4 v71, s[60:63], s29 offen nt lds
    s_add_u32 s29, s47, 337920
    s_add_u32 m0, s64, 67584
    s_nop 0
    buffer_load_dwordx4 v71, s[60:63], s29 offen nt lds
    s_add_u32 s29, s47, 343040
    s_add_u32 m0, s64, 68608
    s_nop 0
    buffer_load_dwordx4 v71, s[60:63], s29 offen nt lds
    s_add_u32 s29, s47, 409600
    s_add_u32 m0, s64, 81920
    s_nop 0
    buffer_load_dwordx4 v71, s[60:63], s29 offen nt lds
    s_add_u32 s29, s47, 414720
    s_add_u32 m0, s64, 82944
    s_nop 0
    buffer_load_dwordx4 v71, s[60:63], s29 offen nt lds
    s_add_u32 s29, s47, 419840
    s_add_u32 m0, s64, 83968
    s_nop 0
    buffer_load_dwordx4 v71, s[60:63], s29 offen nt lds
    s_add_u32 s29, s47, 424960
    s_add_u32 m0, s64, 84992
    s_nop 0
    buffer_load_dwordx4 v71, s[60:63], s29 offen nt lds
    s_add_u32 s29, s47, 491520
    s_add_u32 m0, s64, 98304
    s_nop 0
    buffer_load_dwordx4 v71, s[60:63], s29 offen nt lds
    s_add_u32 s29, s47, 496640
    s_add_u32 m0, s64, 99328
    s_nop 0
    buffer_load_dwordx4 v71, s[60:63], s29 offen nt lds
    s_add_u32 s29, s47, 501760
    s_add_u32 m0, s64, 100352
    s_nop 0
    buffer_load_dwordx4 v71, s[60:63], s29 offen nt lds
    s_add_u32 s29, s47, 506880
    s_add_u32 m0, s64, 101376
    s_nop 0
    buffer_load_dwordx4 v71, s[60:63], s29 offen nt lds
    s_add_u32 s29, s47, 573440
    s_add_u32 m0, s64, 114688
    s_nop 0
    buffer_load_dwordx4 v71, s[60:63], s29 offen nt lds
    s_add_u32 s29, s47, 578560
    s_add_u32 m0, s64, 115712
    s_nop 0
    buffer_load_dwordx4 v71, s[60:63], s29 offen nt lds
    s_add_u32 s29, s47, 583680
    s_add_u32 m0, s64, 116736
    s_nop 0
    buffer_load_dwordx4 v71, s[60:63], s29 offen nt lds
    s_add_u32 s29, s47, 588800
    s_add_u32 m0, s64, 117760
    s_nop 0
    buffer_load_dwordx4 v71, s[60:63], s29 offen nt lds
    s_add_u32 s29, s47, 655360
    s_add_u32 m0, s64, 131072
    s_nop 0
    buffer_load_dwordx4 v71, s[60:63], s29 offen nt lds
    s_add_u32 s29, s47, 660480
    s_add_u32 m0, s64, 132096
    s_nop 0
    buffer_load_dwordx4 v71, s[60:63], s29 offen nt lds
    s_add_u32 s29, s47, 665600
    s_add_u32 m0, s64, 133120
    s_nop 0
    buffer_load_dwordx4 v71, s[60:63], s29 offen nt lds
    s_add_u32 s29, s47, 670720
    s_add_u32 m0, s64, 134144
    s_nop 0
    buffer_load_dwordx4 v71, s[60:63], s29 offen nt lds
    s_waitcnt vmcnt(32)
    s_barrier
    v_add_u32 v6, 0, v72
    ds_read_b64_tr_b16 a[0:1], v6 offset:0
    ds_read_b64_tr_b16 a[2:3], v6 offset:2048
    ds_read_b64_tr_b16 a[4:5], v6 offset:4096
    ds_read_b64_tr_b16 a[6:7], v6 offset:6144
    ds_read_b64_tr_b16 a[8:9], v6 offset:8192
    ds_read_b64_tr_b16 a[10:11], v6 offset:10240
    ds_read_b64_tr_b16 a[12:13], v6 offset:12288
    ds_read_b64_tr_b16 a[14:15], v6 offset:14336
    s_waitcnt lgkmcnt(0)
    s_waitcnt vmcnt(28)
    s_barrier
    v_add_u32 v6, 16384, v72
    ds_read_b64_tr_b16 a[16:17], v6 offset:0
    ds_read_b64_tr_b16 a[18:19], v6 offset:2048
    ds_read_b64_tr_b16 a[20:21], v6 offset:4096
    ds_read_b64_tr_b16 a[22:23], v6 offset:6144
    ds_read_b64_tr_b16 a[24:25], v6 offset:8192
    ds_read_b64_tr_b16 a[26:27], v6 offset:10240
    ds_read_b64_tr_b16 a[28:29], v6 offset:12288
    ds_read_b64_tr_b16 a[30:31], v6 offset:14336
    s_waitcnt lgkmcnt(0)
    s_waitcnt vmcnt(24)
    s_barrier
    v_add_u32 v6, 32768, v72
    ds_read_b64_tr_b16 a[32:33], v6 offset:0
    ds_read_b64_tr_b16 a[34:35], v6 offset:2048
    ds_read_b64_tr_b16 a[36:37], v6 offset:4096
    ds_read_b64_tr_b16 a[38:39], v6 offset:6144
    ds_read_b64_tr_b16 a[40:41], v6 offset:8192
    ds_read_b64_tr_b16 a[42:43], v6 offset:10240
    ds_read_b64_tr_b16 a[44:45], v6 offset:12288
    ds_read_b64_tr_b16 a[46:47], v6 offset:14336
    s_waitcnt lgkmcnt(0)
    s_waitcnt vmcnt(20)
    s_barrier
    v_add_u32 v6, 49152, v72
    ds_read_b64_tr_b16 a[48:49], v6 offset:0
    ds_read_b64_tr_b16 a[50:51], v6 offset:2048
    ds_read_b64_tr_b16 a[52:53], v6 offset:4096
    ds_read_b64_tr_b16 a[54:55], v6 offset:6144
    ds_read_b64_tr_b16 a[56:57], v6 offset:8192
    ds_read_b64_tr_b16 a[58:59], v6 offset:10240
    ds_read_b64_tr_b16 a[60:61], v6 offset:12288
    ds_read_b64_tr_b16 a[62:63], v6 offset:14336
    s_waitcnt lgkmcnt(0)
    s_waitcnt vmcnt(16)
    s_barrier
    v_add_u32 v6, 65536, v72
    ds_read_b64_tr_b16 a[64:65], v6 offset:0
    ds_read_b64_tr_b16 a[66:67], v6 offset:2048
    ds_read_b64_tr_b16 a[68:69], v6 offset:4096
    ds_read_b64_tr_b16 a[70:71], v6 offset:6144
    ds_read_b64_tr_b16 a[72:73], v6 offset:8192
    ds_read_b64_tr_b16 a[74:75], v6 offset:10240
    ds_read_b64_tr_b16 a[76:77], v6 offset:12288
    ds_read_b64_tr_b16 a[78:79], v6 offset:14336
    s_waitcnt lgkmcnt(0)
    s_waitcnt vmcnt(12)
    s_barrier
    v_add_u32 v6, 81920, v72
    ds_read_b64_tr_b16 a[80:81], v6 offset:0
    ds_read_b64_tr_b16 a[82:83], v6 offset:2048
    ds_read_b64_tr_b16 a[84:85], v6 offset:4096
    ds_read_b64_tr_b16 a[86:87], v6 offset:6144
    ds_read_b64_tr_b16 a[88:89], v6 offset:8192
    ds_read_b64_tr_b16 a[90:91], v6 offset:10240
    ds_read_b64_tr_b16 a[92:93], v6 offset:12288
    ds_read_b64_tr_b16 a[94:95], v6 offset:14336
    s_waitcnt lgkmcnt(0)
    s_waitcnt vmcnt(8)
    s_barrier
    v_add_u32 v6, 98304, v72
    ds_read_b64_tr_b16 a[96:97], v6 offset:0
    ds_read_b64_tr_b16 a[98:99], v6 offset:2048
    ds_read_b64_tr_b16 a[100:101], v6 offset:4096
    ds_read_b64_tr_b16 a[102:103], v6 offset:6144
    ds_read_b64_tr_b16 a[104:105], v6 offset:8192
    ds_read_b64_tr_b16 a[106:107], v6 offset:10240
    ds_read_b64_tr_b16 a[108:109], v6 offset:12288
    ds_read_b64_tr_b16 a[110:111], v6 offset:14336
    s_waitcnt lgkmcnt(0)
    s_waitcnt vmcnt(4)
    s_barrier
    v_add_u32 v6, 114688, v72
    ds_read_b64_tr_b16 a[112:113], v6 offset:0
    ds_read_b64_tr_b16 a[114:115], v6 offset:2048
    ds_read_b64_tr_b16 a[116:117], v6 offset:4096
    ds_read_b64_tr_b16 a[118:119], v6 offset:6144
    ds_read_b64_tr_b16 a[120:121], v6 offset:8192
    ds_read_b64_tr_b16 a[122:123], v6 offset:10240
    ds_read_b64_tr_b16 a[124:125], v6 offset:12288
    ds_read_b64_tr_b16 a[126:127], v6 offset:14336
    s_waitcnt lgkmcnt(0)
    s_waitcnt vmcnt(0)
    s_barrier
    v_add_u32 v6, 131072, v72
    ds_read_b64_tr_b16 a[128:129], v6 offset:0
    ds_read_b64_tr_b16 a[130:131], v6 offset:2048
    ds_read_b64_tr_b16 a[132:133], v6 offset:4096
    ds_read_b64_tr_b16 a[134:135], v6 offset:6144
    ds_read_b64_tr_b16 a[136:137], v6 offset:8192
    ds_read_b64_tr_b16 a[138:139], v6 offset:10240
    ds_read_b64_tr_b16 a[140:141], v6 offset:12288
    ds_read_b64_tr_b16 a[142:143], v6 offset:14336
    s_waitcnt lgkmcnt(0)
    s_barrier
    s_mov_b32 s51, 1
L_fl_87:
    buffer_load_dword v69, v11, s[4:7], s50 offen sc1
    s_sub_u32 s27, s27, 1
    s_cbranch_scc0 L_ok_88
    s_mov_b32 s28, 20
    s_branch L_bail
L_ok_88:
    s_waitcnt vmcnt(0)
    v_cmp_gt_u32 vcc, s51, v69
    s_cbranch_vccnz L_fl_87
    s_mov_b32 s53, 0
    s_mov_b32 s55, 0
    s_mul_i32 s56, s53, 110592
    s_add_u32 s56, s56, 79691776
    s_add_u32 s56, s56, s49
    s_add_u32 s56, s56, s58
    s_add_u32 s57, s55, s58
    s_add_u32 s30, s56, 0
    s_add_u32 m0, s57, 0
    s_nop 0
    buffer_load_dwordx4 v4, s[4:7], s30 offen offset:0 sc1 lds
    s_add_u32 m0, s57, 0
    s_nop 0
    buffer_load_dwordx4 v4, s[4:7], s30 offen offset:1024 sc1 lds
    s_add_u32 m0, s57, 0
    s_nop 0
    buffer_load_dwordx4 v4, s[4:7], s30 offen offset:2048 sc1 lds
    s_add_u32 m0, s57, 0
    s_nop 0
    buffer_load_dwordx4 v4, s[4:7], s30 offen offset:3072 sc1 lds
    s_add_u32 s30, s56, 4096
    s_add_u32 m0, s57, 4096
    s_nop 0
    buffer_load_dwordx4 v4, s[4:7], s30 offen offset:0 sc1 lds
    s_add_u32 m0, s57, 4096
    s_nop 0
    buffer_load_dwordx4 v4, s[4:7], s30 offen offset:1024 sc1 lds
    s_add_u32 m0, s57, 4096
    s_nop 0
    buffer_load_dwordx4 v4, s[4:7], s30 offen offset:2048 sc1 lds
    s_add_u32 m0, s57, 4096
    s_nop 0
    buffer_load_dwordx4 v4, s[4:7], s30 offen offset:3072 sc1 lds
    s_add_u32 s30, s56, 8192
    s_add_u32 m0, s57, 8192
    s_nop 0
    buffer_load_dwordx4 v4, s[4:7], s30 offen offset:0 sc1 lds
    s_mov_b32 s51, 2
L_fl_89:
    buffer_load_dword v69, v11, s[4:7], s50 offen sc1
    s_sub_u32 s27, s27, 1
    s_cbranch_scc0 L_ok_90
    s_mov_b32 s28, 20
    s_branch L_bail
L_ok_90:
    s_waitcnt vmcnt(0)
    v_cmp_gt_u32 vcc, s51, v69
    s_cbranch_vccnz L_fl_89
    s_mov_b32 s53, 1
    s_mov_b32 s55, 36864
    s_mul_i32 s56, s53, 110592
    s_add_u32 s56, s56, 79691776
    s_add_u32 s56, s56, s49
    s_add_u32 s56, s56, s58
    s_add_u32 s57, s55, s58
    s_add_u32 s30, s56, 0
    s_add_u32 m0, s57, 0
    s_nop 0
    buffer_load_dwordx4 v4, s[4:7], s30 offen offset:0 sc1 lds
    s_add_u32 m0, s57, 0
    s_nop 0
    buffer_load_dwordx4 v4, s[4:7], s30 offen offset:1024 sc1 lds
    s_add_u32 m0, s57, 0
    s_nop 0
    buffer_load_dwordx4 v4, s[4:7], s30 offen offset:2048 sc1 lds
    s_add_u32 m0, s57, 0
    s_nop 0
    buffer_load_dwordx4 v4, s[4:7], s30 offen offset:3072 sc1 lds
    s_add_u32 s30, s56, 4096
    s_add_u32 m0, s57, 4096
    s_nop 0
    buffer_load_dwordx4 v4, s[4:7], s30 offen offset:0 sc1 lds
    s_add_u32 m0, s57, 4096
    s_nop 0
    buffer_load_dwordx4 v4, s[4:7], s30 offen offset:1024 sc1 lds
    s_add_u32 m0, s57, 4096
    s_nop 0
    buffer_load_dwordx4 v4, s[4:7], s30 offen offset:2048 sc1 lds
    s_add_u32 m0, s57, 4096
    s_nop 0
    buffer_load_dwordx4 v4, s[4:7], s30 offen offset:3072 sc1 lds
    s_add_u32 s30, s56, 8192
    s_add_u32 m0, s57, 8192
    s_nop 0
    buffer_load_dwordx4 v4, s[4:7], s30 offen offset:0 sc1 lds
    s_mov_b32 s51, 3
    buffer_load_dword v69, v11, s[4:7], s50 offen sc1
    s_mov_b32 s52, 0
    s_mov_b32 s53, 2
    s_mov_b32 s54, 0
    s_mov_b32 s55, 73728
    s_waitcnt vmcnt(0)
L_g3top_91:
    s_waitcnt vmcnt(9)
    s_barrier
    v_add_u32 v68, s54, v4
    ds_read_b128 v[52:55], v68 offset:0
    ds_read_b128 v[56:59], v68 offset:1024
    ds_read_b128 v[60:63], v68 offset:2048
    ds_read_b128 v[64:67], v68 offset:3072
    s_waitcnt lgkmcnt(3)
    v_mfma_f32_32x32x16_bf16 v[20:35], a[0:3], v[52:55], 0
    s_sub_u32 s31, s52, 1
    s_max_i32 s31, s31, 0
    v_mov_b32 v70, s31
    buffer_store_dword v70, v10, s[4:7], 0 offen sc1
    ds_read_b128 v[52:55], v68 offset:4096
    s_waitcnt lgkmcnt(3)
    v_mfma_f32_32x32x16_bf16 v[20:35], a[4:7], v[56:59], v[20:35]
    v_cvt_pk_bf16_f32 v12, v36, v37
    v_cvt_pk_bf16_f32 v13, v38, v39
    ds_read_b128 v[56:59], v68 offset:5120
    s_waitcnt lgkmcnt(3)
    v_mfma_f32_32x32x16_bf16 v[20:35], a[8:11], v[60:63], v[20:35]
    v_cvt_pk_bf16_f32 v14, v40, v41
    v_cvt_pk_bf16_f32 v15, v42, v43
    ds_read_b128 v[60:63], v68 offset:6144
    s_waitcnt lgkmcnt(3)
    v_mfma_f32_32x32x16_bf16 v[20:35], a[12:15], v[64:67], v[20:35]
    v_cvt_pk_bf16_f32 v16, v44, v45
    v_cvt_pk_bf16_f32 v17, v46, v47
    ds_read_b128 v[64:67], v68 offset:7168
    s_waitcnt lgkmcnt(3)
    v_mfma_f32_32x32x16_bf16 v[20:35], a[16:19], v[52:55], v[20:35]
    v_cvt_pk_bf16_f32 v18, v48, v49
    v_cvt_pk_bf16_f32 v19, v50, v51
    ds_read_b128 v[52:55], v68 offset:8192
    s_waitcnt lgkmcnt(3)
    v_mfma_f32_32x32x16_bf16 v[20:35], a[20:23], v[56:59], v[20:35]
    s_mul_i32 s46, s52, 122880
    s_add_u32 s46, s46, 134094848
    s_add_u32 s46, s46, s48
    s_cmp_eq_u32 s52, 0
    s_cselect_b32 s46, 1073741824, s46
    v_permlane32_swap_b32 v12, v14
    ds_read_b128 v[56:59], v68 offset:9216
    s_waitcnt lgkmcnt(3)
    v_mfma_f32_32x32x16_bf16 v[20:35], a[24:27], v[60:63], v[20:35]
    v_permlane32_swap_b32 v13, v15
    v_permlane32_swap_b32 v16, v18
    ds_read_b128 v[60:63], v68 offset:10240
    s_waitcnt lgkmcnt(3)
    v_mfma_f32_32x32x16_bf16 v[20:35], a[28:31], v[64:67], v[20:35]
    v_permlane32_swap_b32 v17, v19
    buffer_store_dwordx4 v[12:15], v4, s[4:7], s46 offen offset:0 sc1
    ds_read_b128 v[64:67], v68 offset:11264
    s_waitcnt lgkmcnt(3)
    v_mfma_f32_32x32x16_bf16 v[20:35], a[32:35], v[52:55], v[20:35]
    buffer_store_dwordx4 v[16:19], v4, s[4:7], s46 offen offset:1024 sc1
    ds_read_b128 v[52:55], v68 offset:12288
    s_waitcnt lgkmcnt(3)
    v_mfma_f32_32x32x16_bf16 v[20:35], a[36:39], v[56:59], v[20:35]
    ds_read_b128 v[56:59], v68 offset:13312
    s_waitcnt lgkmcnt(3)
    v_mfma_f32_32x32x16_bf16 v[20:35], a[40:43], v[60:63], v[20:35]
    s_mul_i32 s56, s53, 110592
    s_add_u32 s56, s56, 79691776
    s_add_u32 s56, s56, s49
    s_add_u32 s56, s56, s58
    s_add_u32 s57, s55, s58
    v_cmp_gt_u32 vcc, s51, v69
    ds_read_b128 v[60:63], v68 offset:14336
    s_waitcnt lgkmcnt(3)
    v_mfma_f32_32x32x16_bf16 v[20:35], a[44:47], v[64:67], v[20:35]
    s_cbranch_vccnz L_nf_93
L_nfok_94:
    s_add_u32 s53, s53, 1
    s_min_u32 s53, s53, 63
    s_add_u32 s51, s53, 1
    buffer_load_dword v69, v11, s[4:7], s50 offen sc1
    ds_read_b128 v[64:67], v68 offset:15360
    s_waitcnt lgkmcnt(3)
    v_mfma_f32_32x32x16_bf16 v[20:35], a[48:51], v[52:55], v[20:35]
    s_add_u32 s30, s56, 0
    s_add_u32 m0, s57, 0
    s_nop 0
    buffer_load_dwordx4 v4, s[4:7], s30 offen offset:0 sc1 lds
    ds_read_b128 v[52:55], v68 offset:16384
    s_waitcnt lgkmcnt(3)
    v_mfma_f32_32x32x16_bf16 v[20:35], a[52:55], v[56:59], v[20:35]
    ds_read_b128 v[56:59], v68 offset:17408
    s_waitcnt lgkmcnt(3)
    v_mfma_f32_32x32x16_bf16 v[20:35], a[56:59], v[60:63], v[20:35]
    s_add_u32 m0, s57, 0
    s_nop 0
    buffer_load_dwordx4 v4, s[4:7], s30 offen offset:1024 sc1 lds
    ds_read_b128 v[60:63], v68 offset:18432
    s_waitcnt lgkmcnt(3)
    v_mfma_f32_32x32x16_bf16 v[20:35], a[60:63], v[64:67], v[20:35]
    ds_read_b128 v[64:67], v68 offset:19456
    s_waitcnt lgkmcnt(3)
    v_mfma_f32_32x32x16_bf16 v[20:35], a[64:67], v[52:55], v[20:35]
    s_add_u32 m0, s57, 0
    s_nop 0
    buffer_load_dwordx4 v4, s[4:7], s30 offen offset:2048 sc1 lds
    ds_read_b128 v[52:55], v68 offset:20480
    s_waitcnt lgkmcnt(3)
    v_mfma_f32_32x32x16_bf16 v[20:35], a[68:71], v[56:59], v[20:35]
    ds_read_b128 v[56:59], v68 offset:21504
    s_waitcnt lgkmcnt(3)
    v_mfma_f32_32x32x16_bf16 v[20:35], a[72:75], v[60:63], v[20:35]
    s_add_u32 m0, s57, 0
    s_nop 0
    buffer_load_dwordx4 v4, s[4:7], s30 offen offset:3072 sc1 lds
    ds_read_b128 v[60:63], v68 offset:22528
    s_waitcnt lgkmcnt(3)
    v_mfma_f32_32x32x16_bf16 v[20:35], a[76:79], v[64:67], v[20:35]
    ds_read_b128 v[64:67], v68 offset:23552
    s_waitcnt lgkmcnt(3)
    v_mfma_f32_32x32x16_bf16 v[20:35], a[80:83], v[52:55], v[20:35]
    s_add_u32 s30, s56, 4096
    s_add_u32 m0, s57, 4096
    s_nop 0
    buffer_load_dwordx4 v4, s[4:7], s30 offen offset:0 sc1 lds
    ds_read_b128 v[52:55], v68 offset:24576
    s_waitcnt lgkmcnt(3)
    v_mfma_f32_32x32x16_bf16 v[20:35], a[84:87], v[56:59], v[20:35]
    ds_read_b128 v[56:59], v68 offset:25600
    s_waitcnt lgkmcnt(3)
    v_mfma_f32_32x32x16_bf16 v[20:35], a[88:91], v[60:63], v[20:35]
    s_add_u32 m0, s57, 4096
    s_nop 0
    buffer_load_dwordx4 v4, s[4:7], s30 offen offset:1024 sc1 lds
    ds_read_b128 v[60:63], v68 offset:26624
    s_waitcnt lgkmcnt(3)
    v_mfma_f32_32x32x16_bf16 v[20:35], a[92:95], v[64:67], v[20:35]
    ds_read_b128 v[64:67], v68 offset:27648
    s_waitcnt lgkmcnt(3)
    v_mfma_f32_32x32x16_bf16 v[20:35], a[96:99], v[52:55], v[20:35]
    s_add_u32 m0, s57, 4096
    s_nop 0
    buffer_load_dwordx4 v4, s[4:7], s30 offen offset:2048 sc1 lds
    ds_read_b128 v[52:55], v68 offset:28672
    s_waitcnt lgkmcnt(3)
    v_mfma_f32_32x32x16_bf16 v[20:35], a[100:103], v[56:59], v[20:35]
    ds_read_b128 v[56:59], v68 offset:29696
    s_waitcnt lgkmcnt(3)
    v_mfma_f32_32x32x16_bf16 v[20:35], a[104:107], v[60:63], v[20:35]
    s_add_u32 m0, s57, 4096
    s_nop 0
    buffer_load_dwordx4 v4, s[4:7], s30 offen offset:3072 sc1 lds
    ds_read_b128 v[60:63], v68 offset:30720
    s_waitcnt lgkmcnt(3)
    v_mfma_f32_32x32x16_bf16 v[20:35], a[108:111], v[64:67], v[20:35]
    ds_read_b128 v[64:67], v68 offset:31744
    s_waitcnt lgkmcnt(3)
    v_mfma_f32_32x32x16_bf16 v[20:35], a[112:115], v[52:55], v[20:35]
    s_add_u32 s30, s56, 8192
    s_add_u32 m0, s57, 8192
    s_nop 0
    buffer_load_dwordx4 v4, s[4:7], s30 offen offset:0 sc1 lds
    ds_read_b128 v[52:55], v68 offset:32768
    s_waitcnt lgkmcnt(3)
    v_mfma_f32_32x32x16_bf16 v[20:35], a[116:119], v[56:59], v[20:35]
    ds_read_b128 v[56:59], v68 offset:33792
    s_waitcnt lgkmcnt(3)
    v_mfma_f32_32x32x16_bf16 v[20:35], a[120:123], v[60:63], v[20:35]
    ds_read_b128 v[60:63], v68 offset:34816
    s_waitcnt lgkmcnt(3)
    v_mfma_f32_32x32x16_bf16 v[20:35], a[124:127], v[64:67], v[20:35]
    ds_read_b128 v[64:67], v68 offset:35840
    s_waitcnt lgkmcnt(3)
    v_mfma_f32_32x32x16_bf16 v[20:35], a[128:131], v[52:55], v[20:35]
    s_waitcnt lgkmcnt(2)
    v_mfma_f32_32x32x16_bf16 v[20:35], a[132:135], v[56:59], v[20:35]
    s_waitcnt lgkmcnt(1)
    v_mfma_f32_32x32x16_bf16 v[20:35], a[136:139], v[60:63], v[20:35]
    s_waitcnt lgkmcnt(0)
    v_mfma_f32_32x32x16_bf16 v[20:35], a[140:143], v[64:67], v[20:35]
    s_add_u32 s54, s54, 36864
    s_cmp_eq_u32 s54, 110592
    s_cselect_b32 s54, 0, s54
    s_add_u32 s55, s55, 36864
    s_cmp_eq_u32 s55, 110592
    s_cselect_b32 s55, 0, s55
    s_add_u32 s52, s52, 1
    s_waitcnt vmcnt(9)
    s_barrier
    v_add_u32 v68, s54, v4
    ds_read_b128 v[52:55], v68 offset:0
    ds_read_b128 v[56:59], v68 offset:1024
    ds_read_b128 v[60:63], v68 offset:2048
    ds_read_b128 v[64:67], v68 offset:3072
    s_waitcnt lgkmcnt(3)
    v_mfma_f32_32x32x16_bf16 v[36:51], a[0:3], v[52:55], 0
    s_sub_u32 s31, s52, 1
    s_max_i32 s31, s31, 0
    v_mov_b32 v70, s31
    buffer_store_dword v70, v10, s[4:7], 0 offen sc1
    ds_read_b128 v[52:55], v68 offset:4096
    s_waitcnt lgkmcnt(3)
    v_mfma_f32_32x32x16_bf16 v[36:51], a[4:7], v[56:59], v[36:51]
    v_cvt_pk_bf16_f32 v12, v20, v21
    v_cvt_pk_bf16_f32 v13, v22, v23
    ds_read_b128 v[56:59], v68 offset:5120
    s_waitcnt lgkmcnt(3)
    v_mfma_f32_32x32x16_bf16 v[36:51], a[8:11], v[60:63], v[36:51]
    v_cvt_pk_bf16_f32 v14, v24, v25
    v_cvt_pk_bf16_f32 v15, v26, v27
    ds_read_b128 v[60:63], v68 offset:6144
    s_waitcnt lgkmcnt(3)
    v_mfma_f32_32x32x16_bf16 v[36:51], a[12:15], v[64:67], v[36:51]
    v_cvt_pk_bf16_f32 v16, v28, v29
    v_cvt_pk_bf16_f32 v17, v30, v31
    ds_read_b128 v[64:67], v68 offset:7168
    s_waitcnt lgkmcnt(3)
    v_mfma_f32_32x32x16_bf16 v[36:51], a[16:19], v[52:55], v[36:51]
    v_cvt_pk_bf16_f32 v18, v32, v33
    v_cvt_pk_bf16_f32 v19, v34, v35
    ds_read_b128 v[52:55], v68 offset:8192
    s_waitcnt lgkmcnt(3)
    v_mfma_f32_32x32x16_bf16 v[36:51], a[20:23], v[56:59], v[36:51]
    s_mul_i32 s46, s52, 122880
    s_add_u32 s46, s46, 134094848
    s_add_u32 s46, s46, s48
    s_cmp_eq_u32 s52, 0
    s_cselect_b32 s46, 1073741824, s46
    v_permlane32_swap_b32 v12, v14
    ds_read_b128 v[56:59], v68 offset:9216
    s_waitcnt lgkmcnt(3)
    v_mfma_f32_32x32x16_bf16 v[36:51], a[24:27], v[60:63], v[36:51]
    v_permlane32_swap_b32 v13, v15
    v_permlane32_swap_b32 v16, v18
    ds_read_b128 v[60:63], v68 offset:10240
    s_waitcnt lgkmcnt(3)
    v_mfma_f32_32x32x16_bf16 v[36:51], a[28:31], v[64:67], v[36:51]
    v_permlane32_swap_b32 v17, v19
    buffer_store_dwordx4 v[12:15], v4, s[4:7], s46 offen offset:0 sc1
    ds_read_b128 v[64:67], v68 offset:11264
    s_waitcnt lgkmcnt(3)
    v_mfma_f32_32x32x16_bf16 v[36:51], a[32:35], v[52:55], v[36:51]
    buffer_store_dwordx4 v[16:19], v4, s[4:7], s46 offen offset:1024 sc1
    ds_read_b128 v[52:55], v68 offset:12288
    s_waitcnt lgkmcnt(3)
    v_mfma_f32_32x32x16_bf16 v[36:51], a[36:39], v[56:59], v[36:51]
    ds_read_b128 v[56:59], v68 offset:13312
    s_waitcnt lgkmcnt(3)
    v_mfma_f32_32x32x16_bf16 v[36:51], a[40:43], v[60:63], v[36:51]
    s_mul_i32 s56, s53, 110592
    s_add_u32 s56, s56, 79691776
    s_add_u32 s56, s56, s49
    s_add_u32 s56, s56, s58
    s_add_u32 s57, s55, s58
    v_cmp_gt_u32 vcc, s51, v69
    ds_read_b128 v[60:63], v68 offset:14336
    s_waitcnt lgkmcnt(3)
    v_mfma_f32_32x32x16_bf16 v[36:51], a[44:47], v[64:67], v[36:51]
    s_cbranch_vccnz L_nf_95
L_nfok_96:
    s_add_u32 s53, s53, 1
    s_min_u32 s53, s53, 63
    s_add_u32 s51, s53, 1
    buffer_load_dword v69, v11, s[4:7], s50 offen sc1
    ds_read_b128 v[64:67], v68 offset:15360
    s_waitcnt lgkmcnt(3)
    v_mfma_f32_32x32x16_bf16 v[36:51], a[48:51], v[52:55], v[36:51]
    s_add_u32 s30, s56, 0
    s_add_u32 m0, s57, 0
    s_nop 0
    buffer_load_dwordx4 v4, s[4:7], s30 offen offset:0 sc1 lds
    ds_read_b128 v[52:55], v68 offset:16384
    s_waitcnt lgkmcnt(3)
    v_mfma_f32_32x32x16_bf16 v[36:51], a[52:55], v[56:59], v[36:51]
    ds_read_b128 v[56:59], v68 offset:17408
    s_waitcnt lgkmcnt(3)
    v_mfma_f32_32x32x16_bf16 v[36:51], a[56:59], v[60:63], v[36:51]
    s_add_u32 m0, s57, 0
    s_nop 0
    buffer_load_dwordx4 v4, s[4:7], s30 offen offset:1024 sc1 lds
    ds_read_b128 v[60:63], v68 offset:18432
    s_waitcnt lgkmcnt(3)
    v_mfma_f32_32x32x16_bf16 v[36:51], a[60:63], v[64:67], v[36:51]
    ds_read_b128 v[64:67], v68 offset:19456
    s_waitcnt lgkmcnt(3)
    v_mfma_f32_32x32x16_bf16 v[36:51], a[64:67], v[52:55], v[36:51]
    s_add_u32 m0, s57, 0
    s_nop 0
    buffer_load_dwordx4 v4, s[4:7], s30 offen offset:2048 sc1 lds
    ds_read_b128 v[52:55], v68 offset:20480
    s_waitcnt lgkmcnt(3)
    v_mfma_f32_32x32x16_bf16 v[36:51], a[68:71], v[56:59], v[36:51]
    ds_read_b128 v[56:59], v68 offset:21504
    s_waitcnt lgkmcnt(3)
    v_mfma_f32_32x32x16_bf16 v[36:51], a[72:75], v[60:63], v[36:51]
    s_add_u32 m0, s57, 0
    s_nop 0
    buffer_load_dwordx4 v4, s[4:7], s30 offen offset:3072 sc1 lds
    ds_read_b128 v[60:63], v68 offset:22528
    s_waitcnt lgkmcnt(3)
    v_mfma_f32_32x32x16_bf16 v[36:51], a[76:79], v[64:67], v[36:51]
    ds_read_b128 v[64:67], v68 offset:23552
    s_waitcnt lgkmcnt(3)
    v_mfma_f32_32x32x16_bf16 v[36:51], a[80:83], v[52:55], v[36:51]
    s_add_u32 s30, s56, 4096
    s_add_u32 m0, s57, 4096
    s_nop 0
    buffer_load_dwordx4 v4, s[4:7], s30 offen offset:0 sc1 lds
    ds_read_b128 v[52:55], v68 offset:24576
    s_waitcnt lgkmcnt(3)
    v_mfma_f32_32x32x16_bf16 v[36:51], a[84:87], v[56:59], v[36:51]
    ds_read_b128 v[56:59], v68 offset:25600
    s_waitcnt lgkmcnt(3)
    v_mfma_f32_32x32x16_bf16 v[36:51], a[88:91], v[60:63], v[36:51]
    s_add_u32 m0, s57, 4096
    s_nop 0
    buffer_load_dwordx4 v4, s[4:7], s30 offen offset:1024 sc1 lds
    ds_read_b128 v[60:63], v68 offset:26624
    s_waitcnt lgkmcnt(3)
    v_mfma_f32_32x32x16_bf16 v[36:51], a[92:95], v[64:67], v[36:51]
    ds_read_b128 v[64:67], v68 offset:27648
    s_waitcnt lgkmcnt(3)
    v_mfma_f32_32x32x16_bf16 v[36:51], a[96:99], v[52:55], v[36:51]
    s_add_u32 m0, s57, 4096
    s_nop 0
    buffer_load_dwordx4 v4, s[4:7], s30 offen offset:2048 sc1 lds
    ds_read_b128 v[52:55], v68 offset:28672
    s_waitcnt lgkmcnt(3)
    v_mfma_f32_32x32x16_bf16 v[36:51], a[100:103], v[56:59], v[36:51]
    ds_read_b128 v[56:59], v68 offset:29696
    s_waitcnt lgkmcnt(3)
    v_mfma_f32_32x32x16_bf16 v[36:51], a[104:107], v[60:63], v[36:51]
    s_add_u32 m0, s57, 4096
    s_nop 0
    buffer_load_dwordx4 v4, s[4:7], s30 offen offset:3072 sc1 lds
    ds_read_b128 v[60:63], v68 offset:30720
    s_waitcnt lgkmcnt(3)
    v_mfma_f32_32x32x16_bf16 v[36:51], a[108:111], v[64:67], v[36:51]
    ds_read_b128 v[64:67], v68 offset:31744
    s_waitcnt lgkmcnt(3)
    v_mfma_f32_32x32x16_bf16 v[36:51], a[112:115], v[52:55], v[36:51]
    s_add_u32 s30, s56, 8192
    s_add_u32 m0, s57, 8192
    s_nop 0
    buffer_load_dwordx4 v4, s[4:7], s30 offen offset:0 sc1 lds
    ds_read_b128 v[52:55], v68 offset:32768
    s_waitcnt lgkmcnt(3)
    v_mfma_f32_32x32x16_bf16 v[36:51], a[116:119], v[56:59], v[36:51]
    ds_read_b128 v[56:59], v68 offset:33792
    s_waitcnt lgkmcnt(3)
    v_mfma_f32_32x32x16_bf16 v[36:51], a[120:123], v[60:63], v[36:51]
    ds_read_b128 v[60:63], v68 offset:34816
    s_waitcnt lgkmcnt(3)
    v_mfma_f32_32x32x16_bf16 v[36:51], a[124:127], v[64:67], v[36:51]
    ds_read_b128 v[64:67], v68 offset:35840
    s_waitcnt lgkmcnt(3)
    v_mfma_f32_32x32x16_bf16 v[36:51], a[128:131], v[52:55], v[36:51]
    s_waitcnt lgkmcnt(2)
    v_mfma_f32_32x32x16_bf16 v[36:51], a[132:135], v[56:59], v[36:51]
    s_waitcnt lgkmcnt(1)
    v_mfma_f32_32x32x16_bf16 v[36:51], a[136:139], v[60:63], v[36:51]
    s_waitcnt lgkmcnt(0)
    v_mfma_f32_32x32x16_bf16 v[36:51], a[140:143], v[64:67], v[36:51]
    s_add_u32 s54, s54, 36864
    s_cmp_eq_u32 s54, 110592
    s_cselect_b32 s54, 0, s54
    s_add_u32 s55, s55, 36864
    s_cmp_eq_u32 s55, 110592
    s_cselect_b32 s55, 0, s55
    s_add_u32 s52, s52, 1
    s_cmp_lt_u32 s52, 64
    s_cbranch_scc1 L_g3top_91
    s_nop 2
    v_cvt_pk_bf16_f32 v12, v36, v37
    v_cvt_pk_bf16_f32 v13, v38, v39
    v_cvt_pk_bf16_f32 v14, v40, v41
    v_cvt_pk_bf16_f32 v15, v42, v43
    v_cvt_pk_bf16_f32 v16, v44, v45
    v_cvt_pk_bf16_f32 v17, v46, v47
    v_cvt_pk_bf16_f32 v18, v48, v49
    v_cvt_pk_bf16_f32 v19, v50, v51
    s_mul_i32 s46, s52, 122880
    s_add_u32 s46, s46, 134094848
    s_add_u32 s46, s46, s48
    s_cmp_eq_u32 s52, 0
    s_cselect_b32 s46, 1073741824, s46
    v_permlane32_swap_b32 v12, v14
    v_permlane32_swap_b32 v13, v15
    v_permlane32_swap_b32 v16, v18
    v_permlane32_swap_b32 v17, v19
    buffer_store_dwordx4 v[12:15], v4, s[4:7], s46 offen offset:0 sc1
    buffer_store_dwordx4 v[16:19], v4, s[4:7], s46 offen offset:1024 sc1
    s_waitcnt vmcnt(0)
    s_barrier
    v_mov_b32 v70, 64
    buffer_store_dword v70, v10, s[4:7], 0 offen sc1
    s_endpgm
L_nf_93:
L_fl_97:
    buffer_load_dword v69, v11, s[4:7], s50 offen sc1
    s_sub_u32 s27, s27, 1
    s_cbranch_scc0 L_ok_98
    s_mov_b32 s28, 21
    s_branch L_bail
L_ok_98:
    s_waitcnt vmcnt(0)
    v_cmp_gt_u32 vcc, s51, v69
    s_cbranch_vccnz L_fl_97
    s_branch L_nfok_94
L_nf_95:
L_fl_99:
    buffer_load_dword v69, v11, s[4:7], s50 offen sc1
    s_sub_u32 s27, s27, 1
    s_cbranch_scc0 L_ok_100
    s_mov_b32 s28, 21
    s_branch L_bail
L_ok_100:
    s_waitcnt vmcnt(0)
    v_cmp_gt_u32 vcc, s51, v69
    s_cbranch_vccnz L_fl_99
    s_branch L_nfok_96
L_G4:
    s_getpc_b64 s[28:29]
    v_lshlrev_b32 v1, 4, v0
    global_load_dwordx4 v[252:255], v1, s[28:29]
    v_add_u32 v1, 4096, v1
    global_load_dwordx4 v[252:255], v1, s[28:29]
    v_and_b32 v1, 63, v0
    v_mov_b32 v3, 0
    v_lshlrev_b32 v4, 4, v1
    s_mul_i32 s44, s24, 52
    s_lshr_b32 s44, s44, 8
    s_mul_i32 s45, s44, 5
    s_sub_u32 s45, s24, s45
    v_mov_b32 v10, 0
    s_mul_i32 s28, s24, 128
    v_add_u32 v10, s28, v10
    v_add_u32 v10, 71329792, v10
    v_mov_b32 v6, 1073741824
    v_cmp_eq_u32 vcc, 0, v0
    s_nop 1
    v_cndmask_b32 v10, v6, v10, vcc
    v_bfe_u32 v2, v1, 4, 2
    v_mul_u32_u24 v11, 128, v2
    s_mul_i32 s28, s44, 512
    v_add_u32 v11, s28, v11
    v_add_u32 v11, 71321600, v11
    s_mul_i32 s47, s44, 655360
    s_lshl_b32 s29, s45, 8
    s_add_u32 s47, s47, s29
    s_lshl_b32 s48, s24, 13
    s_lshl_b32 s29, s26, 11
    s_add_u32 s48, s48, s29
    s_lshl_b32 s49, s44, 15
    s_add_u32 s49, s49, s29
    s_mov_b32 s52, s29
    s_cmp_eq_u32 s33, 1
    s_cbranch_scc1 L_cs_101
    v_mbcnt_lo_u32_b32 v7, -1, 0
    v_bfe_u32 v8, v7, 2, 1
    v_and_b32 v7, 3, v7
    v_lshlrev_b32 v7, 6, v7
    v_lshl_add_u32 v7, v8, 2, v7
L_cen_102:
    global_load_dword v8, v7, s[20:21] sc1
    s_sub_u32 s27, s27, 1
    s_cbranch_scc0 L_ok_104
    s_mov_b32 s28, 10
    s_branch L_bail
L_ok_104:
    s_waitcnt vmcnt(0)
L_cenc_103:
    s_mov_b32 s29, 0
    v_readlane_b32 s30, v8, 0
    s_nop 0
    s_add_u32 s29, s29, s30
    v_readlane_b32 s30, v8, 1
    s_nop 0
    s_add_u32 s29, s29, s30
    v_readlane_b32 s30, v8, 2
    s_nop 0
    s_add_u32 s29, s29, s30
    v_readlane_b32 s30, v8, 3
    s_nop 0
    s_add_u32 s29, s29, s30
    v_readlane_b32 s30, v8, 4
    s_nop 0
    s_add_u32 s29, s29, s30
    v_readlane_b32 s30, v8, 5
    s_nop 0
    s_add_u32 s29, s29, s30
    v_readlane_b32 s30, v8, 6
    s_nop 0
    s_add_u32 s29, s29, s30
    v_readlane_b32 s30, v8, 7
    s_nop 0
    s_add_u32 s29, s29, s30
    s_cmp_lt_u32 s29, 256
    s_cbranch_scc1 L_cen_102
    v_cmp_ne_u32 vcc, 32, v8
    s_cbranch_vccnz L_fallback
L_cs_101:
    s_mov_b32 s29, 71305216
    s_mov_b32 s30, 8
L_fl_105:
    buffer_load_dword v7, v3, s[4:7], s29 offen sc1
    s_sub_u32 s27, s27, 1
    s_cbranch_scc0 L_ok_106
    s_mov_b32 s28, 30
    s_branch L_bail
L_ok_106:
    s_waitcnt vmcnt(0)
    v_cmp_gt_u32 vcc, s30, v7
    s_cbranch_vccnz L_fl_105
    s_mov_b32 s56, s14
    s_and_b32 s57, s15, 0xffff
    s_mov_b32 s58, 5242880
    s_mov_b32 s59, 0x20000
    v_bfe_u32 v2, v1, 4, 2
    v_mul_u32_u24 v7, 4, v2
    v_bfe_u32 v2, v1, 0, 4
    v_mul_u32_u24 v8, 1, v2
    v_xor_b32 v7, v7, v8
    v_bfe_u32 v2, v1, 4, 2
    v_mul_u32_u24 v70, 1280, v2
    s_mul_i32 s28, s26, 20480
    v_add_u32 v70, s28, v70
    v_lshl_add_u32 v70, v7, 4, v70
    v_bfe_u32 v2, v1, 2, 2
    v_mul_u32_u24 v7, 4, v2
    v_bfe_u32 v2, v1, 4, 1
    v_mul_u32_u24 v8, 2, v2
    v_bfe_u32 v2, v1, 1, 1
    v_mul_u32_u24 v2, 1, v2
    v_add_u32 v8, v8, v2
    s_mul_i32 s28, s26, 4
    v_add_u32 v8, s28, v8
    v_xor_b32 v7, v7, v8
    v_bfe_u32 v2, v1, 2, 2
    v_mul_u32_u24 v71, 256, v2
    v_bfe_u32 v2, v1, 5, 1
    v_mul_u32_u24 v2, 1024, v2
    v_add_u32 v71, v71, v2
    v_bfe_u32 v2, v1, 0, 1
    v_mul_u32_u24 v2, 8, v2
    v_add_u32 v71, v71, v2
    v_lshl_add_u32 v71, v7, 4, v71
    s_lshl_b32 s60, s26, 12
    s_add_u32 s29, s47, 0
    s_add_u32 m0, s60, 0
    s_nop 0
    buffer_load_dwordx4 v70, s[56:59], s29 offen nt lds
    s_add_u32 s29, s47, 5120
    s_add_u32 m0, s60, 1024
    s_nop 0
    buffer_load_dwordx4 v70, s[56:59], s29 offen nt lds
    s_add_u32 s29, s47, 10240
    s_add_u32 m0, s60, 2048
    s_nop 0
    buffer_load_dwordx4 v70, s[56:59], s29 offen nt lds
    s_add_u32 s29, s47, 15360
    s_add_u32 m0, s60, 3072
    s_nop 0
    buffer_load_dwordx4 v70, s[56:59], s29 offen nt lds
    s_add_u32 s29, s47, 81920
    s_add_u32 m0, s60, 16384
    s_nop 0
    buffer_load_dwordx4 v70, s[56:59], s29 offen nt lds
    s_add_u32 s29, s47, 87040
    s_add_u32 m0, s60, 17408
    s_nop 0
    buffer_load_dwordx4 v70, s[56:59], s29 offen nt lds
    s_add_u32 s29, s47, 92160
    s_add_u32 m0, s60, 18432
    s_nop 0
    buffer_load_dwordx4 v70, s[56:59], s29 offen nt lds
    s_add_u32 s29, s47, 97280
    s_add_u32 m0, s60, 19456
    s_nop 0
    buffer_load_dwordx4 v70, s[56:59], s29 offen nt lds
    s_add_u32 s29, s47, 163840
    s_add_u32 m0, s60, 32768
    s_nop 0
    buffer_load_dwordx4 v70, s[56:59], s29 offen nt lds
    s_add_u32 s29, s47, 168960
    s_add_u32 m0, s60, 33792
    s_nop 0
    buffer_load_dwordx4 v70, s[56:59], s29 offen nt lds
    s_add_u32 s29, s47, 174080
    s_add_u32 m0, s60, 34816
    s_nop 0
    buffer_load_dwordx4 v70, s[56:59], s29 offen nt lds
    s_add_u32 s29, s47, 179200
    s_add_u32 m0, s60, 35840
    s_nop 0
    buffer_load_dwordx4 v70, s[56:59], s29 offen nt lds
    s_add_u32 s29, s47, 245760
    s_add_u32 m0, s60, 49152
    s_nop 0
    buffer_load_dwordx4 v70, s[56:59], s29 offen nt lds
    s_add_u32 s29, s47, 250880
    s_add_u32 m0, s60, 50176
    s_nop 0
    buffer_load_dwordx4 v70, s[56:59], s29 offen nt lds
    s_add_u32 s29, s47, 256000
    s_add_u32 m0, s60, 51200
    s_nop 0
    buffer_load_dwordx4 v70, s[56:59], s29 offen nt lds
    s_add_u32 s29, s47, 261120
    s_add_u32 m0, s60, 52224
    s_nop 0
    buffer_load_dwordx4 v70, s[56:59], s29 offen nt lds
    s_add_u32 s29, s47, 327680
    s_add_u32 m0, s60, 65536
    s_nop 0
    buffer_load_dwordx4 v70, s[56:59], s29 offen nt lds
    s_add_u32 s29, s47, 332800
    s_add_u32 m0, s60, 66560
    s_nop 0
    buffer_load_dwordx4 v70, s[56:59], s29 offen nt lds
    s_add_u32 s29, s47, 337920
    s_add_u32 m0, s60, 67584
    s_nop 0
    buffer_load_dwordx4 v70, s[56:59], s29 offen nt lds
    s_add_u32 s29, s47, 343040
    s_add_u32 m0, s60, 68608
    s_nop 0
    buffer_load_dwordx4 v70, s[56:59], s29 offen nt lds
    s_add_u32 s29, s47, 409600
    s_add_u32 m0, s60, 81920
    s_nop 0
    buffer_load_dwordx4 v70, s[56:59], s29 offen nt lds
    s_add_u32 s29, s47, 414720
    s_add_u32 m0, s60, 82944
    s_nop 0
    buffer_load_dwordx4 v70, s[56:59], s29 offen nt lds
    s_add_u32 s29, s47, 419840
    s_add_u32 m0, s60, 83968
    s_nop 0
    buffer_load_dwordx4 v70, s[56:59], s29 offen nt lds
    s_add_u32 s29, s47, 424960
    s_add_u32 m0, s60, 84992
    s_nop 0
    buffer_load_dwordx4 v70, s[56:59], s29 offen nt lds
    s_add_u32 s29, s47, 491520
    s_add_u32 m0, s60, 98304
    s_nop 0
    buffer_load_dwordx4 v70, s[56:59], s29 offen nt lds
    s_add_u32 s29, s47, 496640
    s_add_u32 m0, s60, 99328
    s_nop 0
    buffer_load_dwordx4 v70, s[56:59], s29 offen nt lds
    s_add_u32 s29, s47, 501760
    s_add_u32 m0, s60, 100352
    s_nop 0
    buffer_load_dwordx4 v70, s[56:59], s29 offen nt lds
    s_add_u32 s29, s47, 506880
    s_add_u32 m0, s60, 101376
    s_nop 0
    buffer_load_dwordx4 v70, s[56:59], s29 offen nt lds
    s_add_u32 s29, s47, 573440
    s_add_u32 m0, s60, 114688
    s_nop 0
    buffer_load_dwordx4 v70, s[56:59], s29 offen nt lds
    s_add_u32 s29, s47, 578560
    s_add_u32 m0, s60, 115712
    s_nop 0
    buffer_load_dwordx4 v70, s[56:59], s29 offen nt lds
    s_add_u32 s29, s47, 583680
    s_add_u32 m0, s60, 116736
    s_nop 0
    buffer_load_dwordx4 v70, s[56:59], s29 offen nt lds
    s_add_u32 s29, s47, 588800
    s_add_u32 m0, s60, 117760
    s_nop 0
    buffer_load_dwordx4 v70, s[56:59], s29 offen nt lds
    s_waitcnt vmcnt(28)
    s_barrier
    v_add_u32 v6, 0, v71
    ds_read_b64_tr_b16 a[0:1], v6 offset:0
    ds_read_b64_tr_b16 a[2:3], v6 offset:4096
    ds_read_b64_tr_b16 a[4:5], v6 offset:2048
    ds_read_b64_tr_b16 a[6:7], v6 offset:6144
    ds_read_b64_tr_b16 a[8:9], v6 offset:8192
    ds_read_b64_tr_b16 a[10:11], v6 offset:12288
    ds_read_b64_tr_b16 a[12:13], v6 offset:10240
    ds_read_b64_tr_b16 a[14:15], v6 offset:14336
    s_waitcnt lgkmcnt(0)
    s_waitcnt vmcnt(24)
    s_barrier
    v_add_u32 v6, 16384, v71
    ds_read_b64_tr_b16 a[16:17], v6 offset:0
    ds_read_b64_tr_b16 a[18:19], v6 offset:4096
    ds_read_b64_tr_b16 a[20:21], v6 offset:2048
    ds_read_b64_tr_b16 a[22:23], v6 offset:6144
    ds_read_b64_tr_b16 a[24:25], v6 offset:8192
    ds_read_b64_tr_b16 a[26:27], v6 offset:12288
    ds_read_b64_tr_b16 a[28:29], v6 offset:10240
    ds_read_b64_tr_b16 a[30:31], v6 offset:14336
    s_waitcnt lgkmcnt(0)
    s_waitcnt vmcnt(20)
    s_barrier
    v_add_u32 v6, 32768, v71
    ds_read_b64_tr_b16 a[32:33], v6 offset:0
    ds_read_b64_tr_b16 a[34:35], v6 offset:4096
    ds_read_b64_tr_b16 a[36:37], v6 offset:2048
    ds_read_b64_tr_b16 a[38:39], v6 offset:6144
    ds_read_b64_tr_b16 a[40:41], v6 offset:8192
    ds_read_b64_tr_b16 a[42:43], v6 offset:12288
    ds_read_b64_tr_b16 a[44:45], v6 offset:10240
    ds_read_b64_tr_b16 a[46:47], v6 offset:14336
    s_waitcnt lgkmcnt(0)
    s_waitcnt vmcnt(16)
    s_barrier
    v_add_u32 v6, 49152, v71
    ds_read_b64_tr_b16 a[48:49], v6 offset:0
    ds_read_b64_tr_b16 a[50:51], v6 offset:4096
    ds_read_b64_tr_b16 a[52:53], v6 offset:2048
    ds_read_b64_tr_b16 a[54:55], v6 offset:6144
    ds_read_b64_tr_b16 a[56:57], v6 offset:8192
    ds_read_b64_tr_b16 a[58:59], v6 offset:12288
    ds_read_b64_tr_b16 a[60:61], v6 offset:10240
    ds_read_b64_tr_b16 a[62:63], v6 offset:14336
    s_waitcnt lgkmcnt(0)
    s_waitcnt vmcnt(12)
    s_barrier
    v_add_u32 v6, 65536, v71
    ds_read_b64_tr_b16 a[64:65], v6 offset:0
    ds_read_b64_tr_b16 a[66:67], v6 offset:4096
    ds_read_b64_tr_b16 a[68:69], v6 offset:2048
    ds_read_b64_tr_b16 a[70:71], v6 offset:6144
    ds_read_b64_tr_b16 a[72:73], v6 offset:8192
    ds_read_b64_tr_b16 a[74:75], v6 offset:12288
    ds_read_b64_tr_b16 a[76:77], v6 offset:10240
    ds_read_b64_tr_b16 a[78:79], v6 offset:14336
    s_waitcnt lgkmcnt(0)
    s_waitcnt vmcnt(8)
    s_barrier
    v_add_u32 v6, 81920, v71
    ds_read_b64_tr_b16 a[80:81], v6 offset:0
    ds_read_b64_tr_b16 a[82:83], v6 offset:4096
    ds_read_b64_tr_b16 a[84:85], v6 offset:2048
    ds_read_b64_tr_b16 a[86:87], v6 offset:6144
    ds_read_b64_tr_b16 a[88:89], v6 offset:8192
    ds_read_b64_tr_b16 a[90:91], v6 offset:12288
    ds_read_b64_tr_b16 a[92:93], v6 offset:10240
    ds_read_b64_tr_b16 a[94:95], v6 offset:14336
    s_waitcnt lgkmcnt(0)
    s_waitcnt vmcnt(4)
    s_barrier
    v_add_u32 v6, 98304, v71
    ds_read_b64_tr_b16 a[96:97], v6 offset:0
    ds_read_b64_tr_b16 a[98:99], v6 offset:4096
    ds_read_b64_tr_b16 a[100:101], v6 offset:2048
    ds_read_b64_tr_b16 a[102:103], v6 offset:6144
    ds_read_b64_tr_b16 a[104:105], v6 offset:8192
    ds_read_b64_tr_b16 a[106:107], v6 offset:12288
    ds_read_b64_tr_b16 a[108:109], v6 offset:10240
    ds_read_b64_tr_b16 a[110:111], v6 offset:14336
    s_waitcnt lgkmcnt(0)
    s_waitcnt vmcnt(0)
    s_barrier
    v_add_u32 v6, 114688, v71
    ds_read_b64_tr_b16 a[112:113], v6 offset:0
    ds_read_b64_tr_b16 a[114:115], v6 offset:4096
    ds_read_b64_tr_b16 a[116:117], v6 offset:2048
    ds_read_b64_tr_b16 a[118:119], v6 offset:6144
    ds_read_b64_tr_b16 a[120:121], v6 offset:8192
    ds_read_b64_tr_b16 a[122:123], v6 offset:12288
    ds_read_b64_tr_b16 a[124:125], v6 offset:10240
    ds_read_b64_tr_b16 a[126:127], v6 offset:14336
    s_waitcnt lgkmcnt(0)
    s_barrier
    s_mov_b32 s50, 0
L_g4top_107:
    buffer_load_dword v12, v11, s[4:7], 0 offen sc1
    s_add_u32 s51, s50, 1
    s_mul_i32 s53, s50, 262144
    s_add_u32 s53, s53, 88080384
    s_add_u32 s53, s53, s49
    v_mov_b32 v13, s50
    s_waitcnt vmcnt(0)
    s_barrier
    v_cmp_gt_u32 vcc, s51, v12
    s_cbranch_vccnz L_g4w_108
L_g4ok_109:
    s_add_u32 s30, s53, 0
    s_add_u32 m0, s52, 0
    s_nop 0
    buffer_load_dwordx4 v4, s[4:7], s30 offen offset:0 sc1 lds
    buffer_load_dwordx4 v4, s[4:7], s30 offen offset:1024 sc1 lds
    s_add_u32 s30, s53, 8192
    s_add_u32 m0, s52, 8192
    s_nop 0
    buffer_load_dwordx4 v4, s[4:7], s30 offen offset:0 sc1 lds
    buffer_load_dwordx4 v4, s[4:7], s30 offen offset:1024 sc1 lds
    s_add_u32 s30, s53, 16384
    s_add_u32 m0, s52, 16384
    s_nop 0
    buffer_load_dwordx4 v4, s[4:7], s30 offen offset:0 sc1 lds
    buffer_load_dwordx4 v4, s[4:7], s30 offen offset:1024 sc1 lds
    s_add_u32 s30, s53, 24576
    s_add_u32 m0, s52, 24576
    s_nop 0
    buffer_load_dwordx4 v4, s[4:7], s30 offen offset:0 sc1 lds
    buffer_load_dwordx4 v4, s[4:7], s30 offen offset:1024 sc1 lds
    buffer_store_dword v13, v10, s[4:7], 0 offen sc1
    s_waitcnt vmcnt(7)
    s_barrier
    ds_read_b128 v[38:41], v4 offset:0
    ds_read_b128 v[42:45], v4 offset:1024
    ds_read_b128 v[46:49], v4 offset:2048
    ds_read_b128 v[50:53], v4 offset:3072
    ds_read_b128 v[54:57], v4 offset:4096
    ds_read_b128 v[58:61], v4 offset:5120
    ds_read_b128 v[62:65], v4 offset:6144
    ds_read_b128 v[66:69], v4 offset:7168
    s_waitcnt lgkmcnt(7)
    v_mfma_f32_32x32x16_bf16 v[22:37], a[0:3], v[38:41], 0
    s_waitcnt lgkmcnt(6)
    v_mfma_f32_32x32x16_bf16 v[22:37], a[4:7], v[42:45], v[22:37]
    s_waitcnt lgkmcnt(5)
    v_mfma_f32_32x32x16_bf16 v[22:37], a[8:11], v[46:49], v[22:37]
    s_waitcnt lgkmcnt(4)
    v_mfma_f32_32x32x16_bf16 v[22:37], a[12:15], v[50:53], v[22:37]
    s_waitcnt lgkmcnt(3)
    v_mfma_f32_32x32x16_bf16 v[22:37], a[16:19], v[54:57], v[22:37]
    s_waitcnt lgkmcnt(2)
    v_mfma_f32_32x32x16_bf16 v[22:37], a[20:23], v[58:61], v[22:37]
    s_waitcnt lgkmcnt(1)
    v_mfma_f32_32x32x16_bf16 v[22:37], a[24:27], v[62:65], v[22:37]
    s_waitcnt lgkmcnt(0)
    v_mfma_f32_32x32x16_bf16 v[22:37], a[28:31], v[66:69], v[22:37]
    s_waitcnt vmcnt(5)
    s_barrier
    ds_read_b128 v[38:41], v4 offset:8192
    ds_read_b128 v[42:45], v4 offset:9216
    ds_read_b128 v[46:49], v4 offset:10240
    ds_read_b128 v[50:53], v4 offset:11264
    ds_read_b128 v[54:57], v4 offset:12288
    ds_read_b128 v[58:61], v4 offset:13312
    ds_read_b128 v[62:65], v4 offset:14336
    ds_read_b128 v[66:69], v4 offset:15360
    s_waitcnt lgkmcnt(7)
    v_mfma_f32_32x32x16_bf16 v[22:37], a[32:35], v[38:41], v[22:37]
    s_waitcnt lgkmcnt(6)
    v_mfma_f32_32x32x16_bf16 v[22:37], a[36:39], v[42:45], v[22:37]
    s_waitcnt lgkmcnt(5)
    v_mfma_f32_32x32x16_bf16 v[22:37], a[40:43], v[46:49], v[22:37]
    s_waitcnt lgkmcnt(4)
    v_mfma_f32_32x32x16_bf16 v[22:37], a[44:47], v[50:53], v[22:37]
    s_waitcnt lgkmcnt(3)
    v_mfma_f32_32x32x16_bf16 v[22:37], a[48:51], v[54:57], v[22:37]
    s_waitcnt lgkmcnt(2)
    v_mfma_f32_32x32x16_bf16 v[22:37], a[52:55], v[58:61], v[22:37]
    s_waitcnt lgkmcnt(1)
    v_mfma_f32_32x32x16_bf16 v[22:37], a[56:59], v[62:65], v[22:37]
    s_waitcnt lgkmcnt(0)
    v_mfma_f32_32x32x16_bf16 v[22:37], a[60:63], v[66:69], v[22:37]
    s_waitcnt vmcnt(3)
    s_barrier
    ds_read_b128 v[38:41], v4 offset:16384
    ds_read_b128 v[42:45], v4 offset:17408
    ds_read_b128 v[46:49], v4 offset:18432
    ds_read_b128 v[50:53], v4 offset:19456
    ds_read_b128 v[54:57], v4 offset:20480
    ds_read_b128 v[58:61], v4 offset:21504
    ds_read_b128 v[62:65], v4 offset:22528
    ds_read_b128 v[66:69], v4 offset:23552
    s_waitcnt lgkmcnt(7)
    v_mfma_f32_32x32x16_bf16 v[22:37], a[64:67], v[38:41], v[22:37]
    s_waitcnt lgkmcnt(6)
    v_mfma_f32_32x32x16_bf16 v[22:37], a[68:71], v[42:45], v[22:37]
    s_waitcnt lgkmcnt(5)
    v_mfma_f32_32x32x16_bf16 v[22:37], a[72:75], v[46:49], v[22:37]
    s_waitcnt lgkmcnt(4)
    v_mfma_f32_32x32x16_bf16 v[22:37], a[76:79], v[50:53], v[22:37]
    s_waitcnt lgkmcnt(3)
    v_mfma_f32_32x32x16_bf16 v[22:37], a[80:83], v[54:57], v[22:37]
    s_waitcnt lgkmcnt(2)
    v_mfma_f32_32x32x16_bf16 v[22:37], a[84:87], v[58:61], v[22:37]
    s_waitcnt lgkmcnt(1)
    v_mfma_f32_32x32x16_bf16 v[22:37], a[88:91], v[62:65], v[22:37]
    s_waitcnt lgkmcnt(0)
    v_mfma_f32_32x32x16_bf16 v[22:37], a[92:95], v[66:69], v[22:37]
    s_waitcnt vmcnt(1)
    s_barrier
    ds_read_b128 v[38:41], v4 offset:24576
    ds_read_b128 v[42:45], v4 offset:25600
    ds_read_b128 v[46:49], v4 offset:26624
    ds_read_b128 v[50:53], v4 offset:27648
    ds_read_b128 v[54:57], v4 offset:28672
    ds_read_b128 v[58:61], v4 offset:29696
    ds_read_b128 v[62:65], v4 offset:30720
    ds_read_b128 v[66:69], v4 offset:31744
    s_waitcnt lgkmcnt(7)
    v_mfma_f32_32x32x16_bf16 v[22:37], a[96:99], v[38:41], v[22:37]
    s_waitcnt lgkmcnt(6)
    v_mfma_f32_32x32x16_bf16 v[22:37], a[100:103], v[42:45], v[22:37]
    s_waitcnt lgkmcnt(5)
    v_mfma_f32_32x32x16_bf16 v[22:37], a[104:107], v[46:49], v[22:37]
    s_waitcnt lgkmcnt(4)
    v_mfma_f32_32x32x16_bf16 v[22:37], a[108:111], v[50:53], v[22:37]
    s_waitcnt lgkmcnt(3)
    v_mfma_f32_32x32x16_bf16 v[22:37], a[112:115], v[54:57], v[22:37]
    s_waitcnt lgkmcnt(2)
    v_mfma_f32_32x32x16_bf16 v[22:37], a[116:119], v[58:61], v[22:37]
    s_waitcnt lgkmcnt(1)
    v_mfma_f32_32x32x16_bf16 v[22:37], a[120:123], v[62:65], v[22:37]
    s_waitcnt lgkmcnt(0)
    v_mfma_f32_32x32x16_bf16 v[22:37], a[124:127], v[66:69], v[22:37]
    s_nop 11
    v_cvt_pk_bf16_f32 v14, v22, v23
    v_cvt_pk_bf16_f32 v15, v24, v25
    v_cvt_pk_bf16_f32 v16, v26, v27
    v_cvt_pk_bf16_f32 v17, v28, v29
    v_cvt_pk_bf16_f32 v18, v30, v31
    v_cvt_pk_bf16_f32 v19, v32, v33
    v_cvt_pk_bf16_f32 v20, v34, v35
    v_cvt_pk_bf16_f32 v21, v36, v37
    s_mul_i32 s46, s50, 327680
    s_add_u32 s46, s46, 109051904
    s_add_u32 s46, s46, s48
    v_permlane32_swap_b32 v14, v16
    v_permlane32_swap_b32 v15, v17
    v_permlane32_swap_b32 v18, v20
    v_permlane32_swap_b32 v19, v21
    buffer_store_dwordx4 v[14:17], v4, s[4:7], s46 offen offset:0 sc1
    buffer_store_dwordx4 v[18:21], v4, s[4:7], s46 offen offset:1024 sc1
    s_add_u32 s50, s50, 1
    s_cmp_lt_u32 s50, 64
    s_cbranch_scc1 L_g4top_107
    s_waitcnt vmcnt(0)
    s_barrier
    v_mov_b32 v13, 64
    buffer_store_dword v13, v10, s[4:7], 0 offen sc1
    s_endpgm
L_g4w_108:
    buffer_store_dword v13, v10, s[4:7], 0 offen sc1
L_fl_110:
    buffer_load_dword v12, v11, s[4:7], 0 offen sc1
    s_sub_u32 s27, s27, 1
    s_cbranch_scc0 L_ok_111
    s_mov_b32 s28, 22
    s_branch L_bail
L_ok_111:
    s_waitcnt vmcnt(0)
    v_cmp_gt_u32 vcc, s51, v12
    s_cbranch_vccnz L_fl_110
    s_branch L_g4ok_109
L_bail:
    v_mov_b32 v1, s28
    v_mov_b32 v2, 0
    global_store_dword v2, v1, s[20:21] offset:60
L_exit:
    s_endpgm
L_R:
    s_cmp_eq_u32 s33, 1
    s_cbranch_scc1 L_R1
    s_getpc_b64 s[28:29]
    v_lshlrev_b32 v1, 4, v0
    global_load_dwordx4 v[252:255], v1, s[28:29]
    v_add_u32 v1, 4096, v1
    global_load_dwordx4 v[252:255], v1, s[28:29]
    v_add_u32 v1, 4096, v1
    global_load_dwordx4 v[252:255], v1, s[28:29]
    v_add_u32 v1, 4096, v1
    global_load_dwordx4 v[252:255], v1, s[28:29]
    v_and_b32 v108, 63, v0
    v_mov_b32 v41, 0
    v_bfe_u32 v109, v108, 4, 1
    v_mul_u32_u24 v110, 2, v109
    v_and_b32 v111, 15, v108
    v_xor_b32 v110, v110, v111
    v_bfe_u32 v109, v108, 4, 2
    v_mul_u32_u24 v88, 8192, v109
    s_mul_i32 s28, s26, 131072
    v_add_u32 v88, s28, v88
    v_lshl_add_u32 v88, v110, 4, v88
    v_bfe_u32 v109, v108, 4, 2
    v_mul_u32_u24 v100, 8192, v109
    s_mul_i32 s28, s26, 131072
    v_add_u32 v100, s28, v100
    v_add_u32 v100, 524288, v100
    v_lshl_add_u32 v100, v110, 4, v100
    v_bfe_u32 v109, v108, 5, 1
    v_mul_u32_u24 v110, 2, v109
    v_and_b32 v111, 7, v108
    v_xor_b32 v110, v110, v111
    v_bfe_u32 v109, v108, 3, 3
    v_mul_u32_u24 v92, 1280, v109
    s_mul_i32 s28, s26, 40960
    v_add_u32 v92, s28, v92
    v_lshl_add_u32 v92, v110, 4, v92
    v_bfe_u32 v109, v108, 4, 1
    v_mul_u32_u24 v110, 2, v109
    v_add_u32 v110, 4, v110
    v_and_b32 v111, 15, v108
    v_xor_b32 v110, v110, v111
    v_bfe_u32 v109, v108, 4, 2
    v_mul_u32_u24 v89, 8192, v109
    s_mul_i32 s28, s26, 131072
    v_add_u32 v89, s28, v89
    v_add_u32 v89, 32768, v89
    v_lshl_add_u32 v89, v110, 4, v89
    v_bfe_u32 v109, v108, 4, 2
    v_mul_u32_u24 v101, 8192, v109
    s_mul_i32 s28, s26, 131072
    v_add_u32 v101, s28, v101
    v_add_u32 v101, 557056, v101
    v_lshl_add_u32 v101, v110, 4, v101
    v_bfe_u32 v109, v108, 5, 1
    v_mul_u32_u24 v110, 2, v109
    v_add_u32 v110, 4, v110
    v_and_b32 v111, 7, v108
    v_xor_b32 v110, v110, v111
    v_bfe_u32 v109, v108, 3, 3
    v_mul_u32_u24 v93, 1280, v109
    s_mul_i32 s28, s26, 40960
    v_add_u32 v93, s28, v93
    v_add_u32 v93, 10240, v93
    v_lshl_add_u32 v93, v110, 4, v93
    v_bfe_u32 v109, v108, 4, 1
    v_mul_u32_u24 v110, 2, v109
    v_add_u32 v110, 8, v110
    v_and_b32 v111, 15, v108
    v_xor_b32 v110, v110, v111
    v_bfe_u32 v109, v108, 4, 2
    v_mul_u32_u24 v90, 8192, v109
    s_mul_i32 s28, s26, 131072
    v_add_u32 v90, s28, v90
    v_add_u32 v90, 65536, v90
    v_lshl_add_u32 v90, v110, 4, v90
    v_bfe_u32 v109, v108, 4, 2
    v_mul_u32_u24 v102, 8192, v109
    s_mul_i32 s28, s26, 131072
    v_add_u32 v102, s28, v102
    v_add_u32 v102, 1048576, v102
    v_lshl_add_u32 v102, v110, 4, v102
    v_bfe_u32 v109, v108, 5, 1
    v_mul_u32_u24 v110, 2, v109
    v_and_b32 v111, 7, v108
    v_xor_b32 v110, v110, v111
    v_bfe_u32 v109, v108, 3, 3
    v_mul_u32_u24 v94, 1280, v109
    s_mul_i32 s28, s26, 40960
    v_add_u32 v94, s28, v94
    v_add_u32 v94, 20480, v94
    v_lshl_add_u32 v94, v110, 4, v94
    v_bfe_u32 v109, v108, 4, 1
    v_mul_u32_u24 v110, 2, v109
    v_add_u32 v110, 12, v110
    v_and_b32 v111, 15, v108
    v_xor_b32 v110, v110, v111
    v_bfe_u32 v109, v108, 4, 2
    v_mul_u32_u24 v91, 8192, v109
    s_mul_i32 s28, s26, 131072
    v_add_u32 v91, s28, v91
    v_add_u32 v91, 98304, v91
    v_lshl_add_u32 v91, v110, 4, v91
    v_bfe_u32 v109, v108, 4, 2
    v_mul_u32_u24 v103, 8192, v109
    s_mul_i32 s28, s26, 131072
    v_add_u32 v103, s28, v103
    v_add_u32 v103, 1081344, v103
    v_lshl_add_u32 v103, v110, 4, v103
    v_bfe_u32 v109, v108, 5, 1
    v_mul_u32_u24 v110, 2, v109
    v_add_u32 v110, 4, v110
    v_and_b32 v111, 7, v108
    v_xor_b32 v110, v110, v111
    v_bfe_u32 v109, v108, 3, 3
    v_mul_u32_u24 v95, 1280, v109
    s_mul_i32 s28, s26, 40960
    v_add_u32 v95, s28, v95
    v_add_u32 v95, 30720, v95
    v_lshl_add_u32 v95, v110, 4, v95
    v_bfe_u32 v109, v108, 3, 1
    v_mul_u32_u24 v110, 8, v109
    v_bfe_u32 v109, v108, 4, 1
    v_mul_u32_u24 v109, 4, v109
    v_add_u32 v110, v110, v109
    v_bfe_u32 v109, v108, 2, 1
    v_mul_u32_u24 v109, 2, v109
    v_add_u32 v110, v110, v109
    v_bfe_u32 v109, v108, 1, 1
    v_mul_u32_u24 v111, 1, v109
    s_mul_i32 s28, s26, 4
    v_add_u32 v111, s28, v111
    v_xor_b32 v110, v110, v111
    v_bfe_u32 v109, v108, 5, 1
    v_mul_u32_u24 v96, 4096, v109
    v_bfe_u32 v109, v108, 3, 1
    v_mul_u32_u24 v109, 2048, v109
    v_add_u32 v96, v96, v109
    v_bfe_u32 v109, v108, 4, 1
    v_mul_u32_u24 v109, 1024, v109
    v_add_u32 v96, v96, v109
    v_bfe_u32 v109, v108, 2, 1
    v_mul_u32_u24 v109, 256, v109
    v_add_u32 v96, v96, v109
    v_bfe_u32 v109, v108, 0, 1
    v_mul_u32_u24 v109, 8, v109
    v_add_u32 v96, v96, v109
    v_lshl_add_u32 v96, v110, 4, v96
    v_xor_b32 v97, 32, v96
    v_bfe_u32 v109, v108, 3, 1
    v_mul_u32_u24 v110, 4, v109
    v_bfe_u32 v109, v108, 4, 1
    v_mul_u32_u24 v109, 2, v109
    v_add_u32 v110, v110, v109
    v_bfe_u32 v109, v108, 1, 1
    v_mul_u32_u24 v111, 1, v109
    s_mul_i32 s28, s26, 2
    v_add_u32 v111, s28, v111
    v_xor_b32 v110, v110, v111
    v_bfe_u32 v109, v108, 5, 1
    v_mul_u32_u24 v98, 2048, v109
    v_bfe_u32 v109, v108, 3, 1
    v_mul_u32_u24 v109, 1024, v109
    v_add_u32 v98, v98, v109
    v_bfe_u32 v109, v108, 4, 1
    v_mul_u32_u24 v109, 512, v109
    v_add_u32 v98, v98, v109
    v_bfe_u32 v109, v108, 2, 1
    v_mul_u32_u24 v109, 128, v109
    v_add_u32 v98, v98, v109
    v_bfe_u32 v109, v108, 0, 1
    v_mul_u32_u24 v109, 8, v109
    v_add_u32 v98, v98, v109
    v_lshl_add_u32 v98, v110, 4, v98
    s_lshl_b32 s29, s24, 8
    s_mul_i32 s45, s25, 2621440
    s_sub_u32 s46, 2621440, s45
    s_add_u32 s45, s45, s29
    s_add_u32 s46, s46, s29
    s_mul_i32 s47, s24, 163840
    s_mul_i32 s29, s25, 640
    s_add_u32 s47, s47, s29
    s_lshl_b32 s61, s26, 12
    s_mov_b32 s38, 5242880
    s_mov_b32 s39, 0x20000
    s_mov_b32 s36, s12
    s_and_b32 s37, s13, 0xffff
    s_add_u32 s28, s45, 0
    s_add_u32 m0, s61, 49152
    s_nop 0
    buffer_load_dwordx4 v88, s[36:39], s28 offen nt lds
    s_add_u32 m0, s61, 50176
    s_nop 0
    buffer_load_dwordx4 v89, s[36:39], s28 offen nt lds
    s_add_u32 m0, s61, 51200
    s_nop 0
    buffer_load_dwordx4 v90, s[36:39], s28 offen nt lds
    s_add_u32 m0, s61, 52224
    s_nop 0
    buffer_load_dwordx4 v91, s[36:39], s28 offen nt lds
    s_add_u32 s28, s45, 0
    s_add_u32 m0, s61, 65536
    s_nop 0
    buffer_load_dwordx4 v100, s[36:39], s28 offen nt lds
    s_add_u32 m0, s61, 66560
    s_nop 0
    buffer_load_dwordx4 v101, s[36:39], s28 offen nt lds
    s_add_u32 m0, s61, 67584
    s_nop 0
    buffer_load_dwordx4 v102, s[36:39], s28 offen nt lds
    s_add_u32 m0, s61, 68608
    s_nop 0
    buffer_load_dwordx4 v103, s[36:39], s28 offen nt lds
    s_add_u32 s28, s45, 65536
    s_add_u32 m0, s61, 81920
    s_nop 0
    buffer_load_dwordx4 v100, s[36:39], s28 offen nt lds
    s_add_u32 m0, s61, 82944
    s_nop 0
    buffer_load_dwordx4 v101, s[36:39], s28 offen nt lds
    s_add_u32 m0, s61, 83968
    s_nop 0
    buffer_load_dwordx4 v102, s[36:39], s28 offen nt lds
    s_add_u32 m0, s61, 84992
    s_nop 0
    buffer_load_dwordx4 v103, s[36:39], s28 offen nt lds
    s_add_u32 s28, s45, 1048576
    s_add_u32 m0, s61, 98304
    s_nop 0
    buffer_load_dwordx4 v100, s[36:39], s28 offen nt lds
    s_add_u32 m0, s61, 99328
    s_nop 0
    buffer_load_dwordx4 v101, s[36:39], s28 offen nt lds
    s_add_u32 m0, s61, 100352
    s_nop 0
    buffer_load_dwordx4 v102, s[36:39], s28 offen nt lds
    s_add_u32 m0, s61, 101376
    s_nop 0
    buffer_load_dwordx4 v103, s[36:39], s28 offen nt lds
    s_mov_b32 s36, s8
    s_and_b32 s37, s9, 0xffff
    s_add_u32 s28, s45, 0
    s_add_u32 m0, s61, 114688
    s_nop 0
    buffer_load_dwordx4 v88, s[36:39], s28 offen nt lds
    s_add_u32 m0, s61, 115712
    s_nop 0
    buffer_load_dwordx4 v89, s[36:39], s28 offen nt lds
    s_add_u32 m0, s61, 116736
    s_nop 0
    buffer_load_dwordx4 v90, s[36:39], s28 offen nt lds
    s_add_u32 m0, s61, 117760
    s_nop 0
    buffer_load_dwordx4 v91, s[36:39], s28 offen nt lds
    s_add_u32 s28, s45, 0
    s_add_u32 m0, s61, 131072
    s_nop 0
    buffer_load_dwordx4 v100, s[36:39], s28 offen nt lds
    s_add_u32 m0, s61, 132096
    s_nop 0
    buffer_load_dwordx4 v101, s[36:39], s28 offen nt lds
    s_add_u32 m0, s61, 133120
    s_nop 0
    buffer_load_dwordx4 v102, s[36:39], s28 offen nt lds
    s_add_u32 m0, s61, 134144
    s_nop 0
    buffer_load_dwordx4 v103, s[36:39], s28 offen nt lds
    s_waitcnt vmcnt(20)
    s_barrier
    s_add_u32 s28, s45, 65536
    s_add_u32 m0, s61, 147456
    s_nop 0
    buffer_load_dwordx4 v100, s[36:39], s28 offen nt lds
    s_add_u32 m0, s61, 148480
    s_nop 0
    buffer_load_dwordx4 v101, s[36:39], s28 offen nt lds
    s_add_u32 m0, s61, 149504
    s_nop 0
    buffer_load_dwordx4 v102, s[36:39], s28 offen nt lds
    s_add_u32 m0, s61, 150528
    s_nop 0
    buffer_load_dwordx4 v103, s[36:39], s28 offen nt lds
    v_bfe_u32 v109, v108, 0, 6
    v_mul_u32_u24 v2, 16, v109
    v_bfe_u32 v109, v108, 0, 6
    v_mul_u32_u24 v3, 16, v109
    s_mul_i32 s28, s26, 1024
    v_add_u32 v3, s28, v3
    v_bfe_u32 v109, v108, 0, 6
    v_mul_u32_u24 v4, 4, v109
    s_mul_i32 s28, s26, 256
    v_add_u32 v4, s28, v4
    v_add_u32 v4, 4096, v4
    v_bfe_u32 v109, v108, 0, 6
    v_mul_u32_u24 v5, 8, v109
    s_mul_i32 s28, s26, 512
    v_add_u32 v5, s28, v5
    v_and_b32 v110, 2, v108
    v_cmp_ne_u32 vcc, 0, v110
    v_mov_b32 v110, 0x44444444
    v_mov_b32 v111, 0xeeeeeeee
    v_cndmask_b32 v1, v110, v111, vcc
    s_add_u32 s29, s24, 16
    s_cmp_lt_u32 s24, 8
    s_cselect_b32 s29, s24, s29
    s_lshl_b32 s30, s24, 1
    s_add_u32 s30, s30, s26
    s_sub_u32 s30, s30, 40
    s_cmp_lt_u32 s24, 24
    s_cselect_b32 s58, s29, s30
    s_cselect_b32 s29, 1, 2
    s_cmp_lt_u32 s26, s29
    s_cselect_b32 s63, 1, 0
    s_cselect_b32 s29, 0, 1073741824
    v_bfe_u32 v109, v108, 2, 1
    v_mul_u32_u24 v6, 64, v109
    v_bfe_u32 v109, v108, 1, 1
    v_mul_u32_u24 v109, 32, v109
    v_add_u32 v6, v6, v109
    v_bfe_u32 v109, v108, 0, 1
    v_add_u32 v99, 49152, v96
    ds_read_b64_tr_b16 a[0:1], v99 offset:0
    ds_read_b64_tr_b16 a[2:3], v99 offset:512
    ds_read_b64_tr_b16 a[4:5], v99 offset:8192
    ds_read_b64_tr_b16 a[6:7], v99 offset:8704
    v_add_u32 v99, 49152, v97
    ds_read_b64_tr_b16 a[8:9], v99 offset:0
    ds_read_b64_tr_b16 a[10:11], v99 offset:512
    ds_read_b64_tr_b16 a[12:13], v99 offset:8192
    ds_read_b64_tr_b16 a[14:15], v99 offset:8704
    s_waitcnt lgkmcnt(0)
    s_waitcnt vmcnt(20)
    s_barrier
    s_mov_b32 s36, s10
    s_and_b32 s37, s11, 0xffff
    s_add_u32 s28, s45, 0
    s_add_u32 m0, s61, 49152
    s_nop 0
    buffer_load_dwordx4 v88, s[36:39], s28 offen nt lds
    s_add_u32 m0, s61, 50176
    s_nop 0
    buffer_load_dwordx4 v89, s[36:39], s28 offen nt lds
    s_add_u32 m0, s61, 51200
    s_nop 0
    buffer_load_dwordx4 v90, s[36:39], s28 offen nt lds
    s_add_u32 m0, s61, 52224
    s_nop 0
    buffer_load_dwordx4 v91, s[36:39], s28 offen nt lds
    v_mul_u32_u24 v109, 16, v109
    v_add_u32 v6, v6, v109
    v_bfe_u32 v109, v108, 4, 1
    v_mul_u32_u24 v109, 8, v109
    v_add_u32 v6, v6, v109
    v_bfe_u32 v109, v108, 5, 1
    v_mul_u32_u24 v109, 4, v109
    v_add_u32 v6, v6, v109
    s_mul_i32 s28, s58, 128
    v_add_u32 v6, s28, v6
    v_bfe_u32 v109, v108, 3, 1
    v_mul_u32_u24 v111, 1, v109
    v_lshl_add_u32 v111, v111, 30, s29
    v_add_u32 v6, v111, v6
    s_lshl_b32 s58, s58, 12
    v_bfe_u32 v109, v108, 4, 1
    v_mul_u32_u24 v20, 4096, v109
    v_mov_b32 v110, 16384
    v_cmp_lt_u32 vcc, 31, v108
    s_nop 1
    v_cndmask_b32 v20, v20, v110, vcc
    v_bfe_u32 v109, v108, 5, 1
    v_mul_u32_u24 v15, 8, v109
    v_bfe_u32 v109, v108, 2, 4
    v_mul_u32_u24 v23, 64, v109
    s_mul_i32 s28, s26, 1024
    v_add_u32 v23, s28, v23
    v_bfe_u32 v109, v108, 2, 2
    v_mul_u32_u24 v111, 64, v109
    s_mul_i32 s28, s26, 256
    v_add_u32 v111, s28, v111
    v_add_u32 v111, 4096, v111
    v_and_b32 v110, 50, v108
    v_cmp_eq_u32 vcc, 50, v110
    s_nop 1
    v_cndmask_b32 v23, v23, v111, vcc
    v_bfe_u32 v109, v108, 2, 2
    v_mul_u32_u24 v11, 64, v109
    v_bfe_u32 v109, v108, 5, 1
    v_mul_u32_u24 v109, 32, v109
    v_add_u32 v99, 65536, v96
    ds_read_b64_tr_b16 a[16:17], v99 offset:0
    ds_read_b64_tr_b16 a[18:19], v99 offset:512
    ds_read_b64_tr_b16 a[20:21], v99 offset:8192
    ds_read_b64_tr_b16 a[22:23], v99 offset:8704
    v_add_u32 v99, 65536, v97
    ds_read_b64_tr_b16 a[24:25], v99 offset:0
    ds_read_b64_tr_b16 a[26:27], v99 offset:512
    ds_read_b64_tr_b16 a[28:29], v99 offset:8192
    ds_read_b64_tr_b16 a[30:31], v99 offset:8704
    s_waitcnt lgkmcnt(0)
    s_waitcnt vmcnt(20)
    s_barrier
    s_add_u32 s28, s45, 0
    s_add_u32 m0, s61, 65536
    s_nop 0
    buffer_load_dwordx4 v100, s[36:39], s28 offen nt lds
    s_add_u32 m0, s61, 66560
    s_nop 0
    buffer_load_dwordx4 v101, s[36:39], s28 offen nt lds
    s_add_u32 m0, s61, 67584
    s_nop 0
    buffer_load_dwordx4 v102, s[36:39], s28 offen nt lds
    s_add_u32 m0, s61, 68608
    s_nop 0
    buffer_load_dwordx4 v103, s[36:39], s28 offen nt lds
    v_add_u32 v11, v11, v109
    v_bfe_u32 v109, v108, 0, 1
    v_mul_u32_u24 v109, 16, v109
    v_add_u32 v11, v11, v109
    v_bfe_u32 v109, v108, 4, 1
    v_mul_u32_u24 v109, 8, v109
    v_add_u32 v11, v11, v109
    v_bfe_u32 v109, v108, 1, 1
    v_mul_u32_u24 v109, 256, v109
    v_add_u32 v11, v11, v109
    s_mul_i32 s28, s26, 512
    v_add_u32 v11, s28, v11
    v_add_u32 v11, 47104, v11
    v_bfe_u32 v109, v108, 1, 1
    v_mul_u32_u24 v110, 32, v109
    v_xor_b32 v11, v11, v110
    v_bfe_u32 v109, v108, 4, 1
    v_mul_u32_u24 v110, 32, v109
    v_xor_b32 v31, v110, v2
    s_mov_b32 s0, 0x33333333
    s_mov_b32 s1, 0x33333333
    v_bfe_u32 v109, v108, 5, 1
    v_mul_u32_u24 v110, 1, v109
    s_mul_i32 s28, s26, 2
    v_add_u32 v110, s28, v110
    v_add_u32 v111, s24, v110
    v_and_b32 v111, 31, v111
    v_bfe_u32 v109, v108, 0, 3
    v_mul_u32_u24 v8, 16, v109
    v_bfe_u32 v109, v108, 4, 1
    v_mul_u32_u24 v109, 8, v109
    v_add_u32 v8, v8, v109
    v_bfe_u32 v109, v108, 3, 1
    v_mul_u32_u24 v109, 4, v109
    v_add_u32 v8, v8, v109
    v_lshl_add_u32 v8, v110, 12, v8
    v_lshl_add_u32 v8, v111, 7, v8
    v_add_u32 v99, 81920, v96
    ds_read_b64_tr_b16 a[32:33], v99 offset:0
    ds_read_b64_tr_b16 a[34:35], v99 offset:512
    ds_read_b64_tr_b16 a[36:37], v99 offset:8192
    ds_read_b64_tr_b16 a[38:39], v99 offset:8704
    v_add_u32 v99, 81920, v97
    ds_read_b64_tr_b16 a[40:41], v99 offset:0
    ds_read_b64_tr_b16 a[42:43], v99 offset:512
    ds_read_b64_tr_b16 a[44:45], v99 offset:8192
    ds_read_b64_tr_b16 a[46:47], v99 offset:8704
    s_waitcnt lgkmcnt(0)
    s_waitcnt vmcnt(20)
    s_barrier
    s_add_u32 s28, s45, 65536
    s_add_u32 m0, s61, 81920
    s_nop 0
    buffer_load_dwordx4 v100, s[36:39], s28 offen nt lds
    s_add_u32 m0, s61, 82944
    s_nop 0
    buffer_load_dwordx4 v101, s[36:39], s28 offen nt lds
    s_add_u32 m0, s61, 83968
    s_nop 0
    buffer_load_dwordx4 v102, s[36:39], s28 offen nt lds
    s_add_u32 m0, s61, 84992
    s_nop 0
    buffer_load_dwordx4 v103, s[36:39], s28 offen nt lds
    v_bfe_u32 v109, v108, 3, 1
    v_mul_u32_u24 v110, 8, v109
    v_bfe_u32 v109, v108, 5, 1
    v_mul_u32_u24 v109, 1, v109
    v_add_u32 v110, v110, v109
    s_mul_i32 s28, s26, 2
    v_add_u32 v110, s28, v110
    v_add_u32 v110, 8, v110
    v_add_u32 v111, s24, v110
    v_and_b32 v111, 31, v111
    v_bfe_u32 v109, v108, 0, 3
    v_mul_u32_u24 v7, 16, v109
    v_bfe_u32 v109, v108, 4, 1
    v_mul_u32_u24 v109, 8, v109
    v_add_u32 v7, v7, v109
    v_lshl_add_u32 v7, v110, 12, v7
    v_lshl_add_u32 v7, v111, 7, v7
    v_bfe_u32 v109, v108, 4, 2
    v_mul_u32_u24 v110, 1, v109
    v_bfe_u32 v109, v108, 2, 2
    v_mul_u32_u24 v111, 1, v109
    v_xor_b32 v110, v110, v111
    v_bfe_u32 v109, v108, 0, 4
    v_mul_u32_u24 v9, 32, v109
    s_mul_i32 s28, s26, 1024
    v_add_u32 v9, s28, v9
    v_add_u32 v9, 37888, v9
    v_lshl_add_u32 v9, v110, 3, v9
    v_bfe_u32 v109, v108, 0, 2
    v_mul_u32_u24 v110, 1, v109
    v_bfe_u32 v109, v108, 4, 1
    v_mul_u32_u24 v111, 1, v109
    v_xor_b32 v110, v110, v111
    v_bfe_u32 v109, v108, 5, 1
    v_mul_u32_u24 v10, 512, v109
    v_bfe_u32 v109, v108, 4, 1
    v_mul_u32_u24 v109, 128, v109
    v_add_u32 v99, 98304, v96
    ds_read_b64_tr_b16 a[48:49], v99 offset:0
    ds_read_b64_tr_b16 a[50:51], v99 offset:512
    ds_read_b64_tr_b16 a[52:53], v99 offset:8192
    ds_read_b64_tr_b16 a[54:55], v99 offset:8704
    v_add_u32 v99, 98304, v97
    ds_read_b64_tr_b16 a[56:57], v99 offset:0
    ds_read_b64_tr_b16 a[58:59], v99 offset:512
    ds_read_b64_tr_b16 a[60:61], v99 offset:8192
    ds_read_b64_tr_b16 a[62:63], v99 offset:8704
    s_waitcnt lgkmcnt(0)
    s_waitcnt vmcnt(20)
    s_barrier
    s_mov_b32 s36, s8
    s_and_b32 s37, s9, 0xffff
    s_add_u32 s28, s46, 0
    s_add_u32 m0, s61, 98304
    s_nop 0
    buffer_load_dwordx4 v88, s[36:39], s28 offen nt lds
    s_add_u32 m0, s61, 99328
    s_nop 0
    buffer_load_dwordx4 v89, s[36:39], s28 offen nt lds
    s_add_u32 m0, s61, 100352
    s_nop 0
    buffer_load_dwordx4 v90, s[36:39], s28 offen nt lds
    s_add_u32 m0, s61, 101376
    s_nop 0
    buffer_load_dwordx4 v91, s[36:39], s28 offen nt lds
    v_add_u32 v10, v10, v109
    v_bfe_u32 v109, v108, 2, 2
    v_mul_u32_u24 v109, 32, v109
    v_add_u32 v10, v10, v109
    v_add_u32 v10, 37888, v10
    v_lshl_add_u32 v10, v110, 3, v10
    v_xor_b32 v0, 16, v10
    v_bfe_u32 v109, v108, 0, 6
    v_mul_u32_u24 v12, 16, v109
    s_mul_i32 s28, s26, 2048
    v_add_u32 v12, s28, v12
    v_bfe_u32 v109, v108, 0, 6
    v_mul_u32_u24 v13, 16, v109
    v_bfe_u32 v109, v108, 4, 2
    v_mul_u32_u24 v14, 64, v109
    v_bfe_u32 v109, v108, 2, 2
    v_mul_u32_u24 v109, 16, v109
    v_add_u32 v14, v14, v109
    v_bfe_u32 v109, v108, 0, 1
    v_mul_u32_u24 v109, 256, v109
    v_add_u32 v14, v14, v109
    v_bfe_u32 v109, v108, 1, 1
    v_mul_u32_u24 v109, 8, v109
    v_add_u32 v14, v14, v109
    s_mul_i32 s28, s26, 1024
    v_add_u32 v14, s28, v14
    v_add_u32 v14, 8192, v14
    v_bfe_u32 v109, v108, 0, 6
    v_mul_u32_u24 v16, 16, v109
    s_mul_i32 s28, s26, 4096
    v_add_u32 v16, s28, v16
    v_add_u32 v16, 49152, v16
    v_add_u32 v17, 65536, v16
    v_bfe_u32 v109, v108, 0, 6
    v_mul_u32_u24 v110, 16, v109
    s_mul_i32 s28, s26, 1024
    v_add_u32 v110, s28, v110
    v_add_u32 v99, 114688, v96
    ds_read_b64_tr_b16 a[64:65], v99 offset:0
    ds_read_b64_tr_b16 a[66:67], v99 offset:512
    ds_read_b64_tr_b16 a[68:69], v99 offset:8192
    ds_read_b64_tr_b16 a[70:71], v99 offset:8704
    v_add_u32 v99, 114688, v97
    ds_read_b64_tr_b16 a[72:73], v99 offset:0
    ds_read_b64_tr_b16 a[74:75], v99 offset:512
    ds_read_b64_tr_b16 a[76:77], v99 offset:8192
    ds_read_b64_tr_b16 a[78:79], v99 offset:8704
    s_waitcnt lgkmcnt(0)
    s_waitcnt vmcnt(20)
    s_barrier
    s_add_u32 s28, s46, 0
    s_add_u32 m0, s61, 114688
    s_nop 0
    buffer_load_dwordx4 v100, s[36:39], s28 offen nt lds
    s_add_u32 m0, s61, 115712
    s_nop 0
    buffer_load_dwordx4 v101, s[36:39], s28 offen nt lds
    s_add_u32 m0, s61, 116736
    s_nop 0
    buffer_load_dwordx4 v102, s[36:39], s28 offen nt lds
    s_add_u32 m0, s61, 117760
    s_nop 0
    buffer_load_dwordx4 v103, s[36:39], s28 offen nt lds
    v_add_u32 v110, 37888, v110
    v_mov_b32 v116, 0
    v_mov_b32 v117, 0
    v_mov_b32 v118, 0
    v_mov_b32 v119, 0
    ds_write_b128 v110, v[116:119]
    s_waitcnt lgkmcnt(0)
    s_lshl_b32 s56, s26, 10
    s_lshl_b32 s64, s26, 8
    s_add_u32 s64, s64, 4096
    v_mov_b32 v36, 0x3f803f80
    v_mov_b32 v32, 0
    v_mov_b32 v40, 0
    v_mov_b32 v37, 0x3f803f80
    v_mov_b32 v33, 0
    v_mov_b32 v41, 0
    v_mov_b32 v38, 0x3f803f80
    v_mov_b32 v34, 0
    v_mov_b32 v42, 0
    v_mov_b32 v39, 0x3f803f80
    v_mov_b32 v35, 0
    v_mov_b32 v43, 0
    v_mov_b32 v22, 2147483648
    v_and_b32 v110, 1, v108
    v_lshlrev_b32 v110, 4, v110
    v_mov_b32 v109, 0x3f80
    v_lshlrev_b32 v30, v110, v109
    s_mov_b32 s72, 0x3e0293ee
    s_mov_b32 s73, 0x3e0293ee
    s_mov_b32 s67, 0x4e800000
    s_mov_b32 s68, 0x30800000
    s_lshl_b32 s57, s24, 21
    s_add_u32 s57, s57, 0
    s_lshl_b32 s62, s24, 7
    s_add_u32 s62, s62, 71305216
    s_add_u32 s65, s57, 1572864
    s_mov_b32 s66, 68419584
    v_add_u32 v99, 131072, v96
    ds_read_b64_tr_b16 a[80:81], v99 offset:0
    ds_read_b64_tr_b16 a[82:83], v99 offset:512
    ds_read_b64_tr_b16 a[84:85], v99 offset:8192
    ds_read_b64_tr_b16 a[86:87], v99 offset:8704
    v_add_u32 v99, 131072, v97
    ds_read_b64_tr_b16 a[88:89], v99 offset:0
    ds_read_b64_tr_b16 a[90:91], v99 offset:512
    ds_read_b64_tr_b16 a[92:93], v99 offset:8192
    ds_read_b64_tr_b16 a[94:95], v99 offset:8704
    s_waitcnt lgkmcnt(0)
    s_waitcnt vmcnt(20)
    s_barrier
    s_add_u32 s28, s46, 65536
    s_add_u32 m0, s61, 131072
    s_nop 0
    buffer_load_dwordx4 v100, s[36:39], s28 offen nt lds
    s_add_u32 m0, s61, 132096
    s_nop 0
    buffer_load_dwordx4 v101, s[36:39], s28 offen nt lds
    s_add_u32 m0, s61, 133120
    s_nop 0
    buffer_load_dwordx4 v102, s[36:39], s28 offen nt lds
    s_add_u32 m0, s61, 134144
    s_nop 0
    buffer_load_dwordx4 v103, s[36:39], s28 offen nt lds
    v_add_u32 v99, 147456, v96
    ds_read_b64_tr_b16 a[96:97], v99 offset:0
    ds_read_b64_tr_b16 a[98:99], v99 offset:512
    ds_read_b64_tr_b16 a[100:101], v99 offset:8192
    ds_read_b64_tr_b16 a[102:103], v99 offset:8704
    v_add_u32 v99, 147456, v97
    ds_read_b64_tr_b16 a[104:105], v99 offset:0
    ds_read_b64_tr_b16 a[106:107], v99 offset:512
    ds_read_b64_tr_b16 a[108:109], v99 offset:8192
    ds_read_b64_tr_b16 a[110:111], v99 offset:8704
    s_waitcnt lgkmcnt(0)
    s_waitcnt vmcnt(20)
    s_barrier
    s_add_u32 s28, s46, 1048576
    s_add_u32 m0, s61, 147456
    s_nop 0
    buffer_load_dwordx4 v100, s[36:39], s28 offen nt lds
    s_add_u32 m0, s61, 148480
    s_nop 0
    buffer_load_dwordx4 v101, s[36:39], s28 offen nt lds
    s_add_u32 m0, s61, 149504
    s_nop 0
    buffer_load_dwordx4 v102, s[36:39], s28 offen nt lds
    s_add_u32 m0, s61, 150528
    s_nop 0
    buffer_load_dwordx4 v103, s[36:39], s28 offen nt lds
    v_add_u32 v99, 49152, v96
    ds_read_b64_tr_b16 a[112:113], v99 offset:0
    ds_read_b64_tr_b16 a[114:115], v99 offset:512
    ds_read_b64_tr_b16 a[116:117], v99 offset:8192
    ds_read_b64_tr_b16 a[118:119], v99 offset:8704
    v_add_u32 v99, 49152, v97
    ds_read_b64_tr_b16 a[120:121], v99 offset:0
    ds_read_b64_tr_b16 a[122:123], v99 offset:512
    ds_read_b64_tr_b16 a[124:125], v99 offset:8192
    ds_read_b64_tr_b16 a[126:127], v99 offset:8704
    s_waitcnt lgkmcnt(0)
    s_waitcnt vmcnt(20)
    s_barrier
    s_add_u32 s28, s46, 1114112
    s_add_u32 m0, s61, 49152
    s_nop 0
    buffer_load_dwordx4 v100, s[36:39], s28 offen nt lds
    s_add_u32 m0, s61, 50176
    s_nop 0
    buffer_load_dwordx4 v101, s[36:39], s28 offen nt lds
    s_add_u32 m0, s61, 51200
    s_nop 0
    buffer_load_dwordx4 v102, s[36:39], s28 offen nt lds
    s_add_u32 m0, s61, 52224
    s_nop 0
    buffer_load_dwordx4 v103, s[36:39], s28 offen nt lds
    v_add_u32 v99, 65536, v96
    ds_read_b64_tr_b16 a[128:129], v99 offset:0
    ds_read_b64_tr_b16 a[130:131], v99 offset:512
    ds_read_b64_tr_b16 a[132:133], v99 offset:8192
    ds_read_b64_tr_b16 a[134:135], v99 offset:8704
    v_add_u32 v99, 65536, v97
    ds_read_b64_tr_b16 a[136:137], v99 offset:0
    ds_read_b64_tr_b16 a[138:139], v99 offset:512
    ds_read_b64_tr_b16 a[140:141], v99 offset:8192
    ds_read_b64_tr_b16 a[142:143], v99 offset:8704
    s_waitcnt lgkmcnt(0)
    s_waitcnt vmcnt(20)
    s_barrier
    s_mov_b32 s36, s10
    s_and_b32 s37, s11, 0xffff
    s_add_u32 s28, s46, 0
    s_add_u32 m0, s61, 65536
    s_nop 0
    buffer_load_dwordx4 v88, s[36:39], s28 offen nt lds
    s_add_u32 m0, s61, 66560
    s_nop 0
    buffer_load_dwordx4 v89, s[36:39], s28 offen nt lds
    s_add_u32 m0, s61, 67584
    s_nop 0
    buffer_load_dwordx4 v90, s[36:39], s28 offen nt lds
    s_add_u32 m0, s61, 68608
    s_nop 0
    buffer_load_dwordx4 v91, s[36:39], s28 offen nt lds
    v_add_u32 v99, 81920, v96
    ds_read_b64_tr_b16 a[144:145], v99 offset:0
    ds_read_b64_tr_b16 a[146:147], v99 offset:512
    ds_read_b64_tr_b16 a[148:149], v99 offset:8192
    ds_read_b64_tr_b16 a[150:151], v99 offset:8704
    v_add_u32 v99, 81920, v97
    ds_read_b64_tr_b16 a[152:153], v99 offset:0
    ds_read_b64_tr_b16 a[154:155], v99 offset:512
    ds_read_b64_tr_b16 a[156:157], v99 offset:8192
    ds_read_b64_tr_b16 a[158:159], v99 offset:8704
    s_waitcnt lgkmcnt(0)
    s_waitcnt vmcnt(20)
    s_barrier
    s_add_u32 s28, s46, 0
    s_add_u32 m0, s61, 81920
    s_nop 0
    buffer_load_dwordx4 v100, s[36:39], s28 offen nt lds
    s_add_u32 m0, s61, 82944
    s_nop 0
    buffer_load_dwordx4 v101, s[36:39], s28 offen nt lds
    s_add_u32 m0, s61, 83968
    s_nop 0
    buffer_load_dwordx4 v102, s[36:39], s28 offen nt lds
    s_add_u32 m0, s61, 84992
    s_nop 0
    buffer_load_dwordx4 v103, s[36:39], s28 offen nt lds
    v_add_u32 v99, 98304, v96
    ds_read_b64_tr_b16 a[160:161], v99 offset:0
    ds_read_b64_tr_b16 a[162:163], v99 offset:512
    ds_read_b64_tr_b16 a[164:165], v99 offset:8192
    ds_read_b64_tr_b16 a[166:167], v99 offset:8704
    v_add_u32 v99, 98304, v97
    ds_read_b64_tr_b16 a[168:169], v99 offset:0
    ds_read_b64_tr_b16 a[170:171], v99 offset:512
    ds_read_b64_tr_b16 a[172:173], v99 offset:8192
    ds_read_b64_tr_b16 a[174:175], v99 offset:8704
    s_waitcnt lgkmcnt(0)
    s_waitcnt vmcnt(20)
    s_barrier
    s_add_u32 s28, s46, 65536
    s_add_u32 m0, s61, 98304
    s_nop 0
    buffer_load_dwordx4 v100, s[36:39], s28 offen nt lds
    s_add_u32 m0, s61, 99328
    s_nop 0
    buffer_load_dwordx4 v101, s[36:39], s28 offen nt lds
    s_add_u32 m0, s61, 100352
    s_nop 0
    buffer_load_dwordx4 v102, s[36:39], s28 offen nt lds
    s_add_u32 m0, s61, 101376
    s_nop 0
    buffer_load_dwordx4 v103, s[36:39], s28 offen nt lds
    v_add_u32 v99, 114688, v96
    ds_read_b64_tr_b16 a[176:177], v99 offset:0
    ds_read_b64_tr_b16 a[178:179], v99 offset:512
    ds_read_b64_tr_b16 a[180:181], v99 offset:8192
    ds_read_b64_tr_b16 a[182:183], v99 offset:8704
    v_add_u32 v99, 114688, v97
    ds_read_b64_tr_b16 a[184:185], v99 offset:0
    ds_read_b64_tr_b16 a[186:187], v99 offset:512
    ds_read_b64_tr_b16 a[188:189], v99 offset:8192
    ds_read_b64_tr_b16 a[190:191], v99 offset:8704
    s_waitcnt lgkmcnt(0)
    s_waitcnt vmcnt(20)
    s_barrier
    s_add_u32 s28, s46, 1048576
    s_add_u32 m0, s61, 114688
    s_nop 0
    buffer_load_dwordx4 v100, s[36:39], s28 offen nt lds
    s_add_u32 m0, s61, 115712
    s_nop 0
    buffer_load_dwordx4 v101, s[36:39], s28 offen nt lds
    s_add_u32 m0, s61, 116736
    s_nop 0
    buffer_load_dwordx4 v102, s[36:39], s28 offen nt lds
    s_add_u32 m0, s61, 117760
    s_nop 0
    buffer_load_dwordx4 v103, s[36:39], s28 offen nt lds
    v_add_u32 v99, 131072, v96
    ds_read_b64_tr_b16 a[192:193], v99 offset:0
    ds_read_b64_tr_b16 a[194:195], v99 offset:512
    ds_read_b64_tr_b16 a[196:197], v99 offset:8192
    ds_read_b64_tr_b16 a[198:199], v99 offset:8704
    v_add_u32 v99, 131072, v97
    ds_read_b64_tr_b16 a[200:201], v99 offset:0
    ds_read_b64_tr_b16 a[202:203], v99 offset:512
    ds_read_b64_tr_b16 a[204:205], v99 offset:8192
    ds_read_b64_tr_b16 a[206:207], v99 offset:8704
    s_waitcnt lgkmcnt(0)
    s_waitcnt vmcnt(20)
    s_barrier
    s_add_u32 s28, s46, 1114112
    s_add_u32 m0, s61, 131072
    s_nop 0
    buffer_load_dwordx4 v100, s[36:39], s28 offen nt lds
    s_add_u32 m0, s61, 132096
    s_nop 0
    buffer_load_dwordx4 v101, s[36:39], s28 offen nt lds
    s_add_u32 m0, s61, 133120
    s_nop 0
    buffer_load_dwordx4 v102, s[36:39], s28 offen nt lds
    s_add_u32 m0, s61, 134144
    s_nop 0
    buffer_load_dwordx4 v103, s[36:39], s28 offen nt lds
    v_mbcnt_lo_u32_b32 v110, -1, 0
    v_bfe_u32 v111, v110, 2, 1
    v_and_b32 v110, 3, v110
    v_lshlrev_b32 v110, 6, v110
    v_lshl_add_u32 v110, v111, 2, v110
    global_load_dword v111, v110, s[20:21] sc1
    global_load_dword v124, v41, s[20:21] offset:48 sc1
    v_add_u32 v99, 147456, v96
    ds_read_b64_tr_b16 a[208:209], v99 offset:0
    ds_read_b64_tr_b16 a[210:211], v99 offset:512
    ds_read_b64_tr_b16 a[212:213], v99 offset:8192
    ds_read_b64_tr_b16 a[214:215], v99 offset:8704
    v_add_u32 v99, 147456, v97
    ds_read_b64_tr_b16 a[216:217], v99 offset:0
    ds_read_b64_tr_b16 a[218:219], v99 offset:512
    ds_read_b64_tr_b16 a[220:221], v99 offset:8192
    ds_read_b64_tr_b16 a[222:223], v99 offset:8704
    s_waitcnt lgkmcnt(0)
    s_waitcnt vmcnt(22)
    s_barrier
    s_mov_b32 s36, s14
    s_and_b32 s37, s15, 0xffff
    s_add_u32 s28, s47, 128
    s_add_u32 m0, s61, 147456
    s_nop 0
    buffer_load_dwordx4 v92, s[36:39], s28 offen nt lds
    s_add_u32 m0, s61, 148480
    s_nop 0
    buffer_load_dwordx4 v93, s[36:39], s28 offen nt lds
    s_add_u32 m0, s61, 149504
    s_nop 0
    buffer_load_dwordx4 v94, s[36:39], s28 offen nt lds
    s_add_u32 m0, s61, 150528
    s_nop 0
    buffer_load_dwordx4 v95, s[36:39], s28 offen nt lds
    v_add_u32 v99, 49152, v96
    ds_read_b64_tr_b16 a[224:225], v99 offset:0
    ds_read_b64_tr_b16 a[226:227], v99 offset:512
    ds_read_b64_tr_b16 a[228:229], v99 offset:8192
    ds_read_b64_tr_b16 a[230:231], v99 offset:8704
    v_add_u32 v99, 49152, v97
    ds_read_b64_tr_b16 a[232:233], v99 offset:0
    ds_read_b64_tr_b16 a[234:235], v99 offset:512
    ds_read_b64_tr_b16 a[236:237], v99 offset:8192
    ds_read_b64_tr_b16 a[238:239], v99 offset:8704
    s_waitcnt lgkmcnt(0)
    s_waitcnt vmcnt(22)
    s_barrier
    s_add_u32 s28, s47, 256
    s_add_u32 m0, s61, 49152
    s_nop 0
    buffer_load_dwordx4 v92, s[36:39], s28 offen nt lds
    s_add_u32 m0, s61, 50176
    s_nop 0
    buffer_load_dwordx4 v93, s[36:39], s28 offen nt lds
    s_add_u32 m0, s61, 51200
    s_nop 0
    buffer_load_dwordx4 v94, s[36:39], s28 offen nt lds
    s_add_u32 m0, s61, 52224
    s_nop 0
    buffer_load_dwordx4 v95, s[36:39], s28 offen nt lds
    v_add_u32 v99, 65536, v96
    ds_read_b64_tr_b16 a[240:241], v99 offset:0
    ds_read_b64_tr_b16 a[242:243], v99 offset:512
    ds_read_b64_tr_b16 a[244:245], v99 offset:8192
    ds_read_b64_tr_b16 a[246:247], v99 offset:8704
    v_add_u32 v99, 65536, v97
    ds_read_b64_tr_b16 a[248:249], v99 offset:0
    ds_read_b64_tr_b16 a[250:251], v99 offset:512
    ds_read_b64_tr_b16 a[252:253], v99 offset:8192
    ds_read_b64_tr_b16 a[254:255], v99 offset:8704
    s_waitcnt lgkmcnt(0)
    s_waitcnt vmcnt(22)
    s_barrier
    s_add_u32 s28, s47, 384
    s_add_u32 m0, s61, 65536
    s_nop 0
    buffer_load_dwordx4 v92, s[36:39], s28 offen nt lds
    s_add_u32 m0, s61, 66560
    s_nop 0
    buffer_load_dwordx4 v93, s[36:39], s28 offen nt lds
    s_add_u32 m0, s61, 67584
    s_nop 0
    buffer_load_dwordx4 v94, s[36:39], s28 offen nt lds
    s_add_u32 m0, s61, 68608
    s_nop 0
    buffer_load_dwordx4 v95, s[36:39], s28 offen nt lds
    v_add_u32 v99, 81920, v96
    ds_read_b64_tr_b16 v[144:145], v99 offset:0
    ds_read_b64_tr_b16 v[146:147], v99 offset:512
    ds_read_b64_tr_b16 v[148:149], v99 offset:8192
    ds_read_b64_tr_b16 v[150:151], v99 offset:8704
    v_add_u32 v99, 81920, v97
    ds_read_b64_tr_b16 v[152:153], v99 offset:0
    ds_read_b64_tr_b16 v[154:155], v99 offset:512
    ds_read_b64_tr_b16 v[156:157], v99 offset:8192
    ds_read_b64_tr_b16 v[158:159], v99 offset:8704
    s_waitcnt lgkmcnt(0)
    s_waitcnt vmcnt(22)
    s_barrier
    s_mov_b32 s36, s12
    s_and_b32 s37, s13, 0xffff
    s_add_u32 s28, s45, 1114112
    s_add_u32 m0, s61, 81920
    s_nop 0
    buffer_load_dwordx4 v100, s[36:39], s28 offen nt lds
    s_add_u32 m0, s61, 82944
    s_nop 0
    buffer_load_dwordx4 v101, s[36:39], s28 offen nt lds
    s_add_u32 m0, s61, 83968
    s_nop 0
    buffer_load_dwordx4 v102, s[36:39], s28 offen nt lds
    s_add_u32 m0, s61, 84992
    s_nop 0
    buffer_load_dwordx4 v103, s[36:39], s28 offen nt lds
    v_add_u32 v99, 98304, v96
    ds_read_b64_tr_b16 v[160:161], v99 offset:0
    ds_read_b64_tr_b16 v[162:163], v99 offset:512
    ds_read_b64_tr_b16 v[164:165], v99 offset:8192
    ds_read_b64_tr_b16 v[166:167], v99 offset:8704
    v_add_u32 v99, 98304, v97
    ds_read_b64_tr_b16 v[168:169], v99 offset:0
    ds_read_b64_tr_b16 v[170:171], v99 offset:512
    ds_read_b64_tr_b16 v[172:173], v99 offset:8192
    ds_read_b64_tr_b16 v[174:175], v99 offset:8704
    s_waitcnt lgkmcnt(0)
    s_waitcnt vmcnt(22)
    s_barrier
    s_mov_b32 s36, s8
    s_and_b32 s37, s9, 0xffff
    s_add_u32 s28, s45, 1048576
    s_add_u32 m0, s61, 98304
    s_nop 0
    buffer_load_dwordx4 v100, s[36:39], s28 offen nt lds
    s_add_u32 m0, s61, 99328
    s_nop 0
    buffer_load_dwordx4 v101, s[36:39], s28 offen nt lds
    s_add_u32 m0, s61, 100352
    s_nop 0
    buffer_load_dwordx4 v102, s[36:39], s28 offen nt lds
    s_add_u32 m0, s61, 101376
    s_nop 0
    buffer_load_dwordx4 v103, s[36:39], s28 offen nt lds
    v_add_u32 v99, 114688, v96
    ds_read_b64_tr_b16 v[176:177], v99 offset:0
    ds_read_b64_tr_b16 v[178:179], v99 offset:512
    ds_read_b64_tr_b16 v[180:181], v99 offset:8192
    ds_read_b64_tr_b16 v[182:183], v99 offset:8704
    v_add_u32 v99, 114688, v97
    ds_read_b64_tr_b16 v[184:185], v99 offset:0
    ds_read_b64_tr_b16 v[186:187], v99 offset:512
    ds_read_b64_tr_b16 v[188:189], v99 offset:8192
    ds_read_b64_tr_b16 v[190:191], v99 offset:8704
    s_waitcnt lgkmcnt(0)
    s_waitcnt vmcnt(22)
    s_barrier
    s_add_u32 s28, s45, 1114112
    s_add_u32 m0, s61, 114688
    s_nop 0
    buffer_load_dwordx4 v100, s[36:39], s28 offen nt lds
    s_add_u32 m0, s61, 115712
    s_nop 0
    buffer_load_dwordx4 v101, s[36:39], s28 offen nt lds
    s_add_u32 m0, s61, 116736
    s_nop 0
    buffer_load_dwordx4 v102, s[36:39], s28 offen nt lds
    s_add_u32 m0, s61, 117760
    s_nop 0
    buffer_load_dwordx4 v103, s[36:39], s28 offen nt lds
    v_add_u32 v99, 131072, v96
    ds_read_b64_tr_b16 v[192:193], v99 offset:0
    ds_read_b64_tr_b16 v[194:195], v99 offset:512
    ds_read_b64_tr_b16 v[196:197], v99 offset:8192
    ds_read_b64_tr_b16 v[198:199], v99 offset:8704
    v_add_u32 v99, 131072, v97
    ds_read_b64_tr_b16 v[200:201], v99 offset:0
    ds_read_b64_tr_b16 v[202:203], v99 offset:512
    ds_read_b64_tr_b16 v[204:205], v99 offset:8192
    ds_read_b64_tr_b16 v[206:207], v99 offset:8704
    s_waitcnt lgkmcnt(0)
    s_waitcnt vmcnt(20)
    s_barrier
    s_mov_b32 s36, s10
    s_and_b32 s37, s11, 0xffff
    s_add_u32 s28, s45, 1048576
    s_add_u32 m0, s61, 131072
    s_nop 0
    buffer_load_dwordx4 v100, s[36:39], s28 offen nt lds
    s_add_u32 m0, s61, 132096
    s_nop 0
    buffer_load_dwordx4 v101, s[36:39], s28 offen nt lds
    s_add_u32 m0, s61, 133120
    s_nop 0
    buffer_load_dwordx4 v102, s[36:39], s28 offen nt lds
    s_add_u32 m0, s61, 134144
    s_nop 0
    buffer_load_dwordx4 v103, s[36:39], s28 offen nt lds
    s_cmp_eq_u32 s33, 1
    s_cbranch_scc1 L_cs_114
    s_branch L_cenc_116
L_cen_115:
    global_load_dword v111, v110, s[20:21] sc1
    s_sub_u32 s27, s27, 1
    s_cbranch_scc0 L_ok_117
    s_mov_b32 s28, 10
    s_branch L_bail
L_ok_117:
    s_waitcnt vmcnt(0)
L_cenc_116:
    s_mov_b32 s29, 0
    v_readlane_b32 s30, v111, 0
    s_nop 0
    s_add_u32 s29, s29, s30
    v_readlane_b32 s30, v111, 1
    s_nop 0
    s_add_u32 s29, s29, s30
    v_readlane_b32 s30, v111, 2
    s_nop 0
    s_add_u32 s29, s29, s30
    v_readlane_b32 s30, v111, 3
    s_nop 0
    s_add_u32 s29, s29, s30
    v_readlane_b32 s30, v111, 4
    s_nop 0
    s_add_u32 s29, s29, s30
    v_readlane_b32 s30, v111, 5
    s_nop 0
    s_add_u32 s29, s29, s30
    v_readlane_b32 s30, v111, 6
    s_nop 0
    s_add_u32 s29, s29, s30
    v_readlane_b32 s30, v111, 7
    s_nop 0
    s_add_u32 s29, s29, s30
    s_cmp_lt_u32 s29, 256
    s_cbranch_scc1 L_cen_115
    v_cmp_ne_u32 vcc, 32, v111
    s_cbranch_vccnz L_fallback
L_cs_114:
L_w_118:
    v_cmp_eq_u32 vcc, 0, v124
    s_cbranch_vccz L_wok_119
    global_load_dword v124, v41, s[20:21] offset:48 sc1
    s_sub_u32 s27, s27, 1
    s_cbranch_scc0 L_ok_120
    s_mov_b32 s28, 8
    s_branch L_bail
L_ok_120:
    s_waitcnt vmcnt(0)
    s_branch L_w_118
L_wok_119:
    v_readfirstlane_b32 s29, v124
    s_nop 0
    s_and_b32 s29, s29, 1
    s_lshl_b32 s30, s29, 13
    s_add_u32 s66, s66, s30
    s_xor_b32 s29, s29, s24
    s_and_b32 s29, s29, 1
    s_lshl_b32 s29, s29, 13
    s_add_u32 s65, s65, s29
    v_add_u32 v99, 147456, v98
    ds_read_b64_tr_b16 v[208:209], v99 offset:0
    ds_read_b64_tr_b16 v[210:211], v99 offset:256
    ds_read_b64_tr_b16 v[212:213], v99 offset:4096
    ds_read_b64_tr_b16 v[214:215], v99 offset:4352
    ds_read_b64_tr_b16 v[216:217], v99 offset:8192
    ds_read_b64_tr_b16 v[218:219], v99 offset:8448
    ds_read_b64_tr_b16 v[220:221], v99 offset:12288
    ds_read_b64_tr_b16 v[222:223], v99 offset:12544
    s_waitcnt lgkmcnt(0)
    s_waitcnt vmcnt(20)
    s_barrier
    s_add_u32 s28, s45, 1114112
    s_add_u32 m0, s61, 147456
    s_nop 0
    buffer_load_dwordx4 v100, s[36:39], s28 offen nt lds
    s_add_u32 m0, s61, 148480
    s_nop 0
    buffer_load_dwordx4 v101, s[36:39], s28 offen nt lds
    s_add_u32 m0, s61, 149504
    s_nop 0
    buffer_load_dwordx4 v102, s[36:39], s28 offen nt lds
    s_add_u32 m0, s61, 150528
    s_nop 0
    buffer_load_dwordx4 v103, s[36:39], s28 offen nt lds
    buffer_load_dword v21, v20, s[4:7], s62 offen sc1
    v_add_u32 v99, 49152, v98
    ds_read_b64_tr_b16 v[224:225], v99 offset:0
    ds_read_b64_tr_b16 v[226:227], v99 offset:256
    ds_read_b64_tr_b16 v[228:229], v99 offset:4096
    ds_read_b64_tr_b16 v[230:231], v99 offset:4352
    ds_read_b64_tr_b16 v[232:233], v99 offset:8192
    ds_read_b64_tr_b16 v[234:235], v99 offset:8448
    ds_read_b64_tr_b16 v[236:237], v99 offset:12288
    ds_read_b64_tr_b16 v[238:239], v99 offset:12544
    s_waitcnt lgkmcnt(0)
    s_waitcnt vmcnt(21)
    s_barrier
    s_mov_b32 s36, s14
    s_and_b32 s37, s15, 0xffff
    s_add_u32 s28, s47, 512
    s_add_u32 m0, s61, 49152
    s_nop 0
    buffer_load_dwordx4 v92, s[36:39], s28 offen nt lds
    s_add_u32 m0, s61, 50176
    s_nop 0
    buffer_load_dwordx4 v93, s[36:39], s28 offen nt lds
    s_add_u32 m0, s61, 51200
    s_nop 0
    buffer_load_dwordx4 v94, s[36:39], s28 offen nt lds
    s_add_u32 m0, s61, 52224
    s_nop 0
    buffer_load_dwordx4 v95, s[36:39], s28 offen nt lds
    v_add_u32 v99, 65536, v98
    ds_read_b64_tr_b16 v[240:241], v99 offset:0
    ds_read_b64_tr_b16 v[242:243], v99 offset:256
    ds_read_b64_tr_b16 v[244:245], v99 offset:4096
    ds_read_b64_tr_b16 v[246:247], v99 offset:4352
    ds_read_b64_tr_b16 v[248:249], v99 offset:8192
    ds_read_b64_tr_b16 v[250:251], v99 offset:8448
    ds_read_b64_tr_b16 v[252:253], v99 offset:12288
    ds_read_b64_tr_b16 v[254:255], v99 offset:12544
    s_waitcnt lgkmcnt(0)
    s_waitcnt vmcnt(21)
    s_barrier
    s_add_u32 s28, s47, 0
    s_add_u32 m0, s61, 65536
    s_nop 0
    buffer_load_dwordx4 v92, s[36:39], s28 offen nt lds
    s_add_u32 m0, s61, 66560
    s_nop 0
    buffer_load_dwordx4 v93, s[36:39], s28 offen nt lds
    s_add_u32 m0, s61, 67584
    s_nop 0
    buffer_load_dwordx4 v94, s[36:39], s28 offen nt lds
    s_add_u32 m0, s61, 68608
    s_nop 0
    buffer_load_dwordx4 v95, s[36:39], s28 offen nt lds
    global_load_dword v125, v41, s[20:21] offset:40 sc1
    v_add_u32 v99, 81920, v96
    ds_read_b64_tr_b16 v[44:45], v99 offset:0
    ds_read_b64_tr_b16 v[46:47], v99 offset:512
    ds_read_b64_tr_b16 v[48:49], v99 offset:8192
    ds_read_b64_tr_b16 v[50:51], v99 offset:8704
    v_add_u32 v99, 81920, v97
    ds_read_b64_tr_b16 v[52:53], v99 offset:0
    ds_read_b64_tr_b16 v[54:55], v99 offset:512
    ds_read_b64_tr_b16 v[56:57], v99 offset:8192
    ds_read_b64_tr_b16 v[58:59], v99 offset:8704
    s_waitcnt lgkmcnt(0)
    s_barrier
    v_add_u32 v99, 32768, v16
    ds_write_b128 v99, v[44:47] offset:0
    ds_write_b128 v99, v[48:51] offset:1024
    ds_write_b128 v99, v[52:55] offset:2048
    ds_write_b128 v99, v[56:59] offset:3072
    s_waitcnt lgkmcnt(0)
    s_waitcnt vmcnt(22)
    s_barrier
    v_add_u32 v99, 98304, v96
    ds_read_b64_tr_b16 v[44:45], v99 offset:0
    ds_read_b64_tr_b16 v[46:47], v99 offset:512
    ds_read_b64_tr_b16 v[48:49], v99 offset:8192
    ds_read_b64_tr_b16 v[50:51], v99 offset:8704
    v_add_u32 v99, 98304, v97
    ds_read_b64_tr_b16 v[52:53], v99 offset:0
    ds_read_b64_tr_b16 v[54:55], v99 offset:512
    ds_read_b64_tr_b16 v[56:57], v99 offset:8192
    ds_read_b64_tr_b16 v[58:59], v99 offset:8704
    s_waitcnt lgkmcnt(0)
    s_barrier
    v_add_u32 v99, 49152, v16
    ds_write_b128 v99, v[44:47] offset:0
    ds_write_b128 v99, v[48:51] offset:1024
    ds_write_b128 v99, v[52:55] offset:2048
    ds_write_b128 v99, v[56:59] offset:3072
    s_waitcnt lgkmcnt(0)
    s_waitcnt vmcnt(18)
    s_barrier
    v_add_u32 v99, 114688, v96
    ds_read_b64_tr_b16 v[44:45], v99 offset:0
    ds_read_b64_tr_b16 v[46:47], v99 offset:512
    ds_read_b64_tr_b16 v[48:49], v99 offset:8192
    ds_read_b64_tr_b16 v[50:51], v99 offset:8704
    v_add_u32 v99, 114688, v97
    ds_read_b64_tr_b16 v[52:53], v99 offset:0
    ds_read_b64_tr_b16 v[54:55], v99 offset:512
    ds_read_b64_tr_b16 v[56:57], v99 offset:8192
    ds_read_b64_tr_b16 v[58:59], v99 offset:8704
    s_waitcnt lgkmcnt(0)
    s_barrier
    v_add_u32 v99, 65536, v16
    ds_write_b128 v99, v[44:47] offset:0
    ds_write_b128 v99, v[48:51] offset:1024
    ds_write_b128 v99, v[52:55] offset:2048
    ds_write_b128 v99, v[56:59] offset:3072
    s_waitcnt lgkmcnt(0)
    s_waitcnt vmcnt(14)
    s_barrier
    v_add_u32 v99, 131072, v96
    ds_read_b64_tr_b16 v[44:45], v99 offset:0
    ds_read_b64_tr_b16 v[46:47], v99 offset:512
    ds_read_b64_tr_b16 v[48:49], v99 offset:8192
    ds_read_b64_tr_b16 v[50:51], v99 offset:8704
    v_add_u32 v99, 131072, v97
    ds_read_b64_tr_b16 v[52:53], v99 offset:0
    ds_read_b64_tr_b16 v[54:55], v99 offset:512
    ds_read_b64_tr_b16 v[56:57], v99 offset:8192
    ds_read_b64_tr_b16 v[58:59], v99 offset:8704
    s_waitcnt lgkmcnt(0)
    s_barrier
    v_add_u32 v99, 81920, v16
    ds_write_b128 v99, v[44:47] offset:0
    ds_write_b128 v99, v[48:51] offset:1024
    ds_write_b128 v99, v[52:55] offset:2048
    ds_write_b128 v99, v[56:59] offset:3072
    s_waitcnt lgkmcnt(0)
    s_waitcnt vmcnt(10)
    s_barrier
    v_add_u32 v99, 147456, v96
    ds_read_b64_tr_b16 v[44:45], v99 offset:0
    ds_read_b64_tr_b16 v[46:47], v99 offset:512
    ds_read_b64_tr_b16 v[48:49], v99 offset:8192
    ds_read_b64_tr_b16 v[50:51], v99 offset:8704
    v_add_u32 v99, 147456, v97
    ds_read_b64_tr_b16 v[52:53], v99 offset:0
    ds_read_b64_tr_b16 v[54:55], v99 offset:512
    ds_read_b64_tr_b16 v[56:57], v99 offset:8192
    ds_read_b64_tr_b16 v[58:59], v99 offset:8704
    s_waitcnt lgkmcnt(0)
    s_barrier
    v_add_u32 v99, 98304, v16
    ds_write_b128 v99, v[44:47] offset:0
    ds_write_b128 v99, v[48:51] offset:1024
    ds_write_b128 v99, v[52:55] offset:2048
    ds_write_b128 v99, v[56:59] offset:3072
    s_waitcnt lgkmcnt(0)
    s_waitcnt vmcnt(5)
    s_barrier
L_w_121:
    v_add_u32 v110, v21, v15
    v_cmp_gt_u32 vcc, 1, v110
    s_cbranch_vccz L_wok_122
    buffer_load_dword v21, v20, s[4:7], s62 offen sc1
    s_sub_u32 s27, s27, 1
    s_cbranch_scc0 L_ok_123
    s_mov_b32 s28, 1
    s_branch L_bail
L_ok_123:
    s_waitcnt vmcnt(0)
    s_branch L_w_121
L_wok_122:
    s_lshl_b32 s61, s26, 11
    s_add_u32 s60, s57, 524288
    s_mov_b32 m0, s61
    s_nop 0
    buffer_load_dwordx4 v12, s[4:7], s57 offen sc1 lds
    buffer_load_dwordx4 v12, s[4:7], s57 offen offset:1024 sc1 lds
    s_add_u32 m0, s61, 8192
    s_nop 0
    buffer_load_dwordx4 v12, s[4:7], s60 offen sc1 lds
    buffer_load_dwordx4 v12, s[4:7], s60 offen offset:1024 sc1 lds
    v_add_u32 v99, 49152, v98
    ds_read_b64_tr_b16 v[44:45], v99 offset:0
    ds_read_b64_tr_b16 v[46:47], v99 offset:256
    ds_read_b64_tr_b16 v[48:49], v99 offset:4096
    ds_read_b64_tr_b16 v[50:51], v99 offset:4352
    ds_read_b64_tr_b16 v[52:53], v99 offset:8192
    ds_read_b64_tr_b16 v[54:55], v99 offset:8448
    ds_read_b64_tr_b16 v[56:57], v99 offset:12288
    ds_read_b64_tr_b16 v[58:59], v99 offset:12544
    s_waitcnt lgkmcnt(0)
    s_barrier
    v_add_u32 v99, 0, v16
    ds_write_b128 v99, v[44:47] offset:0
    ds_write_b128 v99, v[48:51] offset:1024
    ds_write_b128 v99, v[52:55] offset:2048
    ds_write_b128 v99, v[56:59] offset:3072
    s_waitcnt lgkmcnt(0)
    s_waitcnt vmcnt(5)
    s_barrier
    v_add_u32 v99, 65536, v98
    ds_read_b64_tr_b16 v[44:45], v99 offset:0
    ds_read_b64_tr_b16 v[46:47], v99 offset:256
    ds_read_b64_tr_b16 v[48:49], v99 offset:4096
    ds_read_b64_tr_b16 v[50:51], v99 offset:4352
    ds_read_b64_tr_b16 v[52:53], v99 offset:8192
    ds_read_b64_tr_b16 v[54:55], v99 offset:8448
    ds_read_b64_tr_b16 v[56:57], v99 offset:12288
    ds_read_b64_tr_b16 v[58:59], v99 offset:12544
    s_waitcnt lgkmcnt(0)
    s_barrier
    v_add_u32 v99, 16384, v16
    ds_write_b128 v99, v[44:47] offset:0
    ds_write_b128 v99, v[48:51] offset:1024
    ds_write_b128 v99, v[52:55] offset:2048
    ds_write_b128 v99, v[56:59] offset:3072
    s_waitcnt lgkmcnt(0)
    s_waitcnt vmcnt(0)
L_w_124:
    v_cmp_gt_u32 vcc, 32, v125
    s_cbranch_vccz L_wok_125
    global_load_dword v125, v41, s[20:21] offset:40 sc1
    s_sub_u32 s27, s27, 1
    s_cbranch_scc0 L_ok_126
    s_mov_b32 s28, 2
    s_branch L_bail
L_ok_126:
    s_waitcnt vmcnt(0)
    s_branch L_w_124
L_wok_125:
    s_barrier
    v_mov_b32 v108, 0
    v_mov_b32 v116, 0
    v_mov_b32 v124, 0
    v_mov_b32 v109, 0
    v_mov_b32 v117, 0
    v_mov_b32 v125, 0
    v_mov_b32 v110, 0
    v_mov_b32 v118, 0
    v_mov_b32 v126, 0
    v_mov_b32 v111, 0
    v_mov_b32 v119, 0
    v_mov_b32 v127, 0
    v_mov_b32 v112, 0
    v_mov_b32 v120, 0
    v_mov_b32 v128, 0
    v_mov_b32 v113, 0
    v_mov_b32 v121, 0
    v_mov_b32 v129, 0
    v_mov_b32 v114, 0
    v_mov_b32 v122, 0
    v_mov_b32 v130, 0
    v_mov_b32 v115, 0
    v_mov_b32 v123, 0
    v_mov_b32 v131, 0
    s_mov_b32 s40, -1
    s_mov_b64 s[74:75], -1
    s_mov_b32 s69, 1073741824
    s_cmp_eq_u32 s25, 0
    s_cselect_b64 s[76:77], 0, -1
    s_bfe_u32 s41, s40, 0x10001
    s_and_b32 s29, s40, 3
    s_lshl_b32 s28, s25, 17
    s_lshl_b32 s31, s29, 15
    s_add_u32 s50, s28, s31
    s_add_u32 s50, s50, 68157440
    s_xor_b32 s51, s50, 65536
    s_add_u32 s28, s28, s66
    s_add_u32 s53, s28, s31
    s_add_u32 s54, s31, 32768
    s_and_b32 s54, s54, 131071
    s_add_u32 s54, s54, s28
    s_lshl_b32 s31, s29, 14
    s_lshl_b32 s28, s25, 12
    s_add_u32 s28, s28, s65
    s_add_u32 s42, s28, s31
    s_xor_b32 s43, s42, 4096
    s_xor_b32 s44, s42, 32768
    s_and_b32 s28, s40, 1
    s_mul_i32 s29, s28, 163840
    s_lshl_b32 s30, s25, 19
    s_add_u32 s29, s29, s30
    s_add_u32 s45, s29, 67108864
    s_add_u32 s48, s45, s58
    s_add_u32 s49, s45, 65536
    s_add_u32 s29, s40, 1
    s_min_u32 s29, s29, 63
    s_lshl_b32 s29, s29, 13
    s_add_u32 s59, s57, s29
    s_add_u32 s60, s59, 524288
    s_bfe_u32 s29, s40, 0x20001
    s_lshl_b32 s29, s29, 14
    s_lshl_b32 s30, s28, 12
    s_add_u32 s29, s29, s30
    s_lshl_b32 s30, s25, 11
    s_add_u32 s29, s29, s30
    s_add_u32 s29, s29, s65
    s_sub_u32 s70, s29, 524288
    s_cmp_eq_u32 s40, 63
    s_cselect_b64 s[46:47], -1, 0
    s_xor_b32 s28, s28, 1
    s_lshl_b32 s28, s28, 14
    s_lshl_b32 s61, s26, 11
    s_add_u32 s61, s61, s28
    s_mov_b32 s52, s50
    s_xor_b32 s55, s53, 0x20000
    s_mov_b32 s70, 1073741824
    s_branch L_enter0
L_step0:
    s_waitcnt lgkmcnt(4)
    v_smfmac_f32_16x16x64_bf16 v[124:127], v[44:47], a[0:7], v1
    ds_read_b128 v[64:67], v16 offset:32768
    v_smfmac_f32_16x16x64_bf16 v[128:131], v[44:47], a[8:15], v1
    ds_read_b128 v[68:71], v16 offset:33792
    s_add_u32 m0, s64, 41984
    s_nop 0
    buffer_load_dword v4, s[4:7], s55 offen sc1 lds
    s_waitcnt lgkmcnt(5)
    v_smfmac_f32_16x16x64_bf16 v[124:127], v[48:51], a[16:23], v1
    ds_read_b128 v[72:75], v16 offset:34816
    s_add_u32 s29, s40, 2
    s_min_u32 s29, s29, 64
    v_add_u32 v21, v21, v15
    v_cmp_gt_u32 vcc, s29, v21
    v_smfmac_f32_16x16x64_bf16 v[128:131], v[48:51], a[24:31], v1
    ds_read_b128 v[76:79], v16 offset:35840
    s_waitcnt lgkmcnt(6)
    v_smfmac_f32_16x16x64_bf16 v[124:127], v[52:55], a[32:39], v1
    ds_read_b128 v[80:83], v16 offset:49152
    s_cbranch_vccnz L_w1_129
L_w1ok_130:
    s_mov_b32 m0, s61
    s_nop 0
    buffer_load_dwordx4 v12, s[4:7], s59 offen sc1 lds
    v_smfmac_f32_16x16x64_bf16 v[128:131], v[52:55], a[40:47], v1
    ds_read_b128 v[84:87], v16 offset:50176
    s_waitcnt lgkmcnt(7)
    v_smfmac_f32_16x16x64_bf16 v[124:127], v[56:59], a[48:55], v1
    s_waitcnt lgkmcnt(6)
    s_waitcnt lgkmcnt(4)
    v_smfmac_f32_16x16x64_bf16 v[124:127], v[60:63], v[64:71], v1
    ds_read_b128 v[64:67], v16 offset:51200
    v_smfmac_f32_16x16x64_bf16 v[128:131], v[56:59], a[56:63], v1
    ds_read_b128 v[68:71], v16 offset:52224
    s_mov_b32 m0, s61
    s_nop 0
    buffer_load_dwordx4 v12, s[4:7], s59 offen offset:1024 sc1 lds
    s_waitcnt lgkmcnt(4)
    v_smfmac_f32_16x16x64_bf16 v[128:131], v[60:63], v[72:79], v1
    ds_read_b128 v[72:75], v17 offset:0
    v_smfmac_f32_16x16x64_bf16 v[108:111], v[44:47], a[64:71], v1
    ds_read_b128 v[76:79], v17 offset:1024
    v_smfmac_f32_16x16x64_bf16 v[112:115], v[44:47], a[72:79], v1
    v_add_f32 v124, v124, v126
    v_add_f32 v125, v125, v127
    v_add_f32 v126, v128, v130
    v_add_f32 v127, v129, v131
    s_waitcnt lgkmcnt(4)
    v_smfmac_f32_16x16x64_bf16 v[108:111], v[56:59], v[80:87], v1
    ds_read_b128 v[80:83], v17 offset:2048
    v_cvt_pk_bf16_f32 v128, v124, v125
    v_cvt_pk_bf16_f32 v129, v126, v127
    v_max_i32 v128, 2147483649, v128
    buffer_store_dwordx2 v[128:129], v5, s[4:7], s42 offen sc1
    v_smfmac_f32_16x16x64_bf16 v[108:111], v[48:51], a[80:87], v1
    ds_read_b128 v[84:87], v17 offset:3072
    s_waitcnt lgkmcnt(4)
    v_smfmac_f32_16x16x64_bf16 v[112:115], v[56:59], v[64:71], v1
    ds_read_b128 v[64:67], v17 offset:16384
    v_smfmac_f32_16x16x64_bf16 v[112:115], v[48:51], a[88:95], v1
    ds_read_b128 v[68:71], v17 offset:17408
    s_waitcnt lgkmcnt(4)
    v_smfmac_f32_16x16x64_bf16 v[108:111], v[60:63], v[72:79], v1
    ds_read_b128 v[72:75], v17 offset:18432
    v_smfmac_f32_16x16x64_bf16 v[108:111], v[52:55], a[96:103], v1
    ds_read_b128 v[76:79], v17 offset:19456
    v_smfmac_f32_16x16x64_bf16 v[112:115], v[52:55], a[104:111], v1
    s_waitcnt lgkmcnt(4)
    v_smfmac_f32_16x16x64_bf16 v[112:115], v[60:63], v[80:87], v1
    ds_read_b128 v[80:83], v17 offset:32768
    v_smfmac_f32_16x16x64_bf16 v[116:119], v[44:47], a[112:119], v1
    ds_read_b128 v[84:87], v17 offset:33792
    s_waitcnt lgkmcnt(4)
    v_smfmac_f32_16x16x64_bf16 v[116:119], v[56:59], v[64:71], v1
    ds_read_b128 v[64:67], v17 offset:34816
    v_smfmac_f32_16x16x64_bf16 v[120:123], v[44:47], a[120:127], v1
    ds_read_b128 v[68:71], v17 offset:35840
    v_smfmac_f32_16x16x64_bf16 v[116:119], v[48:51], a[128:135], v1
    s_waitcnt lgkmcnt(4)
    v_smfmac_f32_16x16x64_bf16 v[120:123], v[56:59], v[72:79], v1
    v_smfmac_f32_16x16x64_bf16 v[120:123], v[48:51], a[136:143], v1
    s_waitcnt vmcnt(3)
    v_cmp_eq_u32 vcc, v22, v140
    s_waitcnt lgkmcnt(2)
    v_smfmac_f32_16x16x64_bf16 v[116:119], v[60:63], v[80:87], v1
    v_smfmac_f32_16x16x64_bf16 v[116:119], v[52:55], a[144:151], v1
    s_cbranch_vccnz L_rretry_127
L_rjoin_128:
    s_barrier
    ds_read_b128 v[88:91], v2 offset:41984
    ds_read_b128 v[92:95], v2 offset:43008
    ds_read_b128 v[96:99], v2 offset:44032
    ds_read_b128 v[100:103], v2 offset:45056
    ds_read_b128 v[104:107], v2 offset:46080
    s_waitcnt lgkmcnt(5)
    v_smfmac_f32_16x16x64_bf16 v[120:123], v[60:63], v[64:71], v1
    v_smfmac_f32_16x16x64_bf16 v[120:123], v[52:55], a[152:159], v1
    s_waitcnt lgkmcnt(4)
    v_smfmac_f32_16x16x64_bf16 v[108:111], v[88:91], a[160:167], v1
    ds_read_b128 v[44:47], v13 offset:0
    v_smfmac_f32_16x16x64_bf16 v[112:115], v[88:91], a[168:175], v1
    ds_read_b128 v[48:51], v13 offset:1024
    s_waitcnt lgkmcnt(5)
    v_smfmac_f32_16x16x64_bf16 v[108:111], v[92:95], a[176:183], v1
    ds_read_b128 v[52:55], v13 offset:2048
    v_smfmac_f32_16x16x64_bf16 v[112:115], v[92:95], a[184:191], v1
    ds_read_b128 v[56:59], v13 offset:3072
    s_waitcnt lgkmcnt(6)
    v_smfmac_f32_16x16x64_bf16 v[108:111], v[96:99], a[192:199], v1
    ds_read_b128 v[60:63], v13 offset:4096
    v_smfmac_f32_16x16x64_bf16 v[112:115], v[96:99], a[200:207], v1
    ds_read_b128 v[64:67], v13 offset:5120
    s_waitcnt lgkmcnt(7)
    v_smfmac_f32_16x16x64_bf16 v[108:111], v[100:103], a[208:215], v1
    ds_read_b128 v[68:71], v13 offset:6144
    v_smfmac_f32_16x16x64_bf16 v[112:115], v[100:103], a[216:223], v1
    ds_read_b128 v[72:75], v13 offset:7168
    buffer_load_dwordx2 v[140:141], v5, s[4:7], s43 offen sc1
    s_waitcnt lgkmcnt(8)
    v_smfmac_f32_16x16x64_bf16 v[108:111], v[104:107], a[224:231], v1
    ds_read_b64_tr_b16 v[132:133], v14 offset:0
    ds_read_b64_tr_b16 v[134:135], v14 offset:4096
    v_smfmac_f32_16x16x64_bf16 v[112:115], v[104:107], a[232:239], v1
    ds_read_b64_tr_b16 v[136:137], v14 offset:512
    ds_read_b64_tr_b16 v[138:139], v14 offset:4608
    v_smfmac_f32_16x16x64_bf16 v[116:119], v[88:91], a[240:247], v1
    s_add_u32 m0, s61, 8192
    s_nop 0
    buffer_load_dwordx4 v12, s[4:7], s60 offen sc1 lds
    v_smfmac_f32_16x16x64_bf16 v[120:123], v[88:91], a[248:255], v1
    v_add_f32 v108, v108, v110
    v_add_f32 v109, v109, v111
    v_add_f32 v112, v112, v114
    v_add_f32 v113, v113, v115
    v_cvt_pk_bf16_f32 v108, v108, v109
    v_cvt_pk_bf16_f32 v109, v112, v113
    ds_write2_b32 v9, v108, v109 offset0:0 offset1:128
    v_smfmac_f32_16x16x64_bf16 v[116:119], v[92:95], v[144:151], v1
    buffer_load_dwordx2 v[28:29], v5, s[4:7], s43 offen sc1
    v_smfmac_f32_16x16x64_bf16 v[120:123], v[92:95], v[152:159], v1
    v_xor_b32 v13, 16384, v13
    v_smfmac_f32_16x16x64_bf16 v[116:119], v[96:99], v[160:167], v1
    s_add_u32 m0, s61, 8192
    s_nop 0
    buffer_load_dwordx4 v12, s[4:7], s60 offen offset:1024 sc1 lds
    v_smfmac_f32_16x16x64_bf16 v[120:123], v[96:99], v[168:175], v1
    v_xor_b32 v14, 16384, v14
    s_waitcnt lgkmcnt(0)
    s_barrier
    ds_read_b64_tr_b16 v[76:77], v10 offset:0
    ds_read_b64_tr_b16 v[78:79], v0 offset:256
    v_smfmac_f32_16x16x64_bf16 v[116:119], v[100:103], v[176:183], v1
    ds_read_b64_tr_b16 v[80:81], v10 offset:1024
    ds_read_b64_tr_b16 v[82:83], v0 offset:1280
    v_smfmac_f32_16x16x64_bf16 v[120:123], v[100:103], v[184:191], v1
    ds_read_b64_tr_b16 v[84:85], v10 offset:2048
    ds_read_b64_tr_b16 v[86:87], v0 offset:2304
    v_smfmac_f32_16x16x64_bf16 v[116:119], v[104:107], v[192:199], v1
    buffer_load_dword v21, v20, s[4:7], s62 offen sc1
    ds_read_b64_tr_b16 v[88:89], v10 offset:3072
    ds_read_b64_tr_b16 v[90:91], v0 offset:3328
    v_smfmac_f32_16x16x64_bf16 v[120:123], v[104:107], v[200:207], v1
    s_waitcnt lgkmcnt(4)
    v_mfma_f32_16x16x32_bf16 v[108:111], v[44:47], v[76:79], 0
    v_mfma_f32_16x16x32_bf16 v[108:111], v[48:51], v[80:83], v[108:111]
    buffer_store_dwordx2 v[22:23], v5, s[4:7], s44 offen sc1
    s_waitcnt lgkmcnt(0)
    v_mfma_f32_16x16x32_bf16 v[108:111], v[52:55], v[84:87], v[108:111]
    v_add_f32 v116, v116, v118
    v_add_f32 v117, v117, v119
    v_add_f32 v120, v120, v122
    v_mfma_f32_16x16x32_bf16 v[108:111], v[56:59], v[88:91], v[108:111]
    v_add_f32 v121, v121, v123
    v_cvt_pk_bf16_f32 v142, v116, v117
    v_cvt_pk_bf16_f32 v143, v120, v121
    ds_write2st64_b32 v9, v142, v143 offset0:16 offset1:18
    v_mfma_f32_16x16x32_bf16 v[112:115], v[60:63], v[76:79], 0
    v_mfma_f32_16x16x32_bf16 v[112:115], v[64:67], v[80:83], v[112:115]
    buffer_store_dword v22, v6, s[4:7], s54 offen sc1
    v_exp_f32 v108, v108
    v_exp_f32 v109, v109
    v_exp_f32 v110, v110
    v_exp_f32 v111, v111
    v_cvt_pk_bf16_f32 v128, v108, v109
    v_cvt_pk_bf16_f32 v129, v110, v111
    s_waitcnt lgkmcnt(0)
    s_barrier
    ds_read_b64_tr_b16 v[92:93], v10 offset:4096
    ds_read_b64_tr_b16 v[94:95], v0 offset:4352
    v_mfma_f32_16x16x32_bf16 v[112:115], v[68:71], v[84:87], v[112:115]
    ds_read_b64_tr_b16 v[96:97], v10 offset:5120
    ds_read_b64_tr_b16 v[98:99], v0 offset:5376
    v_mfma_f32_16x16x32_bf16 v[112:115], v[72:75], v[88:91], v[112:115]
    ds_read_b64_tr_b16 v[100:101], v10 offset:6144
    ds_read_b64_tr_b16 v[102:103], v0 offset:6400
    ds_read_b64_tr_b16 v[104:105], v10 offset:7168
    ds_read_b64_tr_b16 v[106:107], v0 offset:7424
    s_waitcnt lgkmcnt(4)
    v_mfma_f32_16x16x32_bf16 v[120:123], v[92:95], v[76:79], 0
    v_mfma_f32_16x16x32_bf16 v[120:123], v[96:99], v[80:83], v[120:123]
    v_exp_f32 v112, v112
    s_waitcnt lgkmcnt(0)
    v_mfma_f32_16x16x32_bf16 v[120:123], v[100:103], v[84:87], v[120:123]
    v_exp_f32 v113, v113
    v_mfma_f32_16x16x32_bf16 v[120:123], v[104:107], v[88:91], v[120:123]
    v_exp_f32 v114, v114
    v_exp_f32 v115, v115
    v_cvt_pk_bf16_f32 v130, v112, v113
    v_cvt_pk_bf16_f32 v131, v114, v115
    s_waitcnt vmcnt(6)
L_v_131:
    v_cmp_eq_u32 vcc, v22, v140
    v_lshlrev_b32 v24, 16, v140
    v_and_b32 v25, 0xffff0000, v140
    v_lshlrev_b32 v26, 16, v141
    v_and_b32 v27, 0xffff0000, v141
    s_cbranch_vccnz L_vretry_132
    v_mfma_f32_16x16x32_bf16 v[108:111], v[132:135], v[128:131], 0
    v_mul_f32 v120, s72, v120
    v_mul_f32 v121, s72, v121
    v_mfma_f32_16x16x32_bf16 v[112:115], v[136:139], v[128:131], 0
    v_exp_f32 v120, v120
    v_mfma_f32_16x16x32_bf16 v[116:119], v[128:131], v[36:39], 0
    v_exp_f32 v121, v121
    v_add_f32 v24, v24, v124
    v_add_f32 v25, v25, v125
    v_cvt_pk_bf16_f32 v32, v24, v25
    v_cvt_pk_bf16_f32 v40, v120, v121
    v_add_f32 v26, v26, v126
    v_add_f32 v27, v27, v127
    v_cvt_pk_bf16_f32 v34, v26, v27
L_smjoin_134:
    s_nop 1
    v_mfma_f32_16x16x32_bf16 v[108:111], v[32:35], v[40:43], v[108:111]
    s_mov_b64 vcc, s[0:1]
    v_mfma_f32_16x16x32_bf16 v[112:115], v[34:37], v[40:43], v[112:115]
    v_mfma_f32_16x16x32_bf16 v[116:119], v[40:43], v[36:39], v[116:119]
    v_cndmask_b32 v24, v142, v32, s[76:77]
    v_cndmask_b32 v25, v143, v34, s[76:77]
    v_cvt_pk_bf16_f32 v108, v108, v109
    v_cvt_pk_bf16_f32 v109, v110, v111
    s_nop 0
    v_cvt_pk_bf16_f32 v110, v112, v113
    v_cvt_pk_bf16_f32 v111, v114, v115
    v_mfma_f32_16x16x32_bf16 v[92:95], v[40:43], v[42:45], 0
    v_cndmask_b32_dpp v108, v110, v108, vcc quad_perm:[0,1,0,1] row_mask:0xf bank_mask:0xf
    v_cndmask_b32_dpp v109, v111, v109, vcc quad_perm:[0,1,0,1] row_mask:0xf bank_mask:0xf
    ds_write_b64 v11, v[108:109]
    v_mfma_f32_32x32x16_bf16 v[76:91], v[40:43], v[42:45], 0
    v_max_i32 v24, 2147483649, v24
    buffer_store_dwordx2 v[24:25], v5, s[4:7], s70 offen sc1
    v_max_f32 v26, v116, v117
    v_min_f32 v27, v116, v117
    v_cmp_nge_f32 vcc, s67, v26
    v_cmp_nle_f32 s[80:81], s68, v27
    v_mfma_f32_16x16x32_bf16 v[120:123], v[36:39], v[36:39], v[120:123]
    s_waitcnt lgkmcnt(0)
    s_barrier
    ds_read_b128 v[132:135], v31 offset:47104
    ds_read_b128 v[136:139], v31 offset:48128
    v_rcp_f32 v118, v116
    s_or_b64 vcc, vcc, s[80:81]
    s_and_b64 vcc, vcc, s[74:75]
    v_rcp_f32 v119, v117
    s_or_b64 vcc, vcc, s[46:47]
    v_mfma_f32_16x16x32_bf16 v[120:123], v[36:39], v[36:39], v[120:123]
    s_cbranch_vccnz L_slowsm_133
    v_mfma_f32_16x16x32_bf16 v[120:123], v[36:39], v[36:39], v[120:123]
    ds_read_b128 v[44:47], v16 offset:0
    ds_read_b128 v[48:51], v16 offset:1024
    s_mov_b64 s[74:75], -1
    s_waitcnt lgkmcnt(3)
    v_smfmac_f32_16x16x64_bf16 v[80:83], v[132:135], v[208:215], v1
    ds_read_b128 v[52:55], v16 offset:2048
    s_waitcnt lgkmcnt(3)
    v_smfmac_f32_16x16x64_bf16 v[80:83], v[136:139], v[216:223], v1
    ds_read_b128 v[56:59], v16 offset:3072
    v_smfmac_f32_16x16x64_bf16 v[84:87], v[132:135], v[224:231], v1
    ds_read_b128 v[60:63], v16 offset:16384
    ds_read_b128 v[64:67], v16 offset:17408
    v_smfmac_f32_16x16x64_bf16 v[84:87], v[136:139], v[232:239], v1
    ds_read_b128 v[68:71], v16 offset:18432
    ds_read_b128 v[72:75], v16 offset:19456
    v_add_f32 v80, v80, v82
    v_smfmac_f32_16x16x64_bf16 v[88:91], v[132:135], v[240:247], v1
    v_add_f32 v81, v81, v83
    v_mul_f32 v80, v80, v118
    v_smfmac_f32_16x16x64_bf16 v[88:91], v[136:139], v[248:255], v1
    v_mul_f32 v81, v81, v119
    v_cvt_pk_bf16_f32 v24, v80, v81
    v_and_or_b32 v24, v24, -2, s41
    s_waitcnt lgkmcnt(6)
    v_smfmac_f32_16x16x64_bf16 v[92:95], v[132:135], v[44:51], v1
    v_add_f32 v84, v84, v86
    v_add_f32 v85, v85, v87
    v_mul_f32 v84, v84, v118
    s_waitcnt lgkmcnt(4)
    v_smfmac_f32_16x16x64_bf16 v[92:95], v[136:139], v[52:59], v1
    v_mul_f32 v85, v85, v119
    v_cvt_pk_bf16_f32 v25, v84, v85
    buffer_store_dwordx2 v[24:25], v7, s[4:7], s45 offen
    s_waitcnt lgkmcnt(2)
    v_smfmac_f32_16x16x64_bf16 v[76:79], v[132:135], v[60:67], v1
    v_add_f32 v88, v88, v90
    v_add_f32 v89, v89, v91
    v_mul_f32 v88, v88, v118
    s_waitcnt lgkmcnt(0)
    v_smfmac_f32_16x16x64_bf16 v[76:79], v[136:139], v[68:75], v1
    v_mul_f32 v89, v89, v119
    v_cvt_pk_bf16_f32 v26, v88, v89
    v_and_or_b32 v26, v26, -2, s41
    v_add_f32 v92, v92, v94
    v_add_f32 v93, v93, v95
    v_mul_f32 v92, v92, v118
    v_mul_f32 v93, v93, v119
    v_cvt_pk_bf16_f32 v27, v92, v93
    buffer_store_dwordx2 v[26:27], v7, s[4:7], s49 offen
    v_pk_add_f32 v[76:77], v[76:77], v[78:79]
    v_pk_mul_f32 v[76:77], v[76:77], v[118:119]
    v_cvt_pk_bf16_f32 v24, v76, v77
    v_and_or_b32 v24, v24, -2, s41
    buffer_store_dword v24, v8, s[4:7], s45 offen
    s_mov_b32 s52, s50
    s_xor_b32 s55, s53, 0x20000
    v_mov_b32 v124, 0
    v_mov_b32 v125, 0
    v_mov_b32 v126, 0
    v_mov_b32 v127, 0
    v_mov_b32 v128, 0
    v_mov_b32 v129, 0
    v_mov_b32 v130, 0
    v_mov_b32 v131, 0
    v_mov_b32 v108, 0
    v_mov_b32 v109, 0
    v_mov_b32 v110, 0
    v_mov_b32 v111, 0
    v_mov_b32 v112, 0
    v_mov_b32 v113, 0
    v_mov_b32 v114, 0
    v_mov_b32 v115, 0
    v_mov_b32 v116, 0
    v_mov_b32 v117, 0
    v_mov_b32 v118, 0
    v_mov_b32 v119, 0
    s_cmp_eq_u32 s63, 0
    s_cbranch_scc1 L_zrest_138
    s_mov_b32 vcc_lo, 0x3030303
    s_mov_b32 vcc_hi, 0x3030303
    v_cndmask_b32 v136, v41, v30, vcc
    s_mov_b32 vcc_lo, 0xc0c0c0c
    s_mov_b32 vcc_hi, 0xc0c0c0c
    v_cndmask_b32 v137, v41, v30, vcc
    s_mov_b32 vcc_lo, 0x30303030
    s_mov_b32 vcc_hi, 0x30303030
    v_cndmask_b32 v138, v41, v30, vcc
    s_mov_b32 vcc_lo, 0xc0c0c0c0
    s_mov_b32 vcc_hi, 0xc0c0c0c0
    v_cndmask_b32 v139, v41, v30, vcc
    buffer_load_dwordx4 v[44:47], v2, s[4:7], s48 offen offset:0 sc1
    buffer_load_dwordx4 v[48:51], v2, s[4:7], s48 offen offset:1024 sc1
    buffer_load_dwordx4 v[52:55], v2, s[4:7], s48 offen offset:2048 sc1
    buffer_load_dwordx4 v[56:59], v2, s[4:7], s48 offen offset:3072 sc1
    v_mov_b32 v18, 0
    v_mov_b32 v18, 0
    v_mov_b32 v18, 0
    v_mov_b32 v18, 0
    v_mov_b32 v18, 0
    v_mov_b32 v18, 0
    v_mov_b32 v18, 0
    v_mov_b32 v18, 0
    v_mov_b32 v18, 0
    v_mov_b32 v18, 0
    v_mov_b32 v18, 0
    v_mov_b32 v18, 0
L_rsl_135:
    buffer_load_dwordx4 v[60:63], v2, s[4:7], s48 offen offset:0 sc1
    buffer_load_dwordx4 v[64:67], v2, s[4:7], s48 offen offset:1024 sc1
    buffer_load_dwordx4 v[68:71], v2, s[4:7], s48 offen offset:2048 sc1
    buffer_load_dwordx4 v[72:75], v2, s[4:7], s48 offen offset:3072 sc1
    s_waitcnt vmcnt(7)
    v_mfma_f32_16x16x32_bf16 v[120:123], v[44:47], v[136:139], 0
    s_waitcnt vmcnt(6)
    v_mfma_f32_16x16x32_bf16 v[120:123], v[48:51], v[136:139], v[120:123]
    v_bitop3_b32 v24, v44, v48, s41 bitop3:0x7e
    s_waitcnt vmcnt(5)
    v_mfma_f32_16x16x32_bf16 v[120:123], v[52:55], v[136:139], v[120:123]
    s_waitcnt vmcnt(4)
    v_mfma_f32_16x16x32_bf16 v[120:123], v[56:59], v[136:139], v[120:123]
    v_bitop3_b32 v25, v52, v56, s41 bitop3:0x7e
    v_bitop3_b32 v24, v24, v25, 1 bitop3:0xa8
    v_cmp_ne_u32 vcc, 0, v24
    s_cbranch_vccz L_rsd_136
    buffer_load_dwordx4 v[44:47], v2, s[4:7], s48 offen offset:0 sc1
    buffer_load_dwordx4 v[48:51], v2, s[4:7], s48 offen offset:1024 sc1
    buffer_load_dwordx4 v[52:55], v2, s[4:7], s48 offen offset:2048 sc1
    buffer_load_dwordx4 v[56:59], v2, s[4:7], s48 offen offset:3072 sc1
    s_waitcnt vmcnt(7)
    v_mfma_f32_16x16x32_bf16 v[120:123], v[60:63], v[136:139], 0
    s_waitcnt vmcnt(6)
    v_mfma_f32_16x16x32_bf16 v[120:123], v[64:67], v[136:139], v[120:123]
    v_bitop3_b32 v24, v60, v64, s41 bitop3:0x7e
    s_waitcnt vmcnt(5)
    v_mfma_f32_16x16x32_bf16 v[120:123], v[68:71], v[136:139], v[120:123]
    s_waitcnt vmcnt(4)
    v_mfma_f32_16x16x32_bf16 v[120:123], v[72:75], v[136:139], v[120:123]
    v_bitop3_b32 v25, v68, v72, s41 bitop3:0x7e
    v_bitop3_b32 v24, v24, v25, 1 bitop3:0xa8
    v_cmp_ne_u32 vcc, 0, v24
    s_cbranch_vccz L_rsd_136
    s_sub_u32 s27, s27, 1
    s_cbranch_scc0 L_ok_139
    s_mov_b32 s28, 4
    s_branch L_bail
L_ok_139:
    s_branch L_rsl_135
L_rsd_136:
    s_nop 3
    v_permlane32_swap_b32 v120, v122
    v_permlane32_swap_b32 v121, v123
    v_pk_add_f32 v[120:121], v[120:121], v[122:123]
    v_cvt_pk_bf16_f32 v26, v120, v121
    v_max_i32 v26, 2147483649, v26
    buffer_store_dword v26, v6, s[4:7], s53 offen sc1
    buffer_store_dword v26, v6, s[4:7], s50 offen
    buffer_store_dword v22, v6, s[4:7], s51 offen
L_nored_137:
    s_barrier
L_enter0:
    v_mov_b32 v120, 0
    v_mov_b32 v121, 0
    v_mov_b32 v122, 0
    v_mov_b32 v123, 0
    s_add_u32 s40, s40, 1
    s_mov_b32 s69, s70
    s_bfe_u32 s41, s40, 0x10001
    s_and_b32 s29, s40, 3
    s_lshl_b32 s28, s25, 17
    s_lshl_b32 s31, s29, 15
    s_add_u32 s50, s28, s31
    s_add_u32 s50, s50, 68157440
    s_xor_b32 s51, s50, 65536
    s_add_u32 s28, s28, s66
    s_add_u32 s53, s28, s31
    s_add_u32 s54, s31, 32768
    s_and_b32 s54, s54, 131071
    s_add_u32 s54, s54, s28
    s_lshl_b32 s31, s29, 14
    s_lshl_b32 s28, s25, 12
    s_add_u32 s28, s28, s65
    s_add_u32 s42, s28, s31
    s_xor_b32 s43, s42, 4096
    s_xor_b32 s44, s42, 32768
    s_and_b32 s28, s40, 1
    s_mul_i32 s29, s28, 163840
    s_lshl_b32 s30, s25, 19
    s_add_u32 s29, s29, s30
    s_add_u32 s45, s29, 67108864
    s_add_u32 s48, s45, s58
    s_add_u32 s49, s45, 65536
    s_add_u32 s29, s40, 1
    s_min_u32 s29, s29, 63
    s_lshl_b32 s29, s29, 13
    s_add_u32 s59, s57, s29
    s_add_u32 s60, s59, 524288
    s_bfe_u32 s29, s40, 0x20001
    s_lshl_b32 s29, s29, 14
    s_lshl_b32 s30, s28, 12
    s_add_u32 s29, s29, s30
    s_lshl_b32 s30, s25, 11
    s_add_u32 s29, s29, s30
    s_add_u32 s29, s29, s65
    s_sub_u32 s70, s29, 524288
    v_mov_b32 v18, 0
    v_mov_b32 v18, 0
    v_mov_b32 v18, 0
    v_mov_b32 v18, 0
    v_mov_b32 v18, 0
    v_mov_b32 v18, 0
    v_mov_b32 v18, 0
    v_mov_b32 v18, 0
    v_mov_b32 v18, 0
    v_mov_b32 v18, 0
    v_mov_b32 v18, 0
    v_mov_b32 v18, 0
    buffer_load_dword v132, v23, s[4:7], s52 offen sc1
    s_add_u32 m0, s56, 32768
    s_nop 0
    buffer_load_dwordx4 v3, s[4:7], s52 offen sc1 lds
    s_add_u32 m0, s64, 32768
    s_nop 0
    buffer_load_dword v4, s[4:7], s52 offen sc1 lds
    s_cmp_eq_u32 s40, 63
    s_cselect_b64 s[46:47], -1, 0
    s_xor_b32 s28, s28, 1
    s_lshl_b32 s28, s28, 14
    s_lshl_b32 s61, s26, 11
    s_add_u32 s61, s61, s28
    s_waitcnt vmcnt(0)
    v_cmp_eq_u32 vcc, v22, v132
    s_cbranch_vccnz L_lspin_141
L_lok_140:
    s_barrier
    ds_read_b128 v[44:47], v2 offset:32768
    ds_read_b128 v[48:51], v2 offset:33792
    ds_read_b128 v[52:55], v2 offset:34816
    ds_read_b128 v[56:59], v2 offset:35840
    ds_read_b128 v[60:63], v2 offset:36864
    buffer_load_dword v140, v23, s[4:7], s55 offen sc1
    s_add_u32 m0, s56, 41984
    s_nop 0
    buffer_load_dwordx4 v3, s[4:7], s55 offen sc1 lds
    s_branch L_step0
L_zrest_138:
    s_branch L_nored_137
L_lspin_141:
    buffer_load_dword v133, v23, s[4:7], s52 offen sc1
    s_add_u32 m0, s56, 32768
    s_nop 0
    buffer_load_dwordx4 v3, s[4:7], s52 offen sc1 lds
    s_add_u32 m0, s64, 32768
    s_nop 0
    buffer_load_dword v4, s[4:7], s52 offen sc1 lds
L_sp_142:
    buffer_load_dword v132, v23, s[4:7], s52 offen sc1
    s_add_u32 m0, s56, 32768
    s_nop 0
    buffer_load_dwordx4 v3, s[4:7], s52 offen sc1 lds
    s_add_u32 m0, s64, 32768
    s_nop 0
    buffer_load_dword v4, s[4:7], s52 offen sc1 lds
    s_waitcnt vmcnt(3)
    v_cmp_eq_u32 vcc, v22, v133
    s_cbranch_vccz L_spo_143
    buffer_load_dword v133, v23, s[4:7], s52 offen sc1
    s_add_u32 m0, s56, 32768
    s_nop 0
    buffer_load_dwordx4 v3, s[4:7], s52 offen sc1 lds
    s_add_u32 m0, s64, 32768
    s_nop 0
    buffer_load_dword v4, s[4:7], s52 offen sc1 lds
    s_waitcnt vmcnt(3)
    v_cmp_eq_u32 vcc, v22, v132
    s_cbranch_vccz L_spo_143
    s_sub_u32 s27, s27, 1
    s_cbranch_scc0 L_ok_144
    s_mov_b32 s28, 5
    s_branch L_bail
L_ok_144:
    s_branch L_sp_142
L_spo_143:
    s_branch L_lok_140
L_rretry_127:
    buffer_load_dword v141, v23, s[4:7], s55 offen sc1
    s_add_u32 m0, s56, 41984
    s_nop 0
    buffer_load_dwordx4 v3, s[4:7], s55 offen sc1 lds
    s_add_u32 m0, s64, 41984
    s_nop 0
    buffer_load_dword v4, s[4:7], s55 offen sc1 lds
L_sp_145:
    buffer_load_dword v140, v23, s[4:7], s55 offen sc1
    s_add_u32 m0, s56, 41984
    s_nop 0
    buffer_load_dwordx4 v3, s[4:7], s55 offen sc1 lds
    s_add_u32 m0, s64, 41984
    s_nop 0
    buffer_load_dword v4, s[4:7], s55 offen sc1 lds
    s_waitcnt vmcnt(3)
    v_cmp_eq_u32 vcc, v22, v141
    s_cbranch_vccz L_spo_146
    buffer_load_dword v141, v23, s[4:7], s55 offen sc1
    s_add_u32 m0, s56, 41984
    s_nop 0
    buffer_load_dwordx4 v3, s[4:7], s55 offen sc1 lds
    s_add_u32 m0, s64, 41984
    s_nop 0
    buffer_load_dword v4, s[4:7], s55 offen sc1 lds
    s_waitcnt vmcnt(3)
    v_cmp_eq_u32 vcc, v22, v140
    s_cbranch_vccz L_spo_146
    s_sub_u32 s27, s27, 1
    s_cbranch_scc0 L_ok_147
    s_mov_b32 s28, 6
    s_branch L_bail
L_ok_147:
    s_branch L_sp_145
L_spo_146:
    s_waitcnt vmcnt(0)
    s_branch L_rjoin_128
L_w1_129:
    buffer_load_dword v21, v20, s[4:7], s62 offen sc1
    s_sub_u32 s27, s27, 1
    s_cbranch_scc0 L_ok_148
    s_mov_b32 s28, 3
    s_branch L_bail
L_ok_148:
    s_waitcnt vmcnt(0)
    v_add_u32 v21, v21, v15
    v_cmp_gt_u32 vcc, s29, v21
    s_cbranch_vccnz L_w1_129
    s_branch L_w1ok_130
L_vretry_132:
    s_waitcnt vmcnt(4)
    v_mov_b32 v140, v28
    v_mov_b32 v141, v29
    v_cmp_eq_u32 vcc, v22, v28
    s_cbranch_vccz L_v_131
L_vr2_149:
    buffer_load_dwordx2 v[140:141], v5, s[4:7], s43 offen sc1
    s_sub_u32 s27, s27, 1
    s_cbranch_scc0 L_ok_150
    s_mov_b32 s28, 7
    s_branch L_bail
L_ok_150:
    s_waitcnt vmcnt(0)
    v_cmp_eq_u32 vcc, v22, v140
    s_cbranch_vccnz L_vr2_149
    s_branch L_v_131
L_slowsm_133:
    s_cmp_eq_u32 s40, 63
    s_cbranch_scc1 L_rdone0
    s_mov_b64 s[74:75], 0
    s_waitcnt lgkmcnt(0)
    s_barrier
    v_xor_b32 v26, 16384, v13
    v_xor_b32 v27, 16384, v14
    ds_read_b128 v[44:47], v26 offset:0
    ds_read_b128 v[48:51], v26 offset:1024
    ds_read_b128 v[52:55], v26 offset:2048
    ds_read_b128 v[56:59], v26 offset:3072
    ds_read_b128 v[60:63], v26 offset:4096
    ds_read_b128 v[64:67], v26 offset:5120
    ds_read_b128 v[68:71], v26 offset:6144
    ds_read_b128 v[72:75], v26 offset:7168
    ds_read_b64_tr_b16 v[132:133], v27 offset:0
    ds_read_b64_tr_b16 v[134:135], v27 offset:4096
    ds_read_b64_tr_b16 v[136:137], v27 offset:512
    ds_read_b64_tr_b16 v[138:139], v27 offset:4608
    s_waitcnt lgkmcnt(0)
    ds_read_b64_tr_b16 v[76:77], v10 offset:0
    ds_read_b64_tr_b16 v[78:79], v0 offset:256
    ds_read_b64_tr_b16 v[92:93], v10 offset:4096
    ds_read_b64_tr_b16 v[94:95], v0 offset:4352
    s_waitcnt lgkmcnt(0)
    ds_read_b64_tr_b16 v[80:81], v10 offset:1024
    ds_read_b64_tr_b16 v[82:83], v0 offset:1280
    ds_read_b64_tr_b16 v[96:97], v10 offset:5120
    ds_read_b64_tr_b16 v[98:99], v0 offset:5376
    s_waitcnt lgkmcnt(0)
    ds_read_b64_tr_b16 v[84:85], v10 offset:2048
    ds_read_b64_tr_b16 v[86:87], v0 offset:2304
    ds_read_b64_tr_b16 v[100:101], v10 offset:6144
    ds_read_b64_tr_b16 v[102:103], v0 offset:6400
    s_waitcnt lgkmcnt(0)
    ds_read_b64_tr_b16 v[88:89], v10 offset:3072
    ds_read_b64_tr_b16 v[90:91], v0 offset:3328
    ds_read_b64_tr_b16 v[104:105], v10 offset:7168
    ds_read_b64_tr_b16 v[106:107], v0 offset:7424
    s_waitcnt lgkmcnt(0)
    v_mfma_f32_16x16x32_bf16 v[108:111], v[44:47], v[76:79], 0
    v_mfma_f32_16x16x32_bf16 v[108:111], v[48:51], v[80:83], v[108:111]
    v_mfma_f32_16x16x32_bf16 v[108:111], v[52:55], v[84:87], v[108:111]
    v_mfma_f32_16x16x32_bf16 v[108:111], v[56:59], v[88:91], v[108:111]
    v_mfma_f32_16x16x32_bf16 v[112:115], v[60:63], v[76:79], 0
    v_mfma_f32_16x16x32_bf16 v[112:115], v[64:67], v[80:83], v[112:115]
    v_mfma_f32_16x16x32_bf16 v[112:115], v[68:71], v[84:87], v[112:115]
    v_mfma_f32_16x16x32_bf16 v[112:115], v[72:75], v[88:91], v[112:115]
    v_mfma_f32_16x16x32_bf16 v[120:123], v[92:95], v[76:79], 0
    v_mfma_f32_16x16x32_bf16 v[120:123], v[96:99], v[80:83], v[120:123]
    v_mfma_f32_16x16x32_bf16 v[120:123], v[100:103], v[84:87], v[120:123]
    v_mfma_f32_16x16x32_bf16 v[120:123], v[104:107], v[88:91], v[120:123]
    s_nop 7
    v_mul_f32 v120, s72, v120
    v_mul_f32 v121, s72, v121
    v_max3_f32 v26, v108, v109, v110
    v_max3_f32 v26, v26, v111, v112
    v_max3_f32 v26, v26, v113, v114
    v_max3_f32 v26, v26, v115, v120
    v_max_f32 v26, v26, v121
    v_mov_b32 v27, v26
    s_nop 1
    v_permlane32_swap_b32 v27, v26
    v_max_f32 v26, v26, v27
    v_mov_b32 v27, v26
    s_nop 1
    v_permlane16_swap_b32 v27, v26
    v_max_f32 v26, v26, v27
    v_sub_f32 v108, v108, v26
    v_exp_f32 v108, v108
    v_sub_f32 v109, v109, v26
    v_exp_f32 v109, v109
    v_sub_f32 v110, v110, v26
    v_exp_f32 v110, v110
    v_sub_f32 v111, v111, v26
    v_exp_f32 v111, v111
    v_sub_f32 v112, v112, v26
    v_exp_f32 v112, v112
    v_sub_f32 v113, v113, v26
    v_exp_f32 v113, v113
    v_sub_f32 v114, v114, v26
    v_exp_f32 v114, v114
    v_sub_f32 v115, v115, v26
    v_exp_f32 v115, v115
    v_sub_f32 v120, v120, v26
    v_exp_f32 v120, v120
    v_sub_f32 v121, v121, v26
    v_exp_f32 v121, v121
    v_cvt_pk_bf16_f32 v128, v108, v109
    v_cvt_pk_bf16_f32 v129, v110, v111
    v_cvt_pk_bf16_f32 v130, v112, v113
    v_cvt_pk_bf16_f32 v131, v114, v115
    v_cvt_pk_bf16_f32 v40, v120, v121
    s_nop 0
    v_mfma_f32_16x16x32_bf16 v[108:111], v[132:135], v[128:131], 0
    v_mfma_f32_16x16x32_bf16 v[112:115], v[136:139], v[128:131], 0
    v_mfma_f32_16x16x32_bf16 v[116:119], v[128:131], v[36:39], 0
    s_branch L_smjoin_134
L_rdone0:
    s_endpgm
L_R1:
    v_and_b32 v108, 63, v0
    v_mov_b32 v41, 0
    v_bfe_u32 v109, v108, 4, 1
    v_mul_u32_u24 v110, 2, v109
    v_and_b32 v111, 15, v108
    v_xor_b32 v110, v110, v111
    v_bfe_u32 v109, v108, 4, 2
    v_mul_u32_u24 v88, 8192, v109
    s_mul_i32 s28, s26, 131072
    v_add_u32 v88, s28, v88
    v_lshl_add_u32 v88, v110, 4, v88
    v_bfe_u32 v109, v108, 4, 2
    v_mul_u32_u24 v100, 8192, v109
    s_mul_i32 s28, s26, 131072
    v_add_u32 v100, s28, v100
    v_add_u32 v100, 524288, v100
    v_lshl_add_u32 v100, v110, 4, v100
    v_bfe_u32 v109, v108, 5, 1
    v_mul_u32_u24 v110, 2, v109
    v_and_b32 v111, 7, v108
    v_xor_b32 v110, v110, v111
    v_bfe_u32 v109, v108, 3, 3
    v_mul_u32_u24 v92, 1280, v109
    s_mul_i32 s28, s26, 40960
    v_add_u32 v92, s28, v92
    v_lshl_add_u32 v92, v110, 4, v92
    v_bfe_u32 v109, v108, 4, 1
    v_mul_u32_u24 v110, 2, v109
    v_add_u32 v110, 4, v110
    v_and_b32 v111, 15, v108
    v_xor_b32 v110, v110, v111
    v_bfe_u32 v109, v108, 4, 2
    v_mul_u32_u24 v89, 8192, v109
    s_mul_i32 s28, s26, 131072
    v_add_u32 v89, s28, v89
    v_add_u32 v89, 32768, v89
    v_lshl_add_u32 v89, v110, 4, v89
    v_bfe_u32 v109, v108, 4, 2
    v_mul_u32_u24 v101, 8192, v109
    s_mul_i32 s28, s26, 131072
    v_add_u32 v101, s28, v101
    v_add_u32 v101, 557056, v101
    v_lshl_add_u32 v101, v110, 4, v101
    v_bfe_u32 v109, v108, 5, 1
    v_mul_u32_u24 v110, 2, v109
    v_add_u32 v110, 4, v110
    v_and_b32 v111, 7, v108
    v_xor_b32 v110, v110, v111
    v_bfe_u32 v109, v108, 3, 3
    v_mul_u32_u24 v93, 1280, v109
    s_mul_i32 s28, s26, 40960
    v_add_u32 v93, s28, v93
    v_add_u32 v93, 10240, v93
    v_lshl_add_u32 v93, v110, 4, v93
    v_bfe_u32 v109, v108, 4, 1
    v_mul_u32_u24 v110, 2, v109
    v_add_u32 v110, 8, v110
    v_and_b32 v111, 15, v108
    v_xor_b32 v110, v110, v111
    v_bfe_u32 v109, v108, 4, 2
    v_mul_u32_u24 v90, 8192, v109
    s_mul_i32 s28, s26, 131072
    v_add_u32 v90, s28, v90
    v_add_u32 v90, 65536, v90
    v_lshl_add_u32 v90, v110, 4, v90
    v_bfe_u32 v109, v108, 4, 2
    v_mul_u32_u24 v102, 8192, v109
    s_mul_i32 s28, s26, 131072
    v_add_u32 v102, s28, v102
    v_add_u32 v102, 1048576, v102
    v_lshl_add_u32 v102, v110, 4, v102
    v_bfe_u32 v109, v108, 5, 1
    v_mul_u32_u24 v110, 2, v109
    v_and_b32 v111, 7, v108
    v_xor_b32 v110, v110, v111
    v_bfe_u32 v109, v108, 3, 3
    v_mul_u32_u24 v94, 1280, v109
    s_mul_i32 s28, s26, 40960
    v_add_u32 v94, s28, v94
    v_add_u32 v94, 20480, v94
    v_lshl_add_u32 v94, v110, 4, v94
    v_bfe_u32 v109, v108, 4, 1
    v_mul_u32_u24 v110, 2, v109
    v_add_u32 v110, 12, v110
    v_and_b32 v111, 15, v108
    v_xor_b32 v110, v110, v111
    v_bfe_u32 v109, v108, 4, 2
    v_mul_u32_u24 v91, 8192, v109
    s_mul_i32 s28, s26, 131072
    v_add_u32 v91, s28, v91
    v_add_u32 v91, 98304, v91
    v_lshl_add_u32 v91, v110, 4, v91
    v_bfe_u32 v109, v108, 4, 2
    v_mul_u32_u24 v103, 8192, v109
    s_mul_i32 s28, s26, 131072
    v_add_u32 v103, s28, v103
    v_add_u32 v103, 1081344, v103
    v_lshl_add_u32 v103, v110, 4, v103
    v_bfe_u32 v109, v108, 5, 1
    v_mul_u32_u24 v110, 2, v109
    v_add_u32 v110, 4, v110
    v_and_b32 v111, 7, v108
    v_xor_b32 v110, v110, v111
    v_bfe_u32 v109, v108, 3, 3
    v_mul_u32_u24 v95, 1280, v109
    s_mul_i32 s28, s26, 40960
    v_add_u32 v95, s28, v95
    v_add_u32 v95, 30720, v95
    v_lshl_add_u32 v95, v110, 4, v95
    v_bfe_u32 v109, v108, 3, 1
    v_mul_u32_u24 v110, 8, v109
    v_bfe_u32 v109, v108, 4, 1
    v_mul_u32_u24 v109, 4, v109
    v_add_u32 v110, v110, v109
    v_bfe_u32 v109, v108, 2, 1
    v_mul_u32_u24 v109, 2, v109
    v_add_u32 v110, v110, v109
    v_bfe_u32 v109, v108, 1, 1
    v_mul_u32_u24 v111, 1, v109
    s_mul_i32 s28, s26, 4
    v_add_u32 v111, s28, v111
    v_xor_b32 v110, v110, v111
    v_bfe_u32 v109, v108, 5, 1
    v_mul_u32_u24 v96, 4096, v109
    v_bfe_u32 v109, v108, 3, 1
    v_mul_u32_u24 v109, 2048, v109
    v_add_u32 v96, v96, v109
    v_bfe_u32 v109, v108, 4, 1
    v_mul_u32_u24 v109, 1024, v109
    v_add_u32 v96, v96, v109
    v_bfe_u32 v109, v108, 2, 1
    v_mul_u32_u24 v109, 256, v109
    v_add_u32 v96, v96, v109
    v_bfe_u32 v109, v108, 0, 1
    v_mul_u32_u24 v109, 8, v109
    v_add_u32 v96, v96, v109
    v_lshl_add_u32 v96, v110, 4, v96
    v_xor_b32 v97, 32, v96
    v_bfe_u32 v109, v108, 3, 1
    v_mul_u32_u24 v110, 4, v109
    v_bfe_u32 v109, v108, 4, 1
    v_mul_u32_u24 v109, 2, v109
    v_add_u32 v110, v110, v109
    v_bfe_u32 v109, v108, 1, 1
    v_mul_u32_u24 v111, 1, v109
    s_mul_i32 s28, s26, 2
    v_add_u32 v111, s28, v111
    v_xor_b32 v110, v110, v111
    v_bfe_u32 v109, v108, 5, 1
    v_mul_u32_u24 v98, 2048, v109
    v_bfe_u32 v109, v108, 3, 1
    v_mul_u32_u24 v109, 1024, v109
    v_add_u32 v98, v98, v109
    v_bfe_u32 v109, v108, 4, 1
    v_mul_u32_u24 v109, 512, v109
    v_add_u32 v98, v98, v109
    v_bfe_u32 v109, v108, 2, 1
    v_mul_u32_u24 v109, 128, v109
    v_add_u32 v98, v98, v109
    v_bfe_u32 v109, v108, 0, 1
    v_mul_u32_u24 v109, 8, v109
    v_add_u32 v98, v98, v109
    v_lshl_add_u32 v98, v110, 4, v98
    s_lshl_b32 s29, s24, 8
    s_mul_i32 s45, s25, 2621440
    s_sub_u32 s46, 2621440, s45
    s_add_u32 s45, s45, s29
    s_add_u32 s46, s46, s29
    s_mul_i32 s47, s24, 163840
    s_mul_i32 s29, s25, 640
    s_add_u32 s47, s47, s29
    s_lshl_b32 s61, s26, 12
    s_mov_b32 s38, 5242880
    s_mov_b32 s39, 0x20000
    s_mov_b32 s36, s12
    s_and_b32 s37, s13, 0xffff
    s_add_u32 s28, s45, 0
    s_add_u32 m0, s61, 49152
    s_nop 0
    buffer_load_dwordx4 v88, s[36:39], s28 offen nt lds
    s_add_u32 m0, s61, 50176
    s_nop 0
    buffer_load_dwordx4 v89, s[36:39], s28 offen nt lds
    s_add_u32 m0, s61, 51200
    s_nop 0
    buffer_load_dwordx4 v90, s[36:39], s28 offen nt lds
    s_add_u32 m0, s61, 52224
    s_nop 0
    buffer_load_dwordx4 v91, s[36:39], s28 offen nt lds
    s_add_u32 s28, s45, 0
    s_add_u32 m0, s61, 65536
    s_nop 0
    buffer_load_dwordx4 v100, s[36:39], s28 offen nt lds
    s_add_u32 m0, s61, 66560
    s_nop 0
    buffer_load_dwordx4 v101, s[36:39], s28 offen nt lds
    s_add_u32 m0, s61, 67584
    s_nop 0
    buffer_load_dwordx4 v102, s[36:39], s28 offen nt lds
    s_add_u32 m0, s61, 68608
    s_nop 0
    buffer_load_dwordx4 v103, s[36:39], s28 offen nt lds
    s_add_u32 s28, s45, 65536
    s_add_u32 m0, s61, 81920
    s_nop 0
    buffer_load_dwordx4 v100, s[36:39], s28 offen nt lds
    s_add_u32 m0, s61, 82944
    s_nop 0
    buffer_load_dwordx4 v101, s[36:39], s28 offen nt lds
    s_add_u32 m0, s61, 83968
    s_nop 0
    buffer_load_dwordx4 v102, s[36:39], s28 offen nt lds
    s_add_u32 m0, s61, 84992
    s_nop 0
    buffer_load_dwordx4 v103, s[36:39], s28 offen nt lds
    s_add_u32 s28, s45, 1048576
    s_add_u32 m0, s61, 98304
    s_nop 0
    buffer_load_dwordx4 v100, s[36:39], s28 offen nt lds
    s_add_u32 m0, s61, 99328
    s_nop 0
    buffer_load_dwordx4 v101, s[36:39], s28 offen nt lds
    s_add_u32 m0, s61, 100352
    s_nop 0
    buffer_load_dwordx4 v102, s[36:39], s28 offen nt lds
    s_add_u32 m0, s61, 101376
    s_nop 0
    buffer_load_dwordx4 v103, s[36:39], s28 offen nt lds
    s_mov_b32 s36, s8
    s_and_b32 s37, s9, 0xffff
    s_add_u32 s28, s45, 0
    s_add_u32 m0, s61, 114688
    s_nop 0
    buffer_load_dwordx4 v88, s[36:39], s28 offen nt lds
    s_add_u32 m0, s61, 115712
    s_nop 0
    buffer_load_dwordx4 v89, s[36:39], s28 offen nt lds
    s_add_u32 m0, s61, 116736
    s_nop 0
    buffer_load_dwordx4 v90, s[36:39], s28 offen nt lds
    s_add_u32 m0, s61, 117760
    s_nop 0
    buffer_load_dwordx4 v91, s[36:39], s28 offen nt lds
    s_add_u32 s28, s45, 0
    s_add_u32 m0, s61, 131072
    s_nop 0
    buffer_load_dwordx4 v100, s[36:39], s28 offen nt lds
    s_add_u32 m0, s61, 132096
    s_nop 0
    buffer_load_dwordx4 v101, s[36:39], s28 offen nt lds
    s_add_u32 m0, s61, 133120
    s_nop 0
    buffer_load_dwordx4 v102, s[36:39], s28 offen nt lds
    s_add_u32 m0, s61, 134144
    s_nop 0
    buffer_load_dwordx4 v103, s[36:39], s28 offen nt lds
    s_waitcnt vmcnt(20)
    s_barrier
    s_add_u32 s28, s45, 65536
    s_add_u32 m0, s61, 147456
    s_nop 0
    buffer_load_dwordx4 v100, s[36:39], s28 offen nt lds
    s_add_u32 m0, s61, 148480
    s_nop 0
    buffer_load_dwordx4 v101, s[36:39], s28 offen nt lds
    s_add_u32 m0, s61, 149504
    s_nop 0
    buffer_load_dwordx4 v102, s[36:39], s28 offen nt lds
    s_add_u32 m0, s61, 150528
    s_nop 0
    buffer_load_dwordx4 v103, s[36:39], s28 offen nt lds
    v_bfe_u32 v109, v108, 0, 6
    v_mul_u32_u24 v2, 16, v109
    v_bfe_u32 v109, v108, 0, 6
    v_mul_u32_u24 v3, 16, v109
    s_mul_i32 s28, s26, 1024
    v_add_u32 v3, s28, v3
    v_bfe_u32 v109, v108, 0, 6
    v_mul_u32_u24 v4, 4, v109
    s_mul_i32 s28, s26, 256
    v_add_u32 v4, s28, v4
    v_add_u32 v4, 4096, v4
    v_bfe_u32 v109, v108, 0, 6
    v_mul_u32_u24 v5, 8, v109
    s_mul_i32 s28, s26, 512
    v_add_u32 v5, s28, v5
    v_and_b32 v110, 2, v108
    v_cmp_ne_u32 vcc, 0, v110
    v_mov_b32 v110, 0x44444444
    v_mov_b32 v111, 0xeeeeeeee
    v_cndmask_b32 v1, v110, v111, vcc
    s_add_u32 s29, s24, 16
    s_cmp_lt_u32 s24, 8
    s_cselect_b32 s29, s24, s29
    s_lshl_b32 s30, s24, 1
    s_add_u32 s30, s30, s26
    s_sub_u32 s30, s30, 40
    s_cmp_lt_u32 s24, 24
    s_cselect_b32 s58, s29, s30
    s_cselect_b32 s29, 1, 2
    s_cmp_lt_u32 s26, s29
    s_cselect_b32 s63, 1, 0
    s_cselect_b32 s29, 0, 1073741824
    v_bfe_u32 v109, v108, 2, 1
    v_mul_u32_u24 v6, 64, v109
    v_bfe_u32 v109, v108, 1, 1
    v_mul_u32_u24 v109, 32, v109
    v_add_u32 v6, v6, v109
    v_bfe_u32 v109, v108, 0, 1
    v_add_u32 v99, 49152, v96
    ds_read_b64_tr_b16 a[0:1], v99 offset:0
    ds_read_b64_tr_b16 a[2:3], v99 offset:512
    ds_read_b64_tr_b16 a[4:5], v99 offset:8192
    ds_read_b64_tr_b16 a[6:7], v99 offset:8704
    v_add_u32 v99, 49152, v97
    ds_read_b64_tr_b16 a[8:9], v99 offset:0
    ds_read_b64_tr_b16 a[10:11], v99 offset:512
    ds_read_b64_tr_b16 a[12:13], v99 offset:8192
    ds_read_b64_tr_b16 a[14:15], v99 offset:8704
    s_waitcnt lgkmcnt(0)
    s_waitcnt vmcnt(20)
    s_barrier
    s_mov_b32 s36, s10
    s_and_b32 s37, s11, 0xffff
    s_add_u32 s28, s45, 0
    s_add_u32 m0, s61, 49152
    s_nop 0
    buffer_load_dwordx4 v88, s[36:39], s28 offen nt lds
    s_add_u32 m0, s61, 50176
    s_nop 0
    buffer_load_dwordx4 v89, s[36:39], s28 offen nt lds
    s_add_u32 m0, s61, 51200
    s_nop 0
    buffer_load_dwordx4 v90, s[36:39], s28 offen nt lds
    s_add_u32 m0, s61, 52224
    s_nop 0
    buffer_load_dwordx4 v91, s[36:39], s28 offen nt lds
    v_mul_u32_u24 v109, 16, v109
    v_add_u32 v6, v6, v109
    v_bfe_u32 v109, v108, 4, 1
    v_mul_u32_u24 v109, 8, v109
    v_add_u32 v6, v6, v109
    v_bfe_u32 v109, v108, 5, 1
    v_mul_u32_u24 v109, 4, v109
    v_add_u32 v6, v6, v109
    s_mul_i32 s28, s58, 128
    v_add_u32 v6, s28, v6
    v_bfe_u32 v109, v108, 3, 1
    v_mul_u32_u24 v111, 1, v109
    v_lshl_add_u32 v111, v111, 30, s29
    v_add_u32 v6, v111, v6
    s_lshl_b32 s58, s58, 12
    v_bfe_u32 v109, v108, 4, 1
    v_mul_u32_u24 v20, 4096, v109
    v_mov_b32 v110, 16384
    v_cmp_lt_u32 vcc, 31, v108
    s_nop 1
    v_cndmask_b32 v20, v20, v110, vcc
    v_bfe_u32 v109, v108, 5, 1
    v_mul_u32_u24 v15, 8, v109
    v_bfe_u32 v109, v108, 2, 4
    v_mul_u32_u24 v23, 64, v109
    s_mul_i32 s28, s26, 1024
    v_add_u32 v23, s28, v23
    v_bfe_u32 v109, v108, 2, 2
    v_mul_u32_u24 v111, 64, v109
    s_mul_i32 s28, s26, 256
    v_add_u32 v111, s28, v111
    v_add_u32 v111, 4096, v111
    v_and_b32 v110, 50, v108
    v_cmp_eq_u32 vcc, 50, v110
    s_nop 1
    v_cndmask_b32 v23, v23, v111, vcc
    v_bfe_u32 v109, v108, 2, 2
    v_mul_u32_u24 v11, 64, v109
    v_bfe_u32 v109, v108, 5, 1
    v_mul_u32_u24 v109, 32, v109
    v_add_u32 v99, 65536, v96
    ds_read_b64_tr_b16 a[16:17], v99 offset:0
    ds_read_b64_tr_b16 a[18:19], v99 offset:512
    ds_read_b64_tr_b16 a[20:21], v99 offset:8192
    ds_read_b64_tr_b16 a[22:23], v99 offset:8704
    v_add_u32 v99, 65536, v97
    ds_read_b64_tr_b16 a[24:25], v99 offset:0
    ds_read_b64_tr_b16 a[26:27], v99 offset:512
    ds_read_b64_tr_b16 a[28:29], v99 offset:8192
    ds_read_b64_tr_b16 a[30:31], v99 offset:8704
    s_waitcnt lgkmcnt(0)
    s_waitcnt vmcnt(20)
    s_barrier
    s_add_u32 s28, s45, 0
    s_add_u32 m0, s61, 65536
    s_nop 0
    buffer_load_dwordx4 v100, s[36:39], s28 offen nt lds
    s_add_u32 m0, s61, 66560
    s_nop 0
    buffer_load_dwordx4 v101, s[36:39], s28 offen nt lds
    s_add_u32 m0, s61, 67584
    s_nop 0
    buffer_load_dwordx4 v102, s[36:39], s28 offen nt lds
    s_add_u32 m0, s61, 68608
    s_nop 0
    buffer_load_dwordx4 v103, s[36:39], s28 offen nt lds
    v_add_u32 v11, v11, v109
    v_bfe_u32 v109, v108, 0, 1
    v_mul_u32_u24 v109, 16, v109
    v_add_u32 v11, v11, v109
    v_bfe_u32 v109, v108, 4, 1
    v_mul_u32_u24 v109, 8, v109
    v_add_u32 v11, v11, v109
    v_bfe_u32 v109, v108, 1, 1
    v_mul_u32_u24 v109, 256, v109
    v_add_u32 v11, v11, v109
    s_mul_i32 s28, s26, 512
    v_add_u32 v11, s28, v11
    v_add_u32 v11, 47104, v11
    v_bfe_u32 v109, v108, 1, 1
    v_mul_u32_u24 v110, 32, v109
    v_xor_b32 v11, v11, v110
    v_bfe_u32 v109, v108, 4, 1
    v_mul_u32_u24 v110, 32, v109
    v_xor_b32 v31, v110, v2
    s_mov_b32 s0, 0x33333333
    s_mov_b32 s1, 0x33333333
    v_bfe_u32 v109, v108, 5, 1
    v_mul_u32_u24 v110, 1, v109
    s_mul_i32 s28, s26, 2
    v_add_u32 v110, s28, v110
    v_add_u32 v111, s24, v110
    v_and_b32 v111, 31, v111
    v_bfe_u32 v109, v108, 0, 3
    v_mul_u32_u24 v8, 16, v109
    v_bfe_u32 v109, v108, 4, 1
    v_mul_u32_u24 v109, 8, v109
    v_add_u32 v8, v8, v109
    v_bfe_u32 v109, v108, 3, 1
    v_mul_u32_u24 v109, 4, v109
    v_add_u32 v8, v8, v109
    v_lshl_add_u32 v8, v110, 12, v8
    v_lshl_add_u32 v8, v111, 7, v8
    v_add_u32 v99, 81920, v96
    ds_read_b64_tr_b16 a[32:33], v99 offset:0
    ds_read_b64_tr_b16 a[34:35], v99 offset:512
    ds_read_b64_tr_b16 a[36:37], v99 offset:8192
    ds_read_b64_tr_b16 a[38:39], v99 offset:8704
    v_add_u32 v99, 81920, v97
    ds_read_b64_tr_b16 a[40:41], v99 offset:0
    ds_read_b64_tr_b16 a[42:43], v99 offset:512
    ds_read_b64_tr_b16 a[44:45], v99 offset:8192
    ds_read_b64_tr_b16 a[46:47], v99 offset:8704
    s_waitcnt lgkmcnt(0)
    s_waitcnt vmcnt(20)
    s_barrier
    s_add_u32 s28, s45, 65536
    s_add_u32 m0, s61, 81920
    s_nop 0
    buffer_load_dwordx4 v100, s[36:39], s28 offen nt lds
    s_add_u32 m0, s61, 82944
    s_nop 0
    buffer_load_dwordx4 v101, s[36:39], s28 offen nt lds
    s_add_u32 m0, s61, 83968
    s_nop 0
    buffer_load_dwordx4 v102, s[36:39], s28 offen nt lds
    s_add_u32 m0, s61, 84992
    s_nop 0
    buffer_load_dwordx4 v103, s[36:39], s28 offen nt lds
    v_bfe_u32 v109, v108, 3, 1
    v_mul_u32_u24 v110, 8, v109
    v_bfe_u32 v109, v108, 5, 1
    v_mul_u32_u24 v109, 1, v109
    v_add_u32 v110, v110, v109
    s_mul_i32 s28, s26, 2
    v_add_u32 v110, s28, v110
    v_add_u32 v110, 8, v110
    v_add_u32 v111, s24, v110
    v_and_b32 v111, 31, v111
    v_bfe_u32 v109, v108, 0, 3
    v_mul_u32_u24 v7, 16, v109
    v_bfe_u32 v109, v108, 4, 1
    v_mul_u32_u24 v109, 8, v109
    v_add_u32 v7, v7, v109
    v_lshl_add_u32 v7, v110, 12, v7
    v_lshl_add_u32 v7, v111, 7, v7
    v_bfe_u32 v109, v108, 4, 2
    v_mul_u32_u24 v110, 1, v109
    v_bfe_u32 v109, v108, 2, 2
    v_mul_u32_u24 v111, 1, v109
    v_xor_b32 v110, v110, v111
    v_bfe_u32 v109, v108, 0, 4
    v_mul_u32_u24 v9, 32, v109
    s_mul_i32 s28, s26, 1024
    v_add_u32 v9, s28, v9
    v_add_u32 v9, 37888, v9
    v_lshl_add_u32 v9, v110, 3, v9
    v_bfe_u32 v109, v108, 0, 2
    v_mul_u32_u24 v110, 1, v109
    v_bfe_u32 v109, v108, 4, 1
    v_mul_u32_u24 v111, 1, v109
    v_xor_b32 v110, v110, v111
    v_bfe_u32 v109, v108, 5, 1
    v_mul_u32_u24 v10, 512, v109
    v_bfe_u32 v109, v108, 4, 1
    v_mul_u32_u24 v109, 128, v109
    v_add_u32 v99, 98304, v96
    ds_read_b64_tr_b16 a[48:49], v99 offset:0
    ds_read_b64_tr_b16 a[50:51], v99 offset:512
    ds_read_b64_tr_b16 a[52:53], v99 offset:8192
    ds_read_b64_tr_b16 a[54:55], v99 offset:8704
    v_add_u32 v99, 98304, v97
    ds_read_b64_tr_b16 a[56:57], v99 offset:0
    ds_read_b64_tr_b16 a[58:59], v99 offset:512
    ds_read_b64_tr_b16 a[60:61], v99 offset:8192
    ds_read_b64_tr_b16 a[62:63], v99 offset:8704
    s_waitcnt lgkmcnt(0)
    s_waitcnt vmcnt(20)
    s_barrier
    s_mov_b32 s36, s8
    s_and_b32 s37, s9, 0xffff
    s_add_u32 s28, s46, 0
    s_add_u32 m0, s61, 98304
    s_nop 0
    buffer_load_dwordx4 v88, s[36:39], s28 offen nt lds
    s_add_u32 m0, s61, 99328
    s_nop 0
    buffer_load_dwordx4 v89, s[36:39], s28 offen nt lds
    s_add_u32 m0, s61, 100352
    s_nop 0
    buffer_load_dwordx4 v90, s[36:39], s28 offen nt lds
    s_add_u32 m0, s61, 101376
    s_nop 0
    buffer_load_dwordx4 v91, s[36:39], s28 offen nt lds
    v_add_u32 v10, v10, v109
    v_bfe_u32 v109, v108, 2, 2
    v_mul_u32_u24 v109, 32, v109
    v_add_u32 v10, v10, v109
    v_add_u32 v10, 37888, v10
    v_lshl_add_u32 v10, v110, 3, v10
    v_xor_b32 v0, 16, v10
    v_bfe_u32 v109, v108, 0, 6
    v_mul_u32_u24 v12, 16, v109
    s_mul_i32 s28, s26, 2048
    v_add_u32 v12, s28, v12
    v_bfe_u32 v109, v108, 0, 6
    v_mul_u32_u24 v13, 16, v109
    v_bfe_u32 v109, v108, 4, 2
    v_mul_u32_u24 v14, 64, v109
    v_bfe_u32 v109, v108, 2, 2
    v_mul_u32_u24 v109, 16, v109
    v_add_u32 v14, v14, v109
    v_bfe_u32 v109, v108, 0, 1
    v_mul_u32_u24 v109, 256, v109
    v_add_u32 v14, v14, v109
    v_bfe_u32 v109, v108, 1, 1
    v_mul_u32_u24 v109, 8, v109
    v_add_u32 v14, v14, v109
    s_mul_i32 s28, s26, 1024
    v_add_u32 v14, s28, v14
    v_add_u32 v14, 8192, v14
    v_bfe_u32 v109, v108, 0, 6
    v_mul_u32_u24 v16, 16, v109
    s_mul_i32 s28, s26, 4096
    v_add_u32 v16, s28, v16
    v_add_u32 v16, 49152, v16
    v_add_u32 v17, 65536, v16
    v_bfe_u32 v109, v108, 0, 6
    v_mul_u32_u24 v110, 16, v109
    s_mul_i32 s28, s26, 1024
    v_add_u32 v110, s28, v110
    v_add_u32 v99, 114688, v96
    ds_read_b64_tr_b16 a[64:65], v99 offset:0
    ds_read_b64_tr_b16 a[66:67], v99 offset:512
    ds_read_b64_tr_b16 a[68:69], v99 offset:8192
    ds_read_b64_tr_b16 a[70:71], v99 offset:8704
    v_add_u32 v99, 114688, v97
    ds_read_b64_tr_b16 a[72:73], v99 offset:0
    ds_read_b64_tr_b16 a[74:75], v99 offset:512
    ds_read_b64_tr_b16 a[76:77], v99 offset:8192
    ds_read_b64_tr_b16 a[78:79], v99 offset:8704
    s_waitcnt lgkmcnt(0)
    s_waitcnt vmcnt(20)
    s_barrier
    s_add_u32 s28, s46, 0
    s_add_u32 m0, s61, 114688
    s_nop 0
    buffer_load_dwordx4 v100, s[36:39], s28 offen nt lds
    s_add_u32 m0, s61, 115712
    s_nop 0
    buffer_load_dwordx4 v101, s[36:39], s28 offen nt lds
    s_add_u32 m0, s61, 116736
    s_nop 0
    buffer_load_dwordx4 v102, s[36:39], s28 offen nt lds
    s_add_u32 m0, s61, 117760
    s_nop 0
    buffer_load_dwordx4 v103, s[36:39], s28 offen nt lds
    v_add_u32 v110, 37888, v110
    v_mov_b32 v116, 0
    v_mov_b32 v117, 0
    v_mov_b32 v118, 0
    v_mov_b32 v119, 0
    ds_write_b128 v110, v[116:119]
    s_waitcnt lgkmcnt(0)
    s_lshl_b32 s56, s26, 10
    s_lshl_b32 s64, s26, 8
    s_add_u32 s64, s64, 4096
    v_mov_b32 v36, 0x3f803f80
    v_mov_b32 v32, 0
    v_mov_b32 v40, 0
    v_mov_b32 v37, 0x3f803f80
    v_mov_b32 v33, 0
    v_mov_b32 v41, 0
    v_mov_b32 v38, 0x3f803f80
    v_mov_b32 v34, 0
    v_mov_b32 v42, 0
    v_mov_b32 v39, 0x3f803f80
    v_mov_b32 v35, 0
    v_mov_b32 v43, 0
    v_mov_b32 v22, 2147483648
    v_and_b32 v110, 1, v108
    v_lshlrev_b32 v110, 4, v110
    v_mov_b32 v109, 0x3f80
    v_lshlrev_b32 v30, v110, v109
    s_mov_b32 s72, 0x3e0293ee
    s_mov_b32 s73, 0x3e0293ee
    s_mov_b32 s67, 0x4e800000
    s_mov_b32 s68, 0x30800000
    s_lshl_b32 s57, s24, 21
    s_add_u32 s57, s57, 0
    s_lshl_b32 s62, s24, 7
    s_add_u32 s62, s62, 71305216
    s_add_u32 s65, s57, 1703936
    s_mov_b32 s66, 70516736
    v_add_u32 v99, 131072, v96
    ds_read_b64_tr_b16 a[80:81], v99 offset:0
    ds_read_b64_tr_b16 a[82:83], v99 offset:512
    ds_read_b64_tr_b16 a[84:85], v99 offset:8192
    ds_read_b64_tr_b16 a[86:87], v99 offset:8704
    v_add_u32 v99, 131072, v97
    ds_read_b64_tr_b16 a[88:89], v99 offset:0
    ds_read_b64_tr_b16 a[90:91], v99 offset:512
    ds_read_b64_tr_b16 a[92:93], v99 offset:8192
    ds_read_b64_tr_b16 a[94:95], v99 offset:8704
    s_waitcnt lgkmcnt(0)
    s_waitcnt vmcnt(20)
    s_barrier
    s_add_u32 s28, s46, 65536
    s_add_u32 m0, s61, 131072
    s_nop 0
    buffer_load_dwordx4 v100, s[36:39], s28 offen nt lds
    s_add_u32 m0, s61, 132096
    s_nop 0
    buffer_load_dwordx4 v101, s[36:39], s28 offen nt lds
    s_add_u32 m0, s61, 133120
    s_nop 0
    buffer_load_dwordx4 v102, s[36:39], s28 offen nt lds
    s_add_u32 m0, s61, 134144
    s_nop 0
    buffer_load_dwordx4 v103, s[36:39], s28 offen nt lds
    v_add_u32 v99, 147456, v96
    ds_read_b64_tr_b16 a[96:97], v99 offset:0
    ds_read_b64_tr_b16 a[98:99], v99 offset:512
    ds_read_b64_tr_b16 a[100:101], v99 offset:8192
    ds_read_b64_tr_b16 a[102:103], v99 offset:8704
    v_add_u32 v99, 147456, v97
    ds_read_b64_tr_b16 a[104:105], v99 offset:0
    ds_read_b64_tr_b16 a[106:107], v99 offset:512
    ds_read_b64_tr_b16 a[108:109], v99 offset:8192
    ds_read_b64_tr_b16 a[110:111], v99 offset:8704
    s_waitcnt lgkmcnt(0)
    s_waitcnt vmcnt(20)
    s_barrier
    s_add_u32 s28, s46, 1048576
    s_add_u32 m0, s61, 147456
    s_nop 0
    buffer_load_dwordx4 v100, s[36:39], s28 offen nt lds
    s_add_u32 m0, s61, 148480
    s_nop 0
    buffer_load_dwordx4 v101, s[36:39], s28 offen nt lds
    s_add_u32 m0, s61, 149504
    s_nop 0
    buffer_load_dwordx4 v102, s[36:39], s28 offen nt lds
    s_add_u32 m0, s61, 150528
    s_nop 0
    buffer_load_dwordx4 v103, s[36:39], s28 offen nt lds
    v_add_u32 v99, 49152, v96
    ds_read_b64_tr_b16 a[112:113], v99 offset:0
    ds_read_b64_tr_b16 a[114:115], v99 offset:512
    ds_read_b64_tr_b16 a[116:117], v99 offset:8192
    ds_read_b64_tr_b16 a[118:119], v99 offset:8704
    v_add_u32 v99, 49152, v97
    ds_read_b64_tr_b16 a[120:121], v99 offset:0
    ds_read_b64_tr_b16 a[122:123], v99 offset:512
    ds_read_b64_tr_b16 a[124:125], v99 offset:8192
    ds_read_b64_tr_b16 a[126:127], v99 offset:8704
    s_waitcnt lgkmcnt(0)
    s_waitcnt vmcnt(20)
    s_barrier
    s_add_u32 s28, s46, 1114112
    s_add_u32 m0, s61, 49152
    s_nop 0
    buffer_load_dwordx4 v100, s[36:39], s28 offen nt lds
    s_add_u32 m0, s61, 50176
    s_nop 0
    buffer_load_dwordx4 v101, s[36:39], s28 offen nt lds
    s_add_u32 m0, s61, 51200
    s_nop 0
    buffer_load_dwordx4 v102, s[36:39], s28 offen nt lds
    s_add_u32 m0, s61, 52224
    s_nop 0
    buffer_load_dwordx4 v103, s[36:39], s28 offen nt lds
    v_add_u32 v99, 65536, v96
    ds_read_b64_tr_b16 a[128:129], v99 offset:0
    ds_read_b64_tr_b16 a[130:131], v99 offset:512
    ds_read_b64_tr_b16 a[132:133], v99 offset:8192
    ds_read_b64_tr_b16 a[134:135], v99 offset:8704
    v_add_u32 v99, 65536, v97
    ds_read_b64_tr_b16 a[136:137], v99 offset:0
    ds_read_b64_tr_b16 a[138:139], v99 offset:512
    ds_read_b64_tr_b16 a[140:141], v99 offset:8192
    ds_read_b64_tr_b16 a[142:143], v99 offset:8704
    s_waitcnt lgkmcnt(0)
    s_waitcnt vmcnt(20)
    s_barrier
    s_mov_b32 s36, s10
    s_and_b32 s37, s11, 0xffff
    s_add_u32 s28, s46, 0
    s_add_u32 m0, s61, 65536
    s_nop 0
    buffer_load_dwordx4 v88, s[36:39], s28 offen nt lds
    s_add_u32 m0, s61, 66560
    s_nop 0
    buffer_load_dwordx4 v89, s[36:39], s28 offen nt lds
    s_add_u32 m0, s61, 67584
    s_nop 0
    buffer_load_dwordx4 v90, s[36:39], s28 offen nt lds
    s_add_u32 m0, s61, 68608
    s_nop 0
    buffer_load_dwordx4 v91, s[36:39], s28 offen nt lds
    v_add_u32 v99, 81920, v96
    ds_read_b64_tr_b16 a[144:145], v99 offset:0
    ds_read_b64_tr_b16 a[146:147], v99 offset:512
    ds_read_b64_tr_b16 a[148:149], v99 offset:8192
    ds_read_b64_tr_b16 a[150:151], v99 offset:8704
    v_add_u32 v99, 81920, v97
    ds_read_b64_tr_b16 a[152:153], v99 offset:0
    ds_read_b64_tr_b16 a[154:155], v99 offset:512
    ds_read_b64_tr_b16 a[156:157], v99 offset:8192
    ds_read_b64_tr_b16 a[158:159], v99 offset:8704
    s_waitcnt lgkmcnt(0)
    s_waitcnt vmcnt(20)
    s_barrier
    s_add_u32 s28, s46, 0
    s_add_u32 m0, s61, 81920
    s_nop 0
    buffer_load_dwordx4 v100, s[36:39], s28 offen nt lds
    s_add_u32 m0, s61, 82944
    s_nop 0
    buffer_load_dwordx4 v101, s[36:39], s28 offen nt lds
    s_add_u32 m0, s61, 83968
    s_nop 0
    buffer_load_dwordx4 v102, s[36:39], s28 offen nt lds
    s_add_u32 m0, s61, 84992
    s_nop 0
    buffer_load_dwordx4 v103, s[36:39], s28 offen nt lds
    v_add_u32 v99, 98304, v96
    ds_read_b64_tr_b16 a[160:161], v99 offset:0
    ds_read_b64_tr_b16 a[162:163], v99 offset:512
    ds_read_b64_tr_b16 a[164:165], v99 offset:8192
    ds_read_b64_tr_b16 a[166:167], v99 offset:8704
    v_add_u32 v99, 98304, v97
    ds_read_b64_tr_b16 a[168:169], v99 offset:0
    ds_read_b64_tr_b16 a[170:171], v99 offset:512
    ds_read_b64_tr_b16 a[172:173], v99 offset:8192
    ds_read_b64_tr_b16 a[174:175], v99 offset:8704
    s_waitcnt lgkmcnt(0)
    s_waitcnt vmcnt(20)
    s_barrier
    s_add_u32 s28, s46, 65536
    s_add_u32 m0, s61, 98304
    s_nop 0
    buffer_load_dwordx4 v100, s[36:39], s28 offen nt lds
    s_add_u32 m0, s61, 99328
    s_nop 0
    buffer_load_dwordx4 v101, s[36:39], s28 offen nt lds
    s_add_u32 m0, s61, 100352
    s_nop 0
    buffer_load_dwordx4 v102, s[36:39], s28 offen nt lds
    s_add_u32 m0, s61, 101376
    s_nop 0
    buffer_load_dwordx4 v103, s[36:39], s28 offen nt lds
    v_add_u32 v99, 114688, v96
    ds_read_b64_tr_b16 a[176:177], v99 offset:0
    ds_read_b64_tr_b16 a[178:179], v99 offset:512
    ds_read_b64_tr_b16 a[180:181], v99 offset:8192
    ds_read_b64_tr_b16 a[182:183], v99 offset:8704
    v_add_u32 v99, 114688, v97
    ds_read_b64_tr_b16 a[184:185], v99 offset:0
    ds_read_b64_tr_b16 a[186:187], v99 offset:512
    ds_read_b64_tr_b16 a[188:189], v99 offset:8192
    ds_read_b64_tr_b16 a[190:191], v99 offset:8704
    s_waitcnt lgkmcnt(0)
    s_waitcnt vmcnt(20)
    s_barrier
    s_add_u32 s28, s46, 1048576
    s_add_u32 m0, s61, 114688
    s_nop 0
    buffer_load_dwordx4 v100, s[36:39], s28 offen nt lds
    s_add_u32 m0, s61, 115712
    s_nop 0
    buffer_load_dwordx4 v101, s[36:39], s28 offen nt lds
    s_add_u32 m0, s61, 116736
    s_nop 0
    buffer_load_dwordx4 v102, s[36:39], s28 offen nt lds
    s_add_u32 m0, s61, 117760
    s_nop 0
    buffer_load_dwordx4 v103, s[36:39], s28 offen nt lds
    v_add_u32 v99, 131072, v96
    ds_read_b64_tr_b16 a[192:193], v99 offset:0
    ds_read_b64_tr_b16 a[194:195], v99 offset:512
    ds_read_b64_tr_b16 a[196:197], v99 offset:8192
    ds_read_b64_tr_b16 a[198:199], v99 offset:8704
    v_add_u32 v99, 131072, v97
    ds_read_b64_tr_b16 a[200:201], v99 offset:0
    ds_read_b64_tr_b16 a[202:203], v99 offset:512
    ds_read_b64_tr_b16 a[204:205], v99 offset:8192
    ds_read_b64_tr_b16 a[206:207], v99 offset:8704
    s_waitcnt lgkmcnt(0)
    s_waitcnt vmcnt(20)
    s_barrier
    s_add_u32 s28, s46, 1114112
    s_add_u32 m0, s61, 131072
    s_nop 0
    buffer_load_dwordx4 v100, s[36:39], s28 offen nt lds
    s_add_u32 m0, s61, 132096
    s_nop 0
    buffer_load_dwordx4 v101, s[36:39], s28 offen nt lds
    s_add_u32 m0, s61, 133120
    s_nop 0
    buffer_load_dwordx4 v102, s[36:39], s28 offen nt lds
    s_add_u32 m0, s61, 134144
    s_nop 0
    buffer_load_dwordx4 v103, s[36:39], s28 offen nt lds
    v_mbcnt_lo_u32_b32 v110, -1, 0
    v_bfe_u32 v111, v110, 2, 1
    v_and_b32 v110, 3, v110
    v_lshlrev_b32 v110, 6, v110
    v_lshl_add_u32 v110, v111, 2, v110
    global_load_dword v111, v110, s[20:21] sc1
    global_load_dword v124, v41, s[20:21] offset:52 sc1
    v_add_u32 v99, 147456, v96
    ds_read_b64_tr_b16 a[208:209], v99 offset:0
    ds_read_b64_tr_b16 a[210:211], v99 offset:512
    ds_read_b64_tr_b16 a[212:213], v99 offset:8192
    ds_read_b64_tr_b16 a[214:215], v99 offset:8704
    v_add_u32 v99, 147456, v97
    ds_read_b64_tr_b16 a[216:217], v99 offset:0
    ds_read_b64_tr_b16 a[218:219], v99 offset:512
    ds_read_b64_tr_b16 a[220:221], v99 offset:8192
    ds_read_b64_tr_b16 a[222:223], v99 offset:8704
    s_waitcnt lgkmcnt(0)
    s_waitcnt vmcnt(22)
    s_barrier
    s_mov_b32 s36, s14
    s_and_b32 s37, s15, 0xffff
    s_add_u32 s28, s47, 128
    s_add_u32 m0, s61, 147456
    s_nop 0
    buffer_load_dwordx4 v92, s[36:39], s28 offen nt lds
    s_add_u32 m0, s61, 148480
    s_nop 0
    buffer_load_dwordx4 v93, s[36:39], s28 offen nt lds
    s_add_u32 m0, s61, 149504
    s_nop 0
    buffer_load_dwordx4 v94, s[36:39], s28 offen nt lds
    s_add_u32 m0, s61, 150528
    s_nop 0
    buffer_load_dwordx4 v95, s[36:39], s28 offen nt lds
    v_add_u32 v99, 49152, v96
    ds_read_b64_tr_b16 a[224:225], v99 offset:0
    ds_read_b64_tr_b16 a[226:227], v99 offset:512
    ds_read_b64_tr_b16 a[228:229], v99 offset:8192
    ds_read_b64_tr_b16 a[230:231], v99 offset:8704
    v_add_u32 v99, 49152, v97
    ds_read_b64_tr_b16 a[232:233], v99 offset:0
    ds_read_b64_tr_b16 a[234:235], v99 offset:512
    ds_read_b64_tr_b16 a[236:237], v99 offset:8192
    ds_read_b64_tr_b16 a[238:239], v99 offset:8704
    s_waitcnt lgkmcnt(0)
    s_waitcnt vmcnt(22)
    s_barrier
    s_add_u32 s28, s47, 256
    s_add_u32 m0, s61, 49152
    s_nop 0
    buffer_load_dwordx4 v92, s[36:39], s28 offen nt lds
    s_add_u32 m0, s61, 50176
    s_nop 0
    buffer_load_dwordx4 v93, s[36:39], s28 offen nt lds
    s_add_u32 m0, s61, 51200
    s_nop 0
    buffer_load_dwordx4 v94, s[36:39], s28 offen nt lds
    s_add_u32 m0, s61, 52224
    s_nop 0
    buffer_load_dwordx4 v95, s[36:39], s28 offen nt lds
    v_add_u32 v99, 65536, v96
    ds_read_b64_tr_b16 a[240:241], v99 offset:0
    ds_read_b64_tr_b16 a[242:243], v99 offset:512
    ds_read_b64_tr_b16 a[244:245], v99 offset:8192
    ds_read_b64_tr_b16 a[246:247], v99 offset:8704
    v_add_u32 v99, 65536, v97
    ds_read_b64_tr_b16 a[248:249], v99 offset:0
    ds_read_b64_tr_b16 a[250:251], v99 offset:512
    ds_read_b64_tr_b16 a[252:253], v99 offset:8192
    ds_read_b64_tr_b16 a[254:255], v99 offset:8704
    s_waitcnt lgkmcnt(0)
    s_waitcnt vmcnt(22)
    s_barrier
    s_add_u32 s28, s47, 384
    s_add_u32 m0, s61, 65536
    s_nop 0
    buffer_load_dwordx4 v92, s[36:39], s28 offen nt lds
    s_add_u32 m0, s61, 66560
    s_nop 0
    buffer_load_dwordx4 v93, s[36:39], s28 offen nt lds
    s_add_u32 m0, s61, 67584
    s_nop 0
    buffer_load_dwordx4 v94, s[36:39], s28 offen nt lds
    s_add_u32 m0, s61, 68608
    s_nop 0
    buffer_load_dwordx4 v95, s[36:39], s28 offen nt lds
    v_add_u32 v99, 81920, v96
    ds_read_b64_tr_b16 v[144:145], v99 offset:0
    ds_read_b64_tr_b16 v[146:147], v99 offset:512
    ds_read_b64_tr_b16 v[148:149], v99 offset:8192
    ds_read_b64_tr_b16 v[150:151], v99 offset:8704
    v_add_u32 v99, 81920, v97
    ds_read_b64_tr_b16 v[152:153], v99 offset:0
    ds_read_b64_tr_b16 v[154:155], v99 offset:512
    ds_read_b64_tr_b16 v[156:157], v99 offset:8192
    ds_read_b64_tr_b16 v[158:159], v99 offset:8704
    s_waitcnt lgkmcnt(0)
    s_waitcnt vmcnt(22)
    s_barrier
    s_mov_b32 s36, s12
    s_and_b32 s37, s13, 0xffff
    s_add_u32 s28, s45, 1114112
    s_add_u32 m0, s61, 81920
    s_nop 0
    buffer_load_dwordx4 v100, s[36:39], s28 offen nt lds
    s_add_u32 m0, s61, 82944
    s_nop 0
    buffer_load_dwordx4 v101, s[36:39], s28 offen nt lds
    s_add_u32 m0, s61, 83968
    s_nop 0
    buffer_load_dwordx4 v102, s[36:39], s28 offen nt lds
    s_add_u32 m0, s61, 84992
    s_nop 0
    buffer_load_dwordx4 v103, s[36:39], s28 offen nt lds
    v_add_u32 v99, 98304, v96
    ds_read_b64_tr_b16 v[160:161], v99 offset:0
    ds_read_b64_tr_b16 v[162:163], v99 offset:512
    ds_read_b64_tr_b16 v[164:165], v99 offset:8192
    ds_read_b64_tr_b16 v[166:167], v99 offset:8704
    v_add_u32 v99, 98304, v97
    ds_read_b64_tr_b16 v[168:169], v99 offset:0
    ds_read_b64_tr_b16 v[170:171], v99 offset:512
    ds_read_b64_tr_b16 v[172:173], v99 offset:8192
    ds_read_b64_tr_b16 v[174:175], v99 offset:8704
    s_waitcnt lgkmcnt(0)
    s_waitcnt vmcnt(22)
    s_barrier
    s_mov_b32 s36, s8
    s_and_b32 s37, s9, 0xffff
    s_add_u32 s28, s45, 1048576
    s_add_u32 m0, s61, 98304
    s_nop 0
    buffer_load_dwordx4 v100, s[36:39], s28 offen nt lds
    s_add_u32 m0, s61, 99328
    s_nop 0
    buffer_load_dwordx4 v101, s[36:39], s28 offen nt lds
    s_add_u32 m0, s61, 100352
    s_nop 0
    buffer_load_dwordx4 v102, s[36:39], s28 offen nt lds
    s_add_u32 m0, s61, 101376
    s_nop 0
    buffer_load_dwordx4 v103, s[36:39], s28 offen nt lds
    v_add_u32 v99, 114688, v96
    ds_read_b64_tr_b16 v[176:177], v99 offset:0
    ds_read_b64_tr_b16 v[178:179], v99 offset:512
    ds_read_b64_tr_b16 v[180:181], v99 offset:8192
    ds_read_b64_tr_b16 v[182:183], v99 offset:8704
    v_add_u32 v99, 114688, v97
    ds_read_b64_tr_b16 v[184:185], v99 offset:0
    ds_read_b64_tr_b16 v[186:187], v99 offset:512
    ds_read_b64_tr_b16 v[188:189], v99 offset:8192
    ds_read_b64_tr_b16 v[190:191], v99 offset:8704
    s_waitcnt lgkmcnt(0)
    s_waitcnt vmcnt(22)
    s_barrier
    s_add_u32 s28, s45, 1114112
    s_add_u32 m0, s61, 114688
    s_nop 0
    buffer_load_dwordx4 v100, s[36:39], s28 offen nt lds
    s_add_u32 m0, s61, 115712
    s_nop 0
    buffer_load_dwordx4 v101, s[36:39], s28 offen nt lds
    s_add_u32 m0, s61, 116736
    s_nop 0
    buffer_load_dwordx4 v102, s[36:39], s28 offen nt lds
    s_add_u32 m0, s61, 117760
    s_nop 0
    buffer_load_dwordx4 v103, s[36:39], s28 offen nt lds
    v_add_u32 v99, 131072, v96
    ds_read_b64_tr_b16 v[192:193], v99 offset:0
    ds_read_b64_tr_b16 v[194:195], v99 offset:512
    ds_read_b64_tr_b16 v[196:197], v99 offset:8192
    ds_read_b64_tr_b16 v[198:199], v99 offset:8704
    v_add_u32 v99, 131072, v97
    ds_read_b64_tr_b16 v[200:201], v99 offset:0
    ds_read_b64_tr_b16 v[202:203], v99 offset:512
    ds_read_b64_tr_b16 v[204:205], v99 offset:8192
    ds_read_b64_tr_b16 v[206:207], v99 offset:8704
    s_waitcnt lgkmcnt(0)
    s_waitcnt vmcnt(20)
    s_barrier
    s_mov_b32 s36, s10
    s_and_b32 s37, s11, 0xffff
    s_add_u32 s28, s45, 1048576
    s_add_u32 m0, s61, 131072
    s_nop 0
    buffer_load_dwordx4 v100, s[36:39], s28 offen nt lds
    s_add_u32 m0, s61, 132096
    s_nop 0
    buffer_load_dwordx4 v101, s[36:39], s28 offen nt lds
    s_add_u32 m0, s61, 133120
    s_nop 0
    buffer_load_dwordx4 v102, s[36:39], s28 offen nt lds
    s_add_u32 m0, s61, 134144
    s_nop 0
    buffer_load_dwordx4 v103, s[36:39], s28 offen nt lds
    s_cmp_eq_u32 s33, 1
    s_cbranch_scc1 L_cs_153
    s_branch L_cenc_155
L_cen_154:
    global_load_dword v111, v110, s[20:21] sc1
    s_sub_u32 s27, s27, 1
    s_cbranch_scc0 L_ok_156
    s_mov_b32 s28, 10
    s_branch L_bail
L_ok_156:
    s_waitcnt vmcnt(0)
L_cenc_155:
    s_mov_b32 s29, 0
    v_readlane_b32 s30, v111, 0
    s_nop 0
    s_add_u32 s29, s29, s30
    v_readlane_b32 s30, v111, 1
    s_nop 0
    s_add_u32 s29, s29, s30
    v_readlane_b32 s30, v111, 2
    s_nop 0
    s_add_u32 s29, s29, s30
    v_readlane_b32 s30, v111, 3
    s_nop 0
    s_add_u32 s29, s29, s30
    v_readlane_b32 s30, v111, 4
    s_nop 0
    s_add_u32 s29, s29, s30
    v_readlane_b32 s30, v111, 5
    s_nop 0
    s_add_u32 s29, s29, s30
    v_readlane_b32 s30, v111, 6
    s_nop 0
    s_add_u32 s29, s29, s30
    v_readlane_b32 s30, v111, 7
    s_nop 0
    s_add_u32 s29, s29, s30
    s_cmp_lt_u32 s29, 256
    s_cbranch_scc1 L_cen_154
    v_cmp_ne_u32 vcc, 32, v111
    s_cbranch_vccnz L_fallback
L_cs_153:
L_w_157:
    v_cmp_eq_u32 vcc, 0, v124
    s_cbranch_vccz L_wok_158
    global_load_dword v124, v41, s[20:21] offset:52 sc1
    s_sub_u32 s27, s27, 1
    s_cbranch_scc0 L_ok_159
    s_mov_b32 s28, 8
    s_branch L_bail
L_ok_159:
    s_waitcnt vmcnt(0)
    s_branch L_w_157
L_wok_158:
    v_readfirstlane_b32 s29, v124
    s_nop 0
    s_and_b32 s29, s29, 1
    s_lshl_b32 s30, s29, 13
    s_add_u32 s66, s66, s30
    s_xor_b32 s29, s29, s24
    s_and_b32 s29, s29, 1
    s_lshl_b32 s29, s29, 13
    s_add_u32 s65, s65, s29
    v_add_u32 v99, 147456, v98
    ds_read_b64_tr_b16 v[208:209], v99 offset:0
    ds_read_b64_tr_b16 v[210:211], v99 offset:256
    ds_read_b64_tr_b16 v[212:213], v99 offset:4096
    ds_read_b64_tr_b16 v[214:215], v99 offset:4352
    ds_read_b64_tr_b16 v[216:217], v99 offset:8192
    ds_read_b64_tr_b16 v[218:219], v99 offset:8448
    ds_read_b64_tr_b16 v[220:221], v99 offset:12288
    ds_read_b64_tr_b16 v[222:223], v99 offset:12544
    s_waitcnt lgkmcnt(0)
    s_waitcnt vmcnt(20)
    s_barrier
    s_add_u32 s28, s45, 1114112
    s_add_u32 m0, s61, 147456
    s_nop 0
    buffer_load_dwordx4 v100, s[36:39], s28 offen nt lds
    s_add_u32 m0, s61, 148480
    s_nop 0
    buffer_load_dwordx4 v101, s[36:39], s28 offen nt lds
    s_add_u32 m0, s61, 149504
    s_nop 0
    buffer_load_dwordx4 v102, s[36:39], s28 offen nt lds
    s_add_u32 m0, s61, 150528
    s_nop 0
    buffer_load_dwordx4 v103, s[36:39], s28 offen nt lds
    buffer_load_dword v21, v20, s[4:7], s62 offen sc1
    v_add_u32 v99, 49152, v98
    ds_read_b64_tr_b16 v[224:225], v99 offset:0
    ds_read_b64_tr_b16 v[226:227], v99 offset:256
    ds_read_b64_tr_b16 v[228:229], v99 offset:4096
    ds_read_b64_tr_b16 v[230:231], v99 offset:4352
    ds_read_b64_tr_b16 v[232:233], v99 offset:8192
    ds_read_b64_tr_b16 v[234:235], v99 offset:8448
    ds_read_b64_tr_b16 v[236:237], v99 offset:12288
    ds_read_b64_tr_b16 v[238:239], v99 offset:12544
    s_waitcnt lgkmcnt(0)
    s_waitcnt vmcnt(21)
    s_barrier
    s_mov_b32 s36, s14
    s_and_b32 s37, s15, 0xffff
    s_add_u32 s28, s47, 512
    s_add_u32 m0, s61, 49152
    s_nop 0
    buffer_load_dwordx4 v92, s[36:39], s28 offen nt lds
    s_add_u32 m0, s61, 50176
    s_nop 0
    buffer_load_dwordx4 v93, s[36:39], s28 offen nt lds
    s_add_u32 m0, s61, 51200
    s_nop 0
    buffer_load_dwordx4 v94, s[36:39], s28 offen nt lds
    s_add_u32 m0, s61, 52224
    s_nop 0
    buffer_load_dwordx4 v95, s[36:39], s28 offen nt lds
    v_add_u32 v99, 65536, v98
    ds_read_b64_tr_b16 v[240:241], v99 offset:0
    ds_read_b64_tr_b16 v[242:243], v99 offset:256
    ds_read_b64_tr_b16 v[244:245], v99 offset:4096
    ds_read_b64_tr_b16 v[246:247], v99 offset:4352
    ds_read_b64_tr_b16 v[248:249], v99 offset:8192
    ds_read_b64_tr_b16 v[250:251], v99 offset:8448
    ds_read_b64_tr_b16 v[252:253], v99 offset:12288
    ds_read_b64_tr_b16 v[254:255], v99 offset:12544
    s_waitcnt lgkmcnt(0)
    s_waitcnt vmcnt(21)
    s_barrier
    s_add_u32 s28, s47, 0
    s_add_u32 m0, s61, 65536
    s_nop 0
    buffer_load_dwordx4 v92, s[36:39], s28 offen nt lds
    s_add_u32 m0, s61, 66560
    s_nop 0
    buffer_load_dwordx4 v93, s[36:39], s28 offen nt lds
    s_add_u32 m0, s61, 67584
    s_nop 0
    buffer_load_dwordx4 v94, s[36:39], s28 offen nt lds
    s_add_u32 m0, s61, 68608
    s_nop 0
    buffer_load_dwordx4 v95, s[36:39], s28 offen nt lds
    global_load_dword v125, v41, s[20:21] offset:44 sc1
    v_add_u32 v99, 81920, v96
    ds_read_b64_tr_b16 v[44:45], v99 offset:0
    ds_read_b64_tr_b16 v[46:47], v99 offset:512
    ds_read_b64_tr_b16 v[48:49], v99 offset:8192
    ds_read_b64_tr_b16 v[50:51], v99 offset:8704
    v_add_u32 v99, 81920, v97
    ds_read_b64_tr_b16 v[52:53], v99 offset:0
    ds_read_b64_tr_b16 v[54:55], v99 offset:512
    ds_read_b64_tr_b16 v[56:57], v99 offset:8192
    ds_read_b64_tr_b16 v[58:59], v99 offset:8704
    s_waitcnt lgkmcnt(0)
    s_barrier
    v_add_u32 v99, 32768, v16
    ds_write_b128 v99, v[44:47] offset:0
    ds_write_b128 v99, v[48:51] offset:1024
    ds_write_b128 v99, v[52:55] offset:2048
    ds_write_b128 v99, v[56:59] offset:3072
    s_waitcnt lgkmcnt(0)
    s_waitcnt vmcnt(22)
    s_barrier
    v_add_u32 v99, 98304, v96
    ds_read_b64_tr_b16 v[44:45], v99 offset:0
    ds_read_b64_tr_b16 v[46:47], v99 offset:512
    ds_read_b64_tr_b16 v[48:49], v99 offset:8192
    ds_read_b64_tr_b16 v[50:51], v99 offset:8704
    v_add_u32 v99, 98304, v97
    ds_read_b64_tr_b16 v[52:53], v99 offset:0
    ds_read_b64_tr_b16 v[54:55], v99 offset:512
    ds_read_b64_tr_b16 v[56:57], v99 offset:8192
    ds_read_b64_tr_b16 v[58:59], v99 offset:8704
    s_waitcnt lgkmcnt(0)
    s_barrier
    v_add_u32 v99, 49152, v16
    ds_write_b128 v99, v[44:47] offset:0
    ds_write_b128 v99, v[48:51] offset:1024
    ds_write_b128 v99, v[52:55] offset:2048
    ds_write_b128 v99, v[56:59] offset:3072
    s_waitcnt lgkmcnt(0)
    s_waitcnt vmcnt(18)
    s_barrier
    v_add_u32 v99, 114688, v96
    ds_read_b64_tr_b16 v[44:45], v99 offset:0
    ds_read_b64_tr_b16 v[46:47], v99 offset:512
    ds_read_b64_tr_b16 v[48:49], v99 offset:8192
    ds_read_b64_tr_b16 v[50:51], v99 offset:8704
    v_add_u32 v99, 114688, v97
    ds_read_b64_tr_b16 v[52:53], v99 offset:0
    ds_read_b64_tr_b16 v[54:55], v99 offset:512
    ds_read_b64_tr_b16 v[56:57], v99 offset:8192
    ds_read_b64_tr_b16 v[58:59], v99 offset:8704
    s_waitcnt lgkmcnt(0)
    s_barrier
    v_add_u32 v99, 65536, v16
    ds_write_b128 v99, v[44:47] offset:0
    ds_write_b128 v99, v[48:51] offset:1024
    ds_write_b128 v99, v[52:55] offset:2048
    ds_write_b128 v99, v[56:59] offset:3072
    s_waitcnt lgkmcnt(0)
    s_waitcnt vmcnt(14)
    s_barrier
    v_add_u32 v99, 131072, v96
    ds_read_b64_tr_b16 v[44:45], v99 offset:0
    ds_read_b64_tr_b16 v[46:47], v99 offset:512
    ds_read_b64_tr_b16 v[48:49], v99 offset:8192
    ds_read_b64_tr_b16 v[50:51], v99 offset:8704
    v_add_u32 v99, 131072, v97
    ds_read_b64_tr_b16 v[52:53], v99 offset:0
    ds_read_b64_tr_b16 v[54:55], v99 offset:512
    ds_read_b64_tr_b16 v[56:57], v99 offset:8192
    ds_read_b64_tr_b16 v[58:59], v99 offset:8704
    s_waitcnt lgkmcnt(0)
    s_barrier
    v_add_u32 v99, 81920, v16
    ds_write_b128 v99, v[44:47] offset:0
    ds_write_b128 v99, v[48:51] offset:1024
    ds_write_b128 v99, v[52:55] offset:2048
    ds_write_b128 v99, v[56:59] offset:3072
    s_waitcnt lgkmcnt(0)
    s_waitcnt vmcnt(10)
    s_barrier
    v_add_u32 v99, 147456, v96
    ds_read_b64_tr_b16 v[44:45], v99 offset:0
    ds_read_b64_tr_b16 v[46:47], v99 offset:512
    ds_read_b64_tr_b16 v[48:49], v99 offset:8192
    ds_read_b64_tr_b16 v[50:51], v99 offset:8704
    v_add_u32 v99, 147456, v97
    ds_read_b64_tr_b16 v[52:53], v99 offset:0
    ds_read_b64_tr_b16 v[54:55], v99 offset:512
    ds_read_b64_tr_b16 v[56:57], v99 offset:8192
    ds_read_b64_tr_b16 v[58:59], v99 offset:8704
    s_waitcnt lgkmcnt(0)
    s_barrier
    v_add_u32 v99, 98304, v16
    ds_write_b128 v99, v[44:47] offset:0
    ds_write_b128 v99, v[48:51] offset:1024
    ds_write_b128 v99, v[52:55] offset:2048
    ds_write_b128 v99, v[56:59] offset:3072
    s_waitcnt lgkmcnt(0)
    s_waitcnt vmcnt(5)
    s_barrier
L_w_160:
    v_add_u32 v110, v21, v15
    v_cmp_gt_u32 vcc, 1, v110
    s_cbranch_vccz L_wok_161
    buffer_load_dword v21, v20, s[4:7], s62 offen sc1
    s_sub_u32 s27, s27, 1
    s_cbranch_scc0 L_ok_162
    s_mov_b32 s28, 1
    s_branch L_bail
L_ok_162:
    s_waitcnt vmcnt(0)
    s_branch L_w_160
L_wok_161:
    s_lshl_b32 s61, s26, 11
    s_add_u32 s60, s57, 524288
    s_mov_b32 m0, s61
    s_nop 0
    buffer_load_dwordx4 v12, s[4:7], s57 offen sc1 lds
    buffer_load_dwordx4 v12, s[4:7], s57 offen offset:1024 sc1 lds
    s_add_u32 m0, s61, 8192
    s_nop 0
    buffer_load_dwordx4 v12, s[4:7], s60 offen sc1 lds
    buffer_load_dwordx4 v12, s[4:7], s60 offen offset:1024 sc1 lds
    v_add_u32 v99, 49152, v98
    ds_read_b64_tr_b16 v[44:45], v99 offset:0
    ds_read_b64_tr_b16 v[46:47], v99 offset:256
    ds_read_b64_tr_b16 v[48:49], v99 offset:4096
    ds_read_b64_tr_b16 v[50:51], v99 offset:4352
    ds_read_b64_tr_b16 v[52:53], v99 offset:8192
    ds_read_b64_tr_b16 v[54:55], v99 offset:8448
    ds_read_b64_tr_b16 v[56:57], v99 offset:12288
    ds_read_b64_tr_b16 v[58:59], v99 offset:12544
    s_waitcnt lgkmcnt(0)
    s_barrier
    v_add_u32 v99, 0, v16
    ds_write_b128 v99, v[44:47] offset:0
    ds_write_b128 v99, v[48:51] offset:1024
    ds_write_b128 v99, v[52:55] offset:2048
    ds_write_b128 v99, v[56:59] offset:3072
    s_waitcnt lgkmcnt(0)
    s_waitcnt vmcnt(5)
    s_barrier
    v_add_u32 v99, 65536, v98
    ds_read_b64_tr_b16 v[44:45], v99 offset:0
    ds_read_b64_tr_b16 v[46:47], v99 offset:256
    ds_read_b64_tr_b16 v[48:49], v99 offset:4096
    ds_read_b64_tr_b16 v[50:51], v99 offset:4352
    ds_read_b64_tr_b16 v[52:53], v99 offset:8192
    ds_read_b64_tr_b16 v[54:55], v99 offset:8448
    ds_read_b64_tr_b16 v[56:57], v99 offset:12288
    ds_read_b64_tr_b16 v[58:59], v99 offset:12544
    s_waitcnt lgkmcnt(0)
    s_barrier
    v_add_u32 v99, 16384, v16
    ds_write_b128 v99, v[44:47] offset:0
    ds_write_b128 v99, v[48:51] offset:1024
    ds_write_b128 v99, v[52:55] offset:2048
    ds_write_b128 v99, v[56:59] offset:3072
    s_waitcnt lgkmcnt(0)
    s_waitcnt vmcnt(0)
L_w_163:
    v_cmp_gt_u32 vcc, 32, v125
    s_cbranch_vccz L_wok_164
    global_load_dword v125, v41, s[20:21] offset:44 sc1
    s_sub_u32 s27, s27, 1
    s_cbranch_scc0 L_ok_165
    s_mov_b32 s28, 2
    s_branch L_bail
L_ok_165:
    s_waitcnt vmcnt(0)
    s_branch L_w_163
L_wok_164:
    s_barrier
    v_mov_b32 v108, 0
    v_mov_b32 v116, 0
    v_mov_b32 v124, 0
    v_mov_b32 v109, 0
    v_mov_b32 v117, 0
    v_mov_b32 v125, 0
    v_mov_b32 v110, 0
    v_mov_b32 v118, 0
    v_mov_b32 v126, 0
    v_mov_b32 v111, 0
    v_mov_b32 v119, 0
    v_mov_b32 v127, 0
    v_mov_b32 v112, 0
    v_mov_b32 v120, 0
    v_mov_b32 v128, 0
    v_mov_b32 v113, 0
    v_mov_b32 v121, 0
    v_mov_b32 v129, 0
    v_mov_b32 v114, 0
    v_mov_b32 v122, 0
    v_mov_b32 v130, 0
    v_mov_b32 v115, 0
    v_mov_b32 v123, 0
    v_mov_b32 v131, 0
    s_mov_b32 s40, -1
    s_mov_b64 s[74:75], -1
    s_mov_b32 s69, 1073741824
    s_cmp_eq_u32 s25, 0
    s_cselect_b64 s[76:77], 0, -1
    s_bfe_u32 s41, s40, 0x10001
    s_and_b32 s29, s40, 3
    s_lshl_b32 s28, s25, 17
    s_lshl_b32 s31, s29, 15
    s_add_u32 s50, s28, s31
    s_add_u32 s50, s50, 70254592
    s_xor_b32 s51, s50, 65536
    s_add_u32 s28, s28, s66
    s_add_u32 s53, s28, s31
    s_add_u32 s54, s31, 32768
    s_and_b32 s54, s54, 131071
    s_add_u32 s54, s54, s28
    s_lshl_b32 s31, s29, 14
    s_lshl_b32 s28, s25, 12
    s_add_u32 s28, s28, s65
    s_add_u32 s42, s28, s31
    s_xor_b32 s43, s42, 4096
    s_xor_b32 s44, s42, 32768
    s_and_b32 s28, s40, 1
    s_mul_i32 s29, s28, 163840
    s_lshl_b32 s30, s25, 19
    s_add_u32 s29, s29, s30
    s_add_u32 s45, s29, 69206016
    s_add_u32 s48, s45, s58
    s_add_u32 s49, s45, 65536
    s_add_u32 s29, s40, 1
    s_min_u32 s29, s29, 63
    s_lshl_b32 s29, s29, 13
    s_add_u32 s59, s57, s29
    s_add_u32 s60, s59, 524288
    s_bfe_u32 s29, s40, 0x20001
    s_lshl_b32 s29, s29, 14
    s_lshl_b32 s30, s28, 12
    s_add_u32 s29, s29, s30
    s_lshl_b32 s30, s25, 11
    s_add_u32 s29, s29, s30
    s_add_u32 s29, s29, s65
    s_sub_u32 s70, s29, 655360
    s_cmp_eq_u32 s40, 63
    s_cselect_b64 s[46:47], -1, 0
    s_xor_b32 s28, s28, 1
    s_lshl_b32 s28, s28, 14
    s_lshl_b32 s61, s26, 11
    s_add_u32 s61, s61, s28
    s_mov_b32 s52, s50
    s_xor_b32 s55, s53, 0x20000
    s_mov_b32 s70, 1073741824
    s_branch L_enter1
L_step1:
    s_waitcnt lgkmcnt(4)
    v_smfmac_f32_16x16x64_bf16 v[124:127], v[44:47], a[0:7], v1
    ds_read_b128 v[64:67], v16 offset:32768
    v_smfmac_f32_16x16x64_bf16 v[128:131], v[44:47], a[8:15], v1
    ds_read_b128 v[68:71], v16 offset:33792
    s_add_u32 m0, s64, 41984
    s_nop 0
    buffer_load_dword v4, s[4:7], s55 offen sc1 lds
    s_waitcnt lgkmcnt(5)
    v_smfmac_f32_16x16x64_bf16 v[124:127], v[48:51], a[16:23], v1
    ds_read_b128 v[72:75], v16 offset:34816
    s_add_u32 s29, s40, 2
    s_min_u32 s29, s29, 64
    v_add_u32 v21, v21, v15
    v_cmp_gt_u32 vcc, s29, v21
    v_smfmac_f32_16x16x64_bf16 v[128:131], v[48:51], a[24:31], v1
    ds_read_b128 v[76:79], v16 offset:35840
    s_waitcnt lgkmcnt(6)
    v_smfmac_f32_16x16x64_bf16 v[124:127], v[52:55], a[32:39], v1
    ds_read_b128 v[80:83], v16 offset:49152
    s_cbranch_vccnz L_w1_168
L_w1ok_169:
    s_mov_b32 m0, s61
    s_nop 0
    buffer_load_dwordx4 v12, s[4:7], s59 offen sc1 lds
    v_smfmac_f32_16x16x64_bf16 v[128:131], v[52:55], a[40:47], v1
    ds_read_b128 v[84:87], v16 offset:50176
    s_waitcnt lgkmcnt(7)
    v_smfmac_f32_16x16x64_bf16 v[124:127], v[56:59], a[48:55], v1
    s_waitcnt lgkmcnt(6)
    s_waitcnt lgkmcnt(4)
    v_smfmac_f32_16x16x64_bf16 v[124:127], v[60:63], v[64:71], v1
    ds_read_b128 v[64:67], v16 offset:51200
    v_smfmac_f32_16x16x64_bf16 v[128:131], v[56:59], a[56:63], v1
    ds_read_b128 v[68:71], v16 offset:52224
    s_mov_b32 m0, s61
    s_nop 0
    buffer_load_dwordx4 v12, s[4:7], s59 offen offset:1024 sc1 lds
    s_waitcnt lgkmcnt(4)
    v_smfmac_f32_16x16x64_bf16 v[128:131], v[60:63], v[72:79], v1
    ds_read_b128 v[72:75], v17 offset:0
    v_smfmac_f32_16x16x64_bf16 v[108:111], v[44:47], a[64:71], v1
    ds_read_b128 v[76:79], v17 offset:1024
    v_smfmac_f32_16x16x64_bf16 v[112:115], v[44:47], a[72:79], v1
    v_add_f32 v124, v124, v126
    v_add_f32 v125, v125, v127
    v_add_f32 v126, v128, v130
    v_add_f32 v127, v129, v131
    s_waitcnt lgkmcnt(4)
    v_smfmac_f32_16x16x64_bf16 v[108:111], v[56:59], v[80:87], v1
    ds_read_b128 v[80:83], v17 offset:2048
    v_cvt_pk_bf16_f32 v128, v124, v125
    v_cvt_pk_bf16_f32 v129, v126, v127
    v_max_i32 v128, 2147483649, v128
    buffer_store_dwordx2 v[128:129], v5, s[4:7], s42 offen sc1
    v_smfmac_f32_16x16x64_bf16 v[108:111], v[48:51], a[80:87], v1
    ds_read_b128 v[84:87], v17 offset:3072
    s_waitcnt lgkmcnt(4)
    v_smfmac_f32_16x16x64_bf16 v[112:115], v[56:59], v[64:71], v1
    ds_read_b128 v[64:67], v17 offset:16384
    v_smfmac_f32_16x16x64_bf16 v[112:115], v[48:51], a[88:95], v1
    ds_read_b128 v[68:71], v17 offset:17408
    s_waitcnt lgkmcnt(4)
    v_smfmac_f32_16x16x64_bf16 v[108:111], v[60:63], v[72:79], v1
    ds_read_b128 v[72:75], v17 offset:18432
    v_smfmac_f32_16x16x64_bf16 v[108:111], v[52:55], a[96:103], v1
    ds_read_b128 v[76:79], v17 offset:19456
    v_smfmac_f32_16x16x64_bf16 v[112:115], v[52:55], a[104:111], v1
    s_waitcnt lgkmcnt(4)
    v_smfmac_f32_16x16x64_bf16 v[112:115], v[60:63], v[80:87], v1
    ds_read_b128 v[80:83], v17 offset:32768
    v_smfmac_f32_16x16x64_bf16 v[116:119], v[44:47], a[112:119], v1
    ds_read_b128 v[84:87], v17 offset:33792
    s_waitcnt lgkmcnt(4)
    v_smfmac_f32_16x16x64_bf16 v[116:119], v[56:59], v[64:71], v1
    ds_read_b128 v[64:67], v17 offset:34816
    v_smfmac_f32_16x16x64_bf16 v[120:123], v[44:47], a[120:127], v1
    ds_read_b128 v[68:71], v17 offset:35840
    v_smfmac_f32_16x16x64_bf16 v[116:119], v[48:51], a[128:135], v1
    s_waitcnt lgkmcnt(4)
    v_smfmac_f32_16x16x64_bf16 v[120:123], v[56:59], v[72:79], v1
    v_smfmac_f32_16x16x64_bf16 v[120:123], v[48:51], a[136:143], v1
    s_waitcnt vmcnt(3)
    v_cmp_eq_u32 vcc, v22, v140
    s_waitcnt lgkmcnt(2)
    v_smfmac_f32_16x16x64_bf16 v[116:119], v[60:63], v[80:87], v1
    v_smfmac_f32_16x16x64_bf16 v[116:119], v[52:55], a[144:151], v1
    s_cbranch_vccnz L_rretry_166
L_rjoin_167:
    s_barrier
    ds_read_b128 v[88:91], v2 offset:41984
    ds_read_b128 v[92:95], v2 offset:43008
    ds_read_b128 v[96:99], v2 offset:44032
    ds_read_b128 v[100:103], v2 offset:45056
    ds_read_b128 v[104:107], v2 offset:46080
    s_waitcnt lgkmcnt(5)
    v_smfmac_f32_16x16x64_bf16 v[120:123], v[60:63], v[64:71], v1
    v_smfmac_f32_16x16x64_bf16 v[120:123], v[52:55], a[152:159], v1
    s_waitcnt lgkmcnt(4)
    v_smfmac_f32_16x16x64_bf16 v[108:111], v[88:91], a[160:167], v1
    ds_read_b128 v[44:47], v13 offset:0
    v_smfmac_f32_16x16x64_bf16 v[112:115], v[88:91], a[168:175], v1
    ds_read_b128 v[48:51], v13 offset:1024
    s_waitcnt lgkmcnt(5)
    v_smfmac_f32_16x16x64_bf16 v[108:111], v[92:95], a[176:183], v1
    ds_read_b128 v[52:55], v13 offset:2048
    v_smfmac_f32_16x16x64_bf16 v[112:115], v[92:95], a[184:191], v1
    ds_read_b128 v[56:59], v13 offset:3072
    s_waitcnt lgkmcnt(6)
    v_smfmac_f32_16x16x64_bf16 v[108:111], v[96:99], a[192:199], v1
    ds_read_b128 v[60:63], v13 offset:4096
    v_smfmac_f32_16x16x64_bf16 v[112:115], v[96:99], a[200:207], v1
    ds_read_b128 v[64:67], v13 offset:5120
    s_waitcnt lgkmcnt(7)
    v_smfmac_f32_16x16x64_bf16 v[108:111], v[100:103], a[208:215], v1
    ds_read_b128 v[68:71], v13 offset:6144
    v_smfmac_f32_16x16x64_bf16 v[112:115], v[100:103], a[216:223], v1
    ds_read_b128 v[72:75], v13 offset:7168
    buffer_load_dwordx2 v[140:141], v5, s[4:7], s43 offen sc1
    s_waitcnt lgkmcnt(8)
    v_smfmac_f32_16x16x64_bf16 v[108:111], v[104:107], a[224:231], v1
    ds_read_b64_tr_b16 v[132:133], v14 offset:0
    ds_read_b64_tr_b16 v[134:135], v14 offset:4096
    v_smfmac_f32_16x16x64_bf16 v[112:115], v[104:107], a[232:239], v1
    ds_read_b64_tr_b16 v[136:137], v14 offset:512
    ds_read_b64_tr_b16 v[138:139], v14 offset:4608
    v_smfmac_f32_16x16x64_bf16 v[116:119], v[88:91], a[240:247], v1
    s_add_u32 m0, s61, 8192
    s_nop 0
    buffer_load_dwordx4 v12, s[4:7], s60 offen sc1 lds
    v_smfmac_f32_16x16x64_bf16 v[120:123], v[88:91], a[248:255], v1
    v_add_f32 v108, v108, v110
    v_add_f32 v109, v109, v111
    v_add_f32 v112, v112, v114
    v_add_f32 v113, v113, v115
    v_cvt_pk_bf16_f32 v108, v108, v109
    v_cvt_pk_bf16_f32 v109, v112, v113
    ds_write2_b32 v9, v108, v109 offset0:0 offset1:128
    v_smfmac_f32_16x16x64_bf16 v[116:119], v[92:95], v[144:151], v1
    buffer_load_dwordx2 v[28:29], v5, s[4:7], s43 offen sc1
    v_smfmac_f32_16x16x64_bf16 v[120:123], v[92:95], v[152:159], v1
    v_xor_b32 v13, 16384, v13
    v_smfmac_f32_16x16x64_bf16 v[116:119], v[96:99], v[160:167], v1
    s_add_u32 m0, s61, 8192
    s_nop 0
    buffer_load_dwordx4 v12, s[4:7], s60 offen offset:1024 sc1 lds
    v_smfmac_f32_16x16x64_bf16 v[120:123], v[96:99], v[168:175], v1
    v_xor_b32 v14, 16384, v14
    s_waitcnt lgkmcnt(0)
    s_barrier
    ds_read_b64_tr_b16 v[76:77], v10 offset:0
    ds_read_b64_tr_b16 v[78:79], v0 offset:256
    v_smfmac_f32_16x16x64_bf16 v[116:119], v[100:103], v[176:183], v1
    ds_read_b64_tr_b16 v[80:81], v10 offset:1024
    ds_read_b64_tr_b16 v[82:83], v0 offset:1280
    v_smfmac_f32_16x16x64_bf16 v[120:123], v[100:103], v[184:191], v1
    ds_read_b64_tr_b16 v[84:85], v10 offset:2048
    ds_read_b64_tr_b16 v[86:87], v0 offset:2304
    v_smfmac_f32_16x16x64_bf16 v[116:119], v[104:107], v[192:199], v1
    buffer_load_dword v21, v20, s[4:7], s62 offen sc1
    ds_read_b64_tr_b16 v[88:89], v10 offset:3072
    ds_read_b64_tr_b16 v[90:91], v0 offset:3328
    v_smfmac_f32_16x16x64_bf16 v[120:123], v[104:107], v[200:207], v1
    s_waitcnt lgkmcnt(4)
    v_mfma_f32_16x16x32_bf16 v[108:111], v[44:47], v[76:79], 0
    v_mfma_f32_16x16x32_bf16 v[108:111], v[48:51], v[80:83], v[108:111]
    buffer_store_dwordx2 v[22:23], v5, s[4:7], s44 offen sc1
    s_waitcnt lgkmcnt(0)
    v_mfma_f32_16x16x32_bf16 v[108:111], v[52:55], v[84:87], v[108:111]
    v_add_f32 v116, v116, v118
    v_add_f32 v117, v117, v119
    v_add_f32 v120, v120, v122
    v_mfma_f32_16x16x32_bf16 v[108:111], v[56:59], v[88:91], v[108:111]
    v_add_f32 v121, v121, v123
    v_cvt_pk_bf16_f32 v142, v116, v117
    v_cvt_pk_bf16_f32 v143, v120, v121
    ds_write2st64_b32 v9, v142, v143 offset0:16 offset1:18
    v_mfma_f32_16x16x32_bf16 v[112:115], v[60:63], v[76:79], 0
    v_mfma_f32_16x16x32_bf16 v[112:115], v[64:67], v[80:83], v[112:115]
    buffer_store_dword v22, v6, s[4:7], s54 offen sc1
    v_exp_f32 v108, v108
    v_exp_f32 v109, v109
    v_exp_f32 v110, v110
    v_exp_f32 v111, v111
    v_cvt_pk_bf16_f32 v128, v108, v109
    v_cvt_pk_bf16_f32 v129, v110, v111
    s_waitcnt lgkmcnt(0)
    s_barrier
    ds_read_b64_tr_b16 v[92:93], v10 offset:4096
    ds_read_b64_tr_b16 v[94:95], v0 offset:4352
    v_mfma_f32_16x16x32_bf16 v[112:115], v[68:71], v[84:87], v[112:115]
    ds_read_b64_tr_b16 v[96:97], v10 offset:5120
    ds_read_b64_tr_b16 v[98:99], v0 offset:5376
    v_mfma_f32_16x16x32_bf16 v[112:115], v[72:75], v[88:91], v[112:115]
    ds_read_b64_tr_b16 v[100:101], v10 offset:6144
    ds_read_b64_tr_b16 v[102:103], v0 offset:6400
    ds_read_b64_tr_b16 v[104:105], v10 offset:7168
    ds_read_b64_tr_b16 v[106:107], v0 offset:7424
    s_waitcnt lgkmcnt(4)
    v_mfma_f32_16x16x32_bf16 v[120:123], v[92:95], v[76:79], 0
    v_mfma_f32_16x16x32_bf16 v[120:123], v[96:99], v[80:83], v[120:123]
    v_exp_f32 v112, v112
    s_waitcnt lgkmcnt(0)
    v_mfma_f32_16x16x32_bf16 v[120:123], v[100:103], v[84:87], v[120:123]
    v_exp_f32 v113, v113
    v_mfma_f32_16x16x32_bf16 v[120:123], v[104:107], v[88:91], v[120:123]
    v_exp_f32 v114, v114
    v_exp_f32 v115, v115
    v_cvt_pk_bf16_f32 v130, v112, v113
    v_cvt_pk_bf16_f32 v131, v114, v115
    s_waitcnt vmcnt(6)
L_v_170:
    v_cmp_eq_u32 vcc, v22, v140
    v_lshlrev_b32 v24, 16, v140
    v_and_b32 v25, 0xffff0000, v140
    v_lshlrev_b32 v26, 16, v141
    v_and_b32 v27, 0xffff0000, v141
    s_cbranch_vccnz L_vretry_171
    v_mfma_f32_16x16x32_bf16 v[108:111], v[132:135], v[128:131], 0
    v_mul_f32 v120, s72, v120
    v_mul_f32 v121, s72, v121
    v_mfma_f32_16x16x32_bf16 v[112:115], v[136:139], v[128:131], 0
    v_exp_f32 v120, v120
    v_mfma_f32_16x16x32_bf16 v[116:119], v[128:131], v[36:39], 0
    v_exp_f32 v121, v121
    v_add_f32 v24, v24, v124
    v_add_f32 v25, v25, v125
    v_cvt_pk_bf16_f32 v32, v24, v25
    v_cvt_pk_bf16_f32 v40, v120, v121
    v_add_f32 v26, v26, v126
    v_add_f32 v27, v27, v127
    v_cvt_pk_bf16_f32 v34, v26, v27
L_smjoin_173:
    s_nop 1
    v_mfma_f32_16x16x32_bf16 v[108:111], v[32:35], v[40:43], v[108:111]
    s_mov_b64 vcc, s[0:1]
    v_mfma_f32_16x16x32_bf16 v[112:115], v[34:37], v[40:43], v[112:115]
    v_mfma_f32_16x16x32_bf16 v[116:119], v[40:43], v[36:39], v[116:119]
    v_cndmask_b32 v24, v142, v32, s[76:77]
    v_cndmask_b32 v25, v143, v34, s[76:77]
    v_cvt_pk_bf16_f32 v108, v108, v109
    v_cvt_pk_bf16_f32 v109, v110, v111
    s_nop 0
    v_cvt_pk_bf16_f32 v110, v112, v113
    v_cvt_pk_bf16_f32 v111, v114, v115
    v_mfma_f32_16x16x32_bf16 v[92:95], v[40:43], v[42:45], 0
    v_cndmask_b32_dpp v108, v110, v108, vcc quad_perm:[0,1,0,1] row_mask:0xf bank_mask:0xf
    v_cndmask_b32_dpp v109, v111, v109, vcc quad_perm:[0,1,0,1] row_mask:0xf bank_mask:0xf
    ds_write_b64 v11, v[108:109]
    v_mfma_f32_32x32x16_bf16 v[76:91], v[40:43], v[42:45], 0
    v_max_i32 v24, 2147483649, v24
    buffer_store_dwordx2 v[24:25], v5, s[4:7], s70 offen sc1
    v_max_f32 v26, v116, v117
    v_min_f32 v27, v116, v117
    v_cmp_nge_f32 vcc, s67, v26
    v_cmp_nle_f32 s[80:81], s68, v27
    v_mfma_f32_16x16x32_bf16 v[120:123], v[36:39], v[36:39], v[120:123]
    s_waitcnt lgkmcnt(0)
    s_barrier
    ds_read_b128 v[132:135], v31 offset:47104
    ds_read_b128 v[136:139], v31 offset:48128
    v_rcp_f32 v118, v116
    s_or_b64 vcc, vcc, s[80:81]
    s_and_b64 vcc, vcc, s[74:75]
    v_rcp_f32 v119, v117
    s_or_b64 vcc, vcc, s[46:47]
    v_mfma_f32_16x16x32_bf16 v[120:123], v[36:39], v[36:39], v[120:123]
    s_cbranch_vccnz L_slowsm_172
    v_mfma_f32_16x16x32_bf16 v[120:123], v[36:39], v[36:39], v[120:123]
    ds_read_b128 v[44:47], v16 offset:0
    ds_read_b128 v[48:51], v16 offset:1024
    s_mov_b64 s[74:75], -1
    s_waitcnt lgkmcnt(3)
    v_smfmac_f32_16x16x64_bf16 v[80:83], v[132:135], v[208:215], v1
    ds_read_b128 v[52:55], v16 offset:2048
    s_waitcnt lgkmcnt(3)
    v_smfmac_f32_16x16x64_bf16 v[80:83], v[136:139], v[216:223], v1
    ds_read_b128 v[56:59], v16 offset:3072
    v_smfmac_f32_16x16x64_bf16 v[84:87], v[132:135], v[224:231], v1
    ds_read_b128 v[60:63], v16 offset:16384
    ds_read_b128 v[64:67], v16 offset:17408
    v_smfmac_f32_16x16x64_bf16 v[84:87], v[136:139], v[232:239], v1
    ds_read_b128 v[68:71], v16 offset:18432
    ds_read_b128 v[72:75], v16 offset:19456
    v_add_f32 v80, v80, v82
    v_smfmac_f32_16x16x64_bf16 v[88:91], v[132:135], v[240:247], v1
    v_add_f32 v81, v81, v83
    v_mul_f32 v80, v80, v118
    v_smfmac_f32_16x16x64_bf16 v[88:91], v[136:139], v[248:255], v1
    v_mul_f32 v81, v81, v119
    v_cvt_pk_bf16_f32 v24, v80, v81
    v_and_or_b32 v24, v24, -2, s41
    s_waitcnt lgkmcnt(6)
    v_smfmac_f32_16x16x64_bf16 v[92:95], v[132:135], v[44:51], v1
    v_add_f32 v84, v84, v86
    v_add_f32 v85, v85, v87
    v_mul_f32 v84, v84, v118
    s_waitcnt lgkmcnt(4)
    v_smfmac_f32_16x16x64_bf16 v[92:95], v[136:139], v[52:59], v1
    v_mul_f32 v85, v85, v119
    v_cvt_pk_bf16_f32 v25, v84, v85
    buffer_store_dwordx2 v[24:25], v7, s[4:7], s45 offen sc1
    s_waitcnt lgkmcnt(2)
    v_smfmac_f32_16x16x64_bf16 v[76:79], v[132:135], v[60:67], v1
    v_add_f32 v88, v88, v90
    v_add_f32 v89, v89, v91
    v_mul_f32 v88, v88, v118
    s_waitcnt lgkmcnt(0)
    v_smfmac_f32_16x16x64_bf16 v[76:79], v[136:139], v[68:75], v1
    v_mul_f32 v89, v89, v119
    v_cvt_pk_bf16_f32 v26, v88, v89
    v_and_or_b32 v26, v26, -2, s41
    v_add_f32 v92, v92, v94
    v_add_f32 v93, v93, v95
    v_mul_f32 v92, v92, v118
    v_mul_f32 v93, v93, v119
    v_cvt_pk_bf16_f32 v27, v92, v93
    buffer_store_dwordx2 v[26:27], v7, s[4:7], s49 offen sc1
    v_pk_add_f32 v[76:77], v[76:77], v[78:79]
    v_pk_mul_f32 v[76:77], v[76:77], v[118:119]
    v_cvt_pk_bf16_f32 v24, v76, v77
    v_and_or_b32 v24, v24, -2, s41
    buffer_store_dword v24, v8, s[4:7], s45 offen sc1
    s_mov_b32 s52, s50
    s_xor_b32 s55, s53, 0x20000
    v_mov_b32 v124, 0
    v_mov_b32 v125, 0
    v_mov_b32 v126, 0
    v_mov_b32 v127, 0
    v_mov_b32 v128, 0
    v_mov_b32 v129, 0
    v_mov_b32 v130, 0
    v_mov_b32 v131, 0
    v_mov_b32 v108, 0
    v_mov_b32 v109, 0
    v_mov_b32 v110, 0
    v_mov_b32 v111, 0
    v_mov_b32 v112, 0
    v_mov_b32 v113, 0
    v_mov_b32 v114, 0
    v_mov_b32 v115, 0
    v_mov_b32 v116, 0
    v_mov_b32 v117, 0
    v_mov_b32 v118, 0
    v_mov_b32 v119, 0
    s_cmp_eq_u32 s63, 0
    s_cbranch_scc1 L_zrest_177
    s_mov_b32 vcc_lo, 0x3030303
    s_mov_b32 vcc_hi, 0x3030303
    v_cndmask_b32 v136, v41, v30, vcc
    s_mov_b32 vcc_lo, 0xc0c0c0c
    s_mov_b32 vcc_hi, 0xc0c0c0c
    v_cndmask_b32 v137, v41, v30, vcc
    s_mov_b32 vcc_lo, 0x30303030
    s_mov_b32 vcc_hi, 0x30303030
    v_cndmask_b32 v138, v41, v30, vcc
    s_mov_b32 vcc_lo, 0xc0c0c0c0
    s_mov_b32 vcc_hi, 0xc0c0c0c0
    v_cndmask_b32 v139, v41, v30, vcc
    buffer_load_dwordx4 v[44:47], v2, s[4:7], s48 offen offset:0 sc1
    buffer_load_dwordx4 v[48:51], v2, s[4:7], s48 offen offset:1024 sc1
    buffer_load_dwordx4 v[52:55], v2, s[4:7], s48 offen offset:2048 sc1
    buffer_load_dwordx4 v[56:59], v2, s[4:7], s48 offen offset:3072 sc1
    v_mov_b32 v18, 0
    v_mov_b32 v18, 0
    v_mov_b32 v18, 0
    v_mov_b32 v18, 0
    v_mov_b32 v18, 0
    v_mov_b32 v18, 0
    v_mov_b32 v18, 0
    v_mov_b32 v18, 0
    v_mov_b32 v18, 0
    v_mov_b32 v18, 0
    v_mov_b32 v18, 0
    v_mov_b32 v18, 0
L_rsl_174:
    buffer_load_dwordx4 v[60:63], v2, s[4:7], s48 offen offset:0 sc1
    buffer_load_dwordx4 v[64:67], v2, s[4:7], s48 offen offset:1024 sc1
    buffer_load_dwordx4 v[68:71], v2, s[4:7], s48 offen offset:2048 sc1
    buffer_load_dwordx4 v[72:75], v2, s[4:7], s48 offen offset:3072 sc1
    s_waitcnt vmcnt(7)
    v_mfma_f32_16x16x32_bf16 v[120:123], v[44:47], v[136:139], 0
    s_waitcnt vmcnt(6)
    v_mfma_f32_16x16x32_bf16 v[120:123], v[48:51], v[136:139], v[120:123]
    v_bitop3_b32 v24, v44, v48, s41 bitop3:0x7e
    s_waitcnt vmcnt(5)
    v_mfma_f32_16x16x32_bf16 v[120:123], v[52:55], v[136:139], v[120:123]
    s_waitcnt vmcnt(4)
    v_mfma_f32_16x16x32_bf16 v[120:123], v[56:59], v[136:139], v[120:123]
    v_bitop3_b32 v25, v52, v56, s41 bitop3:0x7e
    v_bitop3_b32 v24, v24, v25, 1 bitop3:0xa8
    v_cmp_ne_u32 vcc, 0, v24
    s_cbranch_vccz L_rsd_175
    buffer_load_dwordx4 v[44:47], v2, s[4:7], s48 offen offset:0 sc1
    buffer_load_dwordx4 v[48:51], v2, s[4:7], s48 offen offset:1024 sc1
    buffer_load_dwordx4 v[52:55], v2, s[4:7], s48 offen offset:2048 sc1
    buffer_load_dwordx4 v[56:59], v2, s[4:7], s48 offen offset:3072 sc1
    s_waitcnt vmcnt(7)
    v_mfma_f32_16x16x32_bf16 v[120:123], v[60:63], v[136:139], 0
    s_waitcnt vmcnt(6)
    v_mfma_f32_16x16x32_bf16 v[120:123], v[64:67], v[136:139], v[120:123]
    v_bitop3_b32 v24, v60, v64, s41 bitop3:0x7e
    s_waitcnt vmcnt(5)
    v_mfma_f32_16x16x32_bf16 v[120:123], v[68:71], v[136:139], v[120:123]
    s_waitcnt vmcnt(4)
    v_mfma_f32_16x16x32_bf16 v[120:123], v[72:75], v[136:139], v[120:123]
    v_bitop3_b32 v25, v68, v72, s41 bitop3:0x7e
    v_bitop3_b32 v24, v24, v25, 1 bitop3:0xa8
    v_cmp_ne_u32 vcc, 0, v24
    s_cbranch_vccz L_rsd_175
    s_sub_u32 s27, s27, 1
    s_cbranch_scc0 L_ok_178
    s_mov_b32 s28, 4
    s_branch L_bail
L_ok_178:
    s_branch L_rsl_174
L_rsd_175:
    s_nop 3
    v_permlane32_swap_b32 v120, v122
    v_permlane32_swap_b32 v121, v123
    v_pk_add_f32 v[120:121], v[120:121], v[122:123]
    v_cvt_pk_bf16_f32 v26, v120, v121
    v_max_i32 v26, 2147483649, v26
    buffer_store_dword v26, v6, s[4:7], s53 offen sc1
    buffer_store_dword v26, v6, s[4:7], s50 offen sc1
    buffer_store_dword v22, v6, s[4:7], s51 offen sc1
L_nored_176:
    s_barrier
L_enter1:
    v_mov_b32 v120, 0
    v_mov_b32 v121, 0
    v_mov_b32 v122, 0
    v_mov_b32 v123, 0
    s_add_u32 s40, s40, 1
    s_mov_b32 s69, s70
    s_bfe_u32 s41, s40, 0x10001
    s_and_b32 s29, s40, 3
    s_lshl_b32 s28, s25, 17
    s_lshl_b32 s31, s29, 15
    s_add_u32 s50, s28, s31
    s_add_u32 s50, s50, 70254592
    s_xor_b32 s51, s50, 65536
    s_add_u32 s28, s28, s66
    s_add_u32 s53, s28, s31
    s_add_u32 s54, s31, 32768
    s_and_b32 s54, s54, 131071
    s_add_u32 s54, s54, s28
    s_lshl_b32 s31, s29, 14
    s_lshl_b32 s28, s25, 12
    s_add_u32 s28, s28, s65
    s_add_u32 s42, s28, s31
    s_xor_b32 s43, s42, 4096
    s_xor_b32 s44, s42, 32768
    s_and_b32 s28, s40, 1
    s_mul_i32 s29, s28, 163840
    s_lshl_b32 s30, s25, 19
    s_add_u32 s29, s29, s30
    s_add_u32 s45, s29, 69206016
    s_add_u32 s48, s45, s58
    s_add_u32 s49, s45, 65536
    s_add_u32 s29, s40, 1
    s_min_u32 s29, s29, 63
    s_lshl_b32 s29, s29, 13
    s_add_u32 s59, s57, s29
    s_add_u32 s60, s59, 524288
    s_bfe_u32 s29, s40, 0x20001
    s_lshl_b32 s29, s29, 14
    s_lshl_b32 s30, s28, 12
    s_add_u32 s29, s29, s30
    s_lshl_b32 s30, s25, 11
    s_add_u32 s29, s29, s30
    s_add_u32 s29, s29, s65
    s_sub_u32 s70, s29, 655360
    v_mov_b32 v18, 0
    v_mov_b32 v18, 0
    v_mov_b32 v18, 0
    v_mov_b32 v18, 0
    v_mov_b32 v18, 0
    v_mov_b32 v18, 0
    v_mov_b32 v18, 0
    v_mov_b32 v18, 0
    v_mov_b32 v18, 0
    v_mov_b32 v18, 0
    v_mov_b32 v18, 0
    v_mov_b32 v18, 0
    buffer_load_dword v132, v23, s[4:7], s52 offen sc1
    s_add_u32 m0, s56, 32768
    s_nop 0
    buffer_load_dwordx4 v3, s[4:7], s52 offen sc1 lds
    s_add_u32 m0, s64, 32768
    s_nop 0
    buffer_load_dword v4, s[4:7], s52 offen sc1 lds
    s_cmp_eq_u32 s40, 63
    s_cselect_b64 s[46:47], -1, 0
    s_xor_b32 s28, s28, 1
    s_lshl_b32 s28, s28, 14
    s_lshl_b32 s61, s26, 11
    s_add_u32 s61, s61, s28
    s_waitcnt vmcnt(0)
    v_cmp_eq_u32 vcc, v22, v132
    s_cbranch_vccnz L_lspin_180
L_lok_179:
    s_barrier
    ds_read_b128 v[44:47], v2 offset:32768
    ds_read_b128 v[48:51], v2 offset:33792
    ds_read_b128 v[52:55], v2 offset:34816
    ds_read_b128 v[56:59], v2 offset:35840
    ds_read_b128 v[60:63], v2 offset:36864
    buffer_load_dword v140, v23, s[4:7], s55 offen sc1
    s_add_u32 m0, s56, 41984
    s_nop 0
    buffer_load_dwordx4 v3, s[4:7], s55 offen sc1 lds
    s_branch L_step1
L_zrest_177:
    s_branch L_nored_176
L_lspin_180:
    buffer_load_dword v133, v23, s[4:7], s52 offen sc1
    s_add_u32 m0, s56, 32768
    s_nop 0
    buffer_load_dwordx4 v3, s[4:7], s52 offen sc1 lds
    s_add_u32 m0, s64, 32768
    s_nop 0
    buffer_load_dword v4, s[4:7], s52 offen sc1 lds
L_sp_181:
    buffer_load_dword v132, v23, s[4:7], s52 offen sc1
    s_add_u32 m0, s56, 32768
    s_nop 0
    buffer_load_dwordx4 v3, s[4:7], s52 offen sc1 lds
    s_add_u32 m0, s64, 32768
    s_nop 0
    buffer_load_dword v4, s[4:7], s52 offen sc1 lds
    s_waitcnt vmcnt(3)
    v_cmp_eq_u32 vcc, v22, v133
    s_cbranch_vccz L_spo_182
    buffer_load_dword v133, v23, s[4:7], s52 offen sc1
    s_add_u32 m0, s56, 32768
    s_nop 0
    buffer_load_dwordx4 v3, s[4:7], s52 offen sc1 lds
    s_add_u32 m0, s64, 32768
    s_nop 0
    buffer_load_dword v4, s[4:7], s52 offen sc1 lds
    s_waitcnt vmcnt(3)
    v_cmp_eq_u32 vcc, v22, v132
    s_cbranch_vccz L_spo_182
    s_sub_u32 s27, s27, 1
    s_cbranch_scc0 L_ok_183
    s_mov_b32 s28, 5
    s_branch L_bail
L_ok_183:
    s_branch L_sp_181
L_spo_182:
    s_branch L_lok_179
L_rretry_166:
    buffer_load_dword v141, v23, s[4:7], s55 offen sc1
    s_add_u32 m0, s56, 41984
    s_nop 0
    buffer_load_dwordx4 v3, s[4:7], s55 offen sc1 lds
    s_add_u32 m0, s64, 41984
    s_nop 0
    buffer_load_dword v4, s[4:7], s55 offen sc1 lds
L_sp_184:
    buffer_load_dword v140, v23, s[4:7], s55 offen sc1
    s_add_u32 m0, s56, 41984
    s_nop 0
    buffer_load_dwordx4 v3, s[4:7], s55 offen sc1 lds
    s_add_u32 m0, s64, 41984
    s_nop 0
    buffer_load_dword v4, s[4:7], s55 offen sc1 lds
    s_waitcnt vmcnt(3)
    v_cmp_eq_u32 vcc, v22, v141
    s_cbranch_vccz L_spo_185
    buffer_load_dword v141, v23, s[4:7], s55 offen sc1
    s_add_u32 m0, s56, 41984
    s_nop 0
    buffer_load_dwordx4 v3, s[4:7], s55 offen sc1 lds
    s_add_u32 m0, s64, 41984
    s_nop 0
    buffer_load_dword v4, s[4:7], s55 offen sc1 lds
    s_waitcnt vmcnt(3)
    v_cmp_eq_u32 vcc, v22, v140
    s_cbranch_vccz L_spo_185
    s_sub_u32 s27, s27, 1
    s_cbranch_scc0 L_ok_186
    s_mov_b32 s28, 6
    s_branch L_bail
L_ok_186:
    s_branch L_sp_184
L_spo_185:
    s_waitcnt vmcnt(0)
    s_branch L_rjoin_167
L_w1_168:
    buffer_load_dword v21, v20, s[4:7], s62 offen sc1
    s_sub_u32 s27, s27, 1
    s_cbranch_scc0 L_ok_187
    s_mov_b32 s28, 3
    s_branch L_bail
L_ok_187:
    s_waitcnt vmcnt(0)
    v_add_u32 v21, v21, v15
    v_cmp_gt_u32 vcc, s29, v21
    s_cbranch_vccnz L_w1_168
    s_branch L_w1ok_169
L_vretry_171:
    s_waitcnt vmcnt(4)
    v_mov_b32 v140, v28
    v_mov_b32 v141, v29
    v_cmp_eq_u32 vcc, v22, v28
    s_cbranch_vccz L_v_170
L_vr2_188:
    buffer_load_dwordx2 v[140:141], v5, s[4:7], s43 offen sc1
    s_sub_u32 s27, s27, 1
    s_cbranch_scc0 L_ok_189
    s_mov_b32 s28, 7
    s_branch L_bail
L_ok_189:
    s_waitcnt vmcnt(0)
    v_cmp_eq_u32 vcc, v22, v140
    s_cbranch_vccnz L_vr2_188
    s_branch L_v_170
L_slowsm_172:
    s_cmp_eq_u32 s40, 63
    s_cbranch_scc1 L_rdone1
    s_mov_b64 s[74:75], 0
    s_waitcnt lgkmcnt(0)
    s_barrier
    v_xor_b32 v26, 16384, v13
    v_xor_b32 v27, 16384, v14
    ds_read_b128 v[44:47], v26 offset:0
    ds_read_b128 v[48:51], v26 offset:1024
    ds_read_b128 v[52:55], v26 offset:2048
    ds_read_b128 v[56:59], v26 offset:3072
    ds_read_b128 v[60:63], v26 offset:4096
    ds_read_b128 v[64:67], v26 offset:5120
    ds_read_b128 v[68:71], v26 offset:6144
    ds_read_b128 v[72:75], v26 offset:7168
    ds_read_b64_tr_b16 v[132:133], v27 offset:0
    ds_read_b64_tr_b16 v[134:135], v27 offset:4096
    ds_read_b64_tr_b16 v[136:137], v27 offset:512
    ds_read_b64_tr_b16 v[138:139], v27 offset:4608
    s_waitcnt lgkmcnt(0)
    ds_read_b64_tr_b16 v[76:77], v10 offset:0
    ds_read_b64_tr_b16 v[78:79], v0 offset:256
    ds_read_b64_tr_b16 v[92:93], v10 offset:4096
    ds_read_b64_tr_b16 v[94:95], v0 offset:4352
    s_waitcnt lgkmcnt(0)
    ds_read_b64_tr_b16 v[80:81], v10 offset:1024
    ds_read_b64_tr_b16 v[82:83], v0 offset:1280
    ds_read_b64_tr_b16 v[96:97], v10 offset:5120
    ds_read_b64_tr_b16 v[98:99], v0 offset:5376
    s_waitcnt lgkmcnt(0)
    ds_read_b64_tr_b16 v[84:85], v10 offset:2048
    ds_read_b64_tr_b16 v[86:87], v0 offset:2304
    ds_read_b64_tr_b16 v[100:101], v10 offset:6144
    ds_read_b64_tr_b16 v[102:103], v0 offset:6400
    s_waitcnt lgkmcnt(0)
    ds_read_b64_tr_b16 v[88:89], v10 offset:3072
    ds_read_b64_tr_b16 v[90:91], v0 offset:3328
    ds_read_b64_tr_b16 v[104:105], v10 offset:7168
    ds_read_b64_tr_b16 v[106:107], v0 offset:7424
    s_waitcnt lgkmcnt(0)
    v_mfma_f32_16x16x32_bf16 v[108:111], v[44:47], v[76:79], 0
    v_mfma_f32_16x16x32_bf16 v[108:111], v[48:51], v[80:83], v[108:111]
    v_mfma_f32_16x16x32_bf16 v[108:111], v[52:55], v[84:87], v[108:111]
    v_mfma_f32_16x16x32_bf16 v[108:111], v[56:59], v[88:91], v[108:111]
    v_mfma_f32_16x16x32_bf16 v[112:115], v[60:63], v[76:79], 0
    v_mfma_f32_16x16x32_bf16 v[112:115], v[64:67], v[80:83], v[112:115]
    v_mfma_f32_16x16x32_bf16 v[112:115], v[68:71], v[84:87], v[112:115]
    v_mfma_f32_16x16x32_bf16 v[112:115], v[72:75], v[88:91], v[112:115]
    v_mfma_f32_16x16x32_bf16 v[120:123], v[92:95], v[76:79], 0
    v_mfma_f32_16x16x32_bf16 v[120:123], v[96:99], v[80:83], v[120:123]
    v_mfma_f32_16x16x32_bf16 v[120:123], v[100:103], v[84:87], v[120:123]
    v_mfma_f32_16x16x32_bf16 v[120:123], v[104:107], v[88:91], v[120:123]
    s_nop 7
    v_mul_f32 v120, s72, v120
    v_mul_f32 v121, s72, v121
    v_max3_f32 v26, v108, v109, v110
    v_max3_f32 v26, v26, v111, v112
    v_max3_f32 v26, v26, v113, v114
    v_max3_f32 v26, v26, v115, v120
    v_max_f32 v26, v26, v121
    v_mov_b32 v27, v26
    s_nop 1
    v_permlane32_swap_b32 v27, v26
    v_max_f32 v26, v26, v27
    v_mov_b32 v27, v26
    s_nop 1
    v_permlane16_swap_b32 v27, v26
    v_max_f32 v26, v26, v27
    v_sub_f32 v108, v108, v26
    v_exp_f32 v108, v108
    v_sub_f32 v109, v109, v26
    v_exp_f32 v109, v109
    v_sub_f32 v110, v110, v26
    v_exp_f32 v110, v110
    v_sub_f32 v111, v111, v26
    v_exp_f32 v111, v111
    v_sub_f32 v112, v112, v26
    v_exp_f32 v112, v112
    v_sub_f32 v113, v113, v26
    v_exp_f32 v113, v113
    v_sub_f32 v114, v114, v26
    v_exp_f32 v114, v114
    v_sub_f32 v115, v115, v26
    v_exp_f32 v115, v115
    v_sub_f32 v120, v120, v26
    v_exp_f32 v120, v120
    v_sub_f32 v121, v121, v26
    v_exp_f32 v121, v121
    v_cvt_pk_bf16_f32 v128, v108, v109
    v_cvt_pk_bf16_f32 v129, v110, v111
    v_cvt_pk_bf16_f32 v130, v112, v113
    v_cvt_pk_bf16_f32 v131, v114, v115
    v_cvt_pk_bf16_f32 v40, v120, v121
    s_nop 0
    v_mfma_f32_16x16x32_bf16 v[108:111], v[132:135], v[128:131], 0
    v_mfma_f32_16x16x32_bf16 v[112:115], v[136:139], v[128:131], 0
    v_mfma_f32_16x16x32_bf16 v[116:119], v[128:131], v[36:39], 0
    s_branch L_smjoin_173
L_rdone1:
    s_endpgm
.section .rodata,"a"
.p2align 6
.amdhsa_kernel parallel_sum__memory_aug_recurrent_mem_tr__glu_gated_glu__prompt_kernel
  .amdhsa_next_free_vgpr 512
  .amdhsa_next_free_sgpr 102
  .amdhsa_accum_offset 256
  .amdhsa_group_segment_fixed_size 0
  .amdhsa_kernarg_size 112
  .amdhsa_user_sgpr_count 2
  .amdhsa_user_sgpr_kernarg_segment_ptr 1
  .amdhsa_system_sgpr_workgroup_id_x 1
.end_amdhsa_kernel
```
